```python
import torch

def _softmax(x, axis=-1):
    return torch.softmax(x, dim=axis)
def _gelu(x):
    return torch.nn.functional.gelu(x, approximate="tanh")
def _silu(x):
    return torch.nn.functional.silu(x)
def _sigmoid(x):
    return torch.sigmoid(x)
def _layernorm(x, axis=-1, eps=1e-5):
    m = x.mean(dim=axis, keepdim=True)
    v = x.var(dim=axis, keepdim=True, unbiased=False)
    return (x - m) / torch.sqrt(v + eps)
def _scatter_add(tgt, idx, src, axis=0):
    return tgt.clone().index_add_(axis, idx, src)
def _segment_sum(src, seg, n):
    out = torch.zeros((n,) + src.shape[1:], dtype=src.dtype)
    return out.index_add_(0, seg, src)
def _pad(x, pw):
    flat = tuple(v for pair in reversed(pw) for v in pair)
    return torch.nn.functional.pad(x, flat)

kernel_name = 'interleave_layers__spectral_fnet__dense_activation_relu__prompt'

def setup_inputs():

    _w = (lambda a: (lambda t: t.to(torch.bfloat16) if t.is_floating_point() else t)(torch.as_tensor(a)))
    def _A_setup():
        B, S, D = 1, 2048, 448
        ns = torch.arange(S)[:, None] * torch.arange(S)[None, :]
        nd = torch.arange(D)[:, None] * torch.arange(D)[None, :]
        Ws_re = torch.cos(-2.0 * torch.pi * ns / S).to(float)
        Ws_im = torch.sin(-2.0 * torch.pi * ns / S).to(float)
        Wd_re = torch.cos(-2.0 * torch.pi * nd / D).to(float)
        Wd_im = torch.sin(-2.0 * torch.pi * nd / D).to(float)
        return {
            "x": _w((lambda *s: torch.randn(*s, dtype=torch.bfloat16) * 0.05)(B, S, D)),
            "dft_seq_re": _w(Ws_re),
            "dft_seq_im": _w(Ws_im),
            "dft_hid_re": _w(Wd_re),
            "dft_hid_im": _w(Wd_im),
        }
    _A_in = _A_setup()

    def _B_setup():
        B, S, D, Dff = 1, 2048, 448, 1792
        return {
            "x": _w((lambda *s: torch.randn(*s, dtype=torch.bfloat16) * 0.05)(B, S, D)),
            "w1": _w((lambda *s: torch.randn(*s, dtype=torch.bfloat16) * 1.6)(D, Dff)),
            "w2": _w((lambda *s: torch.randn(*s, dtype=torch.bfloat16) * 1.6)(Dff, D)),
        }
    _B_in = _B_setup()

    return {
        "A_x": _A_in["x"],
        "A_dft_seq_re": _A_in["dft_seq_re"],
        "A_dft_seq_im": _A_in["dft_seq_im"],
        "A_dft_hid_re": _A_in["dft_hid_re"],
        "A_dft_hid_im": _A_in["dft_hid_im"],
        "B_x": _B_in["x"],
        "B_w1": _B_in["w1"],
        "B_w2": _B_in["w2"],
    }

def reference(A_x, A_dft_seq_re, A_dft_seq_im, A_dft_hid_re, A_dft_hid_im, B_x, B_w1, B_w2):
    def _A_ref(x, dft_seq_re, dft_seq_im, dft_hid_re, dft_hid_im):
        a = torch.einsum("bsd,ed->bse", x, dft_hid_re)
        b = torch.einsum("bsd,ed->bse", x, dft_hid_im)
        y = torch.einsum("ts,bse->bte", dft_seq_re, a) - torch.einsum("ts,bse->bte", dft_seq_im, b)
        return y

    def _B_ref(x, w1, w2):
        h = torch.einsum("bsd,df->bsf", x, w1)
        zero = torch.zeros_like(h)
        h = torch.maximum(h, zero)
        return torch.einsum("bsf,fd->bsd", h, w2)

    x = A_x
    x = x + _A_ref(_layernorm(x, axis=-1), A_dft_seq_re, A_dft_seq_im, A_dft_hid_re, A_dft_hid_im)
    x = x + _B_ref(_layernorm(x, axis=-1), B_w1, B_w2)
    x = x + _A_ref(_layernorm(x, axis=-1), A_dft_seq_re, A_dft_seq_im, A_dft_hid_re, A_dft_hid_im)
    x = x + _B_ref(_layernorm(x, axis=-1), B_w1, B_w2)
    return x
```

```asm
; @launch grid=(256,1,1) block=(256,1,1) lds=163840
.amdgcn_target "amdgcn-amd-amdhsa--gfx950"
.text
.globl interleave_layers__spectral_fnet__dense_activation_relu__prompt_kernel
.p2align 8
.type interleave_layers__spectral_fnet__dense_activation_relu__prompt_kernel,@function
interleave_layers__spectral_fnet__dense_activation_relu__prompt_kernel:
    s_cmp_ge_u32 s2, 256
    s_cbranch_scc1 L_end
    s_load_dwordx2 s[4:5], s[0:1], 0
    s_load_dwordx4 s[40:43], s[0:1], 48
    s_load_dwordx4 s[44:47], s[0:1], 64
    s_load_dwordx2 s[8:9], s[0:1], 80
    s_getpc_b64 s[36:37]
L_pf_1:
    s_lshr_b32 s34, s2, 3
    s_lshl_b32 s34, s34, 11
    v_lshrrev_b32 v22, 4, v0
    v_lshl_add_u32 v22, v22, 7, s34
    v_min_u32 v22, L_code_end - L_pf_1 - 64, v22
    global_load_dword v13, v22, s[36:37]
    v_lshrrev_b32 v23, 6, v0
    v_and_b32 v0, 63, v0
    v_readfirstlane_b32 s26, v23
    v_lshlrev_b32 v1, 4, v0
    s_mov_b32 s6, 1835008
    s_mov_b32 s7, 0x20000
    s_mov_b32 s10, 13729792
    s_mov_b32 s11, 0x20000
    s_and_b32 s30, s2, 7
    s_mul_i32 s60, s26, 24576
    s_add_u32 s60, s60, 59392
    s_cmp_ge_u32 s2, 224
    s_cbranch_scc1 L_helper
    s_lshr_b32 s34, s2, 3
    s_mul_i32 s35, s34, 37
    s_lshr_b32 s35, s35, 8
    s_lshl2_add_u32 s24, s30, s35
    s_mul_i32 s35, s35, 7
    s_sub_u32 s25, s34, s35
    s_lshr_b32 s27, s24, 1
    s_and_b32 s34, s24, 1
    s_lshl_b32 s34, s34, 5
    s_add_u32 s27, s27, s34
    s_cmp_eq_u32 s24, 1
    s_cselect_b32 s27, 16, s27
    s_cmp_eq_u32 s24, 0
    s_cselect_b32 s28, 32, s27
    s_cselect_b32 s38, 0, 1.0
    s_and_b32 s29, s27, 31
    s_lshl2_add_u32 s31, s25, s26
    v_and_b32 v2, 15, v0
    v_lshrrev_b32 v3, 4, v0
    s_lshl_b32 s34, s26, 8
    s_add_u32 s3, s34, s27
    s_mul_i32 s3, s3, 896
    s_add_u32 s100, s34, s28
    s_sub_u32 s100, 2048, s100
    s_mul_i32 s100, s100, 896
    s_mul_i32 s101, s26, 3712
    s_waitcnt lgkmcnt(0)
    s_and_b32 s5, s5, 0xffff
    s_add_u32 m0, s101, 0
    s_add_u32 s57, s3, 0
    s_mov_b32 exec_hi, 0x00ffffff
    buffer_load_dwordx4 v1, s[4:7], s57 offen sc1 lds
    s_mov_b32 exec_hi, -1
    s_add_u32 m0, s101, 928
    s_add_u32 s57, s3, 57344
    s_mov_b32 exec_hi, 0x00ffffff
    buffer_load_dwordx4 v1, s[4:7], s57 offen sc1 lds
    s_mov_b32 exec_hi, -1
    s_add_u32 m0, s101, 1856
    s_add_u32 s57, s3, 114688
    s_mov_b32 exec_hi, 0x00ffffff
    buffer_load_dwordx4 v1, s[4:7], s57 offen sc1 lds
    s_mov_b32 exec_hi, -1
    s_and_b32 s9, s9, 0xffff
    s_mov_b32 s39, 262144
    s_mov_b32 s16, s40
    s_and_b32 s17, s41, 0xffff
    s_mov_b32 s18, 1605632
    s_mov_b32 s19, 0x20000
    s_mov_b32 s20, s42
    s_and_b32 s21, s43, 0xffff
    s_add_u32 m0, s101, 2784
    s_add_u32 s57, s3, 172032
    s_mov_b32 exec_hi, 0x00ffffff
    buffer_load_dwordx4 v1, s[4:7], s57 offen sc1 lds
    s_mov_b32 exec_hi, -1
    s_mov_b32 s22, 1605632
    s_mov_b32 s23, 0x20000
    s_mov_b32 s12, s44
    s_and_b32 s13, s45, 0xffff
    s_mov_b32 s14, 1835008
    s_mov_b32 s15, 0x20000
    s_mov_b32 s92, s46
    s_and_b32 s93, s47, 0xffff
    s_add_u32 m0, s101, 14848
    s_add_u32 s57, s3, 917504
    s_mov_b32 exec_hi, 0x00ffffff
    buffer_load_dwordx4 v1, s[4:7], s57 offen sc1 lds
    s_mov_b32 exec_hi, -1
    s_mov_b32 s94, 256
    s_mov_b32 s95, 0x20000
    v_lshrrev_b32 v136, 3, v0
    v_and_b32 v137, 6, v136
    v_xor_b32 v137, v137, v0
    v_and_b32 v137, 7, v137
    v_lshlrev_b32 v137, 4, v137
    s_lshl_b32 s34, s31, 7
    s_add_u32 m0, s101, 15776
    s_add_u32 s57, s3, 974848
    s_mov_b32 exec_hi, 0x00ffffff
    buffer_load_dwordx4 v1, s[4:7], s57 offen sc1 lds
    s_mov_b32 exec_hi, -1
    v_add_u32 v137, s34, v137
    v_and_b32 v138, 4, v136
    v_add_u32 v138, v138, v136
    s_movk_i32 s35, 3584
    v_mad_u32_u24 v248, v138, s35, v137
    v_sub_u32 v22, 11, v138
    v_mad_u32_u24 v249, v22, s35, v137
    v_sub_u32 v22, 447, v138
    s_add_u32 m0, s101, 16704
    s_add_u32 s57, s3, 1032192
    s_mov_b32 exec_hi, 0x00ffffff
    buffer_load_dwordx4 v1, s[4:7], s57 offen sc1 lds
    s_mov_b32 exec_hi, -1
    v_mov_b32 v23, 223
    v_cmp_eq_u32 vcc, 0, v138
    s_nop 1
    v_cndmask_b32 v22, v22, v23, vcc
    v_mad_u32_u24 v250, v22, s35, v137
    v_bfe_u32 v136, v0, 2, 3
    v_lshrrev_b32 v22, 5, v0
    v_lshlrev_b32 v22, 11, v22
    v_lshl_add_u32 v22, v136, 7, v22
    s_add_u32 m0, s101, 17632
    s_add_u32 s57, s3, 1089536
    s_mov_b32 exec_hi, 0x00ffffff
    buffer_load_dwordx4 v1, s[4:7], s57 offen sc1 lds
    s_mov_b32 exec_hi, -1
    v_lshrrev_b32 v136, 1, v136
    v_lshl_add_u32 v22, v136, 5, v22
    v_and_b32 v23, 3, v0
    v_lshl_add_u32 v22, v23, 3, v22
    v_add_u32 v252, s60, v22
    v_xor_b32 v253, 32, v252
    v_xor_b32 v254, 64, v252
    v_xor_b32 v255, 96, v252
    s_add_u32 m0, s101, 29696
    s_sub_u32 s57, s100, 0
    s_mov_b32 exec_hi, 0x00ffffff
    buffer_load_dwordx4 v1, s[4:7], s57 offen sc1 lds
    s_mov_b32 exec_hi, -1
    v_mul_u32_u24 v132, 928, v2
    v_lshl_add_u32 v132, v3, 4, v132
    v_and_b32 v22, 3, v2
    v_and_b32 v23, 4, v2
    v_lshl_add_u32 v22, v23, 2, v22
    s_lshl_b32 s34, s26, 2
    v_add_u32 v22, s34, v22
    v_lshlrev_b32 v215, 2, v22
    v_add_u32 v215, 157696, v215
    v_mul_u32_u24 v133, 928, v22
    v_lshrrev_b32 v23, 3, v2
    v_lshl_add_u32 v133, v3, 4, v133
    v_lshl_add_u32 v196, v23, 6, v133
    v_mul_u32_u24 v23, 384, v23
    v_add_u32 v133, v133, v23
    s_lshl_b32 s34, s31, 11
    s_lshl_b32 s35, s24, 6
    s_add_u32 s34, s34, s35
    v_mul_u32_u24 v134, 57344, v2
    v_lshl_add_u32 v134, v3, 4, v134
    s_add_u32 m0, s101, 30624
    s_sub_u32 s57, s100, 57344
    s_mov_b32 exec_hi, 0x00ffffff
    buffer_load_dwordx4 v1, s[4:7], s57 offen sc1 lds
    s_mov_b32 exec_hi, -1
    v_add_u32 v134, s34, v134
    v_mov_b32 v208, 0x3f803f80
    v_mov_b32 v209, 0x3f803f80
    v_mov_b32 v210, 0x3f803f80
    v_mov_b32 v211, 0x3f803f80
    s_lshr_b32 s34, s31, 1
    s_lshl_b32 s34, s34, 4
    s_and_b32 s35, s31, 1
    s_lshl2_add_u32 s34, s35, s34
    v_and_b32 v185, 7, v2
    v_and_b32 v184, 4, v2
    v_add3_u32 v185, v185, v184, s34
    v_cmp_le_u32 vcc, 8, v2
    v_cmp_eq_u32 s[36:37], 0, v185
    s_nop 0
    s_and_b64 s[36:37], s[36:37], vcc
    s_andn2_b64 vcc, vcc, s[36:37]
    v_mov_b32 v184, 224
    v_cndmask_b32 v185, v185, v184, s[36:37]
    v_mov_b32 v184, 0xbe800000
    s_add_u32 m0, s101, 31552
    s_sub_u32 s57, s100, 114688
    s_mov_b32 exec_hi, 0x00ffffff
    buffer_load_dwordx4 v1, s[4:7], s57 offen sc1 lds
    s_mov_b32 exec_hi, -1
    v_cndmask_b32 v186, 0, v184, vcc
    v_cndmask_b32 v213, 1.0, -1.0, vcc
    v_mul_f32 v212, s38, v213
    v_bfe_i32 v188, v185, 0, 1
    v_and_b32 v188, 0x80008000, v188
    v_cvt_f32_u32 v185, v185
    v_mul_f32 v185, 0x3b124925, v185
    v_lshlrev_b32 v187, 3, v3
    v_cvt_f32_u32 v187, v187
    v_fma_f32 v168, v187, v185, v186
    v_mul_f32 v184, 0x42000000, v185
    v_fmamk_f32 v169, v185, 0x3f800000, v168
    v_fmamk_f32 v170, v185, 0x40000000, v168
    v_fmamk_f32 v171, v185, 0x40400000, v168
    v_fmamk_f32 v172, v185, 0x40800000, v168
    v_fmamk_f32 v173, v185, 0x40a00000, v168
    v_fmamk_f32 v174, v185, 0x40c00000, v168
    v_fmamk_f32 v175, v185, 0x40e00000, v168
    v_pk_add_f32 v[176:177], v[168:169], v[184:185] op_sel_hi:[1,0]
    v_pk_add_f32 v[178:179], v[170:171], v[184:185] op_sel_hi:[1,0]
    s_add_u32 m0, s101, 32480
    s_sub_u32 s57, s100, 172032
    s_mov_b32 exec_hi, 0x00ffffff
    buffer_load_dwordx4 v1, s[4:7], s57 offen sc1 lds
    s_mov_b32 exec_hi, -1
    v_pk_add_f32 v[180:181], v[172:173], v[184:185] op_sel_hi:[1,0]
    v_pk_add_f32 v[182:183], v[174:175], v[184:185] op_sel_hi:[1,0]
    v_cos_f32 v184, v184
    v_cos_f32 v168, v168
    v_cos_f32 v169, v169
    v_cos_f32 v170, v170
    v_cos_f32 v171, v171
    v_cos_f32 v172, v172
    v_cos_f32 v173, v173
    v_cos_f32 v174, v174
    v_cos_f32 v175, v175
    s_add_u32 m0, s101, 44544
    s_sub_u32 s57, s100, 917504
    s_mov_b32 exec_hi, 0x00ffffff
    buffer_load_dwordx4 v1, s[4:7], s57 offen sc1 lds
    s_mov_b32 exec_hi, -1
    v_cos_f32 v176, v176
    v_cos_f32 v177, v177
    v_cos_f32 v178, v178
    v_cos_f32 v179, v179
    v_cos_f32 v180, v180
    v_cos_f32 v181, v181
    v_cos_f32 v182, v182
    v_cos_f32 v183, v183
    v_add_f32 v184, v184, v184
    v_cvt_pk_bf16_f32 v56, v168, v169
    v_cvt_pk_bf16_f32 v57, v170, v171
    s_add_u32 m0, s101, 45472
    s_sub_u32 s57, s100, 974848
    s_mov_b32 exec_hi, 0x00ffffff
    buffer_load_dwordx4 v1, s[4:7], s57 offen sc1 lds
    s_mov_b32 exec_hi, -1
    v_cvt_pk_bf16_f32 v58, v172, v173
    v_cvt_pk_bf16_f32 v59, v174, v175
    v_cvt_pk_bf16_f32 v60, v176, v177
    v_cvt_pk_bf16_f32 v61, v178, v179
    v_cvt_pk_bf16_f32 v62, v180, v181
    v_cvt_pk_bf16_f32 v63, v182, v183
    v_pk_fma_f32 v[168:169], v[184:185], v[176:177], v[168:169] op_sel_hi:[0,1,1] neg_lo:[0,0,1] neg_hi:[0,0,1]
    v_pk_fma_f32 v[170:171], v[184:185], v[178:179], v[170:171] op_sel_hi:[0,1,1] neg_lo:[0,0,1] neg_hi:[0,0,1]
    v_pk_fma_f32 v[172:173], v[184:185], v[180:181], v[172:173] op_sel_hi:[0,1,1] neg_lo:[0,0,1] neg_hi:[0,0,1]
    v_pk_fma_f32 v[174:175], v[184:185], v[182:183], v[174:175] op_sel_hi:[0,1,1] neg_lo:[0,0,1] neg_hi:[0,0,1]
    v_cvt_pk_bf16_f32 v64, v168, v169
    v_cvt_pk_bf16_f32 v65, v170, v171
    v_cvt_pk_bf16_f32 v66, v172, v173
    v_cvt_pk_bf16_f32 v67, v174, v175
    v_pk_fma_f32 v[176:177], v[184:185], v[168:169], v[176:177] op_sel_hi:[0,1,1] neg_lo:[0,0,1] neg_hi:[0,0,1]
    v_pk_fma_f32 v[178:179], v[184:185], v[170:171], v[178:179] op_sel_hi:[0,1,1] neg_lo:[0,0,1] neg_hi:[0,0,1]
    v_pk_fma_f32 v[180:181], v[184:185], v[172:173], v[180:181] op_sel_hi:[0,1,1] neg_lo:[0,0,1] neg_hi:[0,0,1]
    v_pk_fma_f32 v[182:183], v[184:185], v[174:175], v[182:183] op_sel_hi:[0,1,1] neg_lo:[0,0,1] neg_hi:[0,0,1]
    v_cvt_pk_bf16_f32 v68, v176, v177
    s_add_u32 m0, s101, 46400
    s_sub_u32 s57, s100, 1032192
    s_mov_b32 exec_hi, 0x00ffffff
    buffer_load_dwordx4 v1, s[4:7], s57 offen sc1 lds
    s_mov_b32 exec_hi, -1
    v_cvt_pk_bf16_f32 v69, v178, v179
    v_cvt_pk_bf16_f32 v70, v180, v181
    v_cvt_pk_bf16_f32 v71, v182, v183
    v_pk_fma_f32 v[168:169], v[184:185], v[176:177], v[168:169] op_sel_hi:[0,1,1] neg_lo:[0,0,1] neg_hi:[0,0,1]
    v_pk_fma_f32 v[170:171], v[184:185], v[178:179], v[170:171] op_sel_hi:[0,1,1] neg_lo:[0,0,1] neg_hi:[0,0,1]
    v_pk_fma_f32 v[172:173], v[184:185], v[180:181], v[172:173] op_sel_hi:[0,1,1] neg_lo:[0,0,1] neg_hi:[0,0,1]
    v_pk_fma_f32 v[174:175], v[184:185], v[182:183], v[174:175] op_sel_hi:[0,1,1] neg_lo:[0,0,1] neg_hi:[0,0,1]
    v_cvt_pk_bf16_f32 v72, v168, v169
    v_cvt_pk_bf16_f32 v73, v170, v171
    v_cvt_pk_bf16_f32 v74, v172, v173
    v_cvt_pk_bf16_f32 v75, v174, v175
    v_pk_fma_f32 v[176:177], v[184:185], v[168:169], v[176:177] op_sel_hi:[0,1,1] neg_lo:[0,0,1] neg_hi:[0,0,1]
    v_pk_fma_f32 v[178:179], v[184:185], v[170:171], v[178:179] op_sel_hi:[0,1,1] neg_lo:[0,0,1] neg_hi:[0,0,1]
    v_pk_fma_f32 v[180:181], v[184:185], v[172:173], v[180:181] op_sel_hi:[0,1,1] neg_lo:[0,0,1] neg_hi:[0,0,1]
    v_pk_fma_f32 v[182:183], v[184:185], v[174:175], v[182:183] op_sel_hi:[0,1,1] neg_lo:[0,0,1] neg_hi:[0,0,1]
    v_cvt_pk_bf16_f32 v76, v176, v177
    v_cvt_pk_bf16_f32 v77, v178, v179
    v_cvt_pk_bf16_f32 v78, v180, v181
    v_cvt_pk_bf16_f32 v79, v182, v183
    v_pk_fma_f32 v[168:169], v[184:185], v[176:177], v[168:169] op_sel_hi:[0,1,1] neg_lo:[0,0,1] neg_hi:[0,0,1]
    s_add_u32 m0, s101, 47328
    s_sub_u32 s57, s100, 1089536
    s_mov_b32 exec_hi, 0x00ffffff
    buffer_load_dwordx4 v1, s[4:7], s57 offen sc1 lds
    s_mov_b32 exec_hi, -1
    v_pk_fma_f32 v[170:171], v[184:185], v[178:179], v[170:171] op_sel_hi:[0,1,1] neg_lo:[0,0,1] neg_hi:[0,0,1]
    v_pk_fma_f32 v[172:173], v[184:185], v[180:181], v[172:173] op_sel_hi:[0,1,1] neg_lo:[0,0,1] neg_hi:[0,0,1]
    v_pk_fma_f32 v[174:175], v[184:185], v[182:183], v[174:175] op_sel_hi:[0,1,1] neg_lo:[0,0,1] neg_hi:[0,0,1]
    v_cvt_pk_bf16_f32 v80, v168, v169
    v_cvt_pk_bf16_f32 v81, v170, v171
    v_cvt_pk_bf16_f32 v82, v172, v173
    v_cvt_pk_bf16_f32 v83, v174, v175
    v_xor_b32 v84, v56, v188
    v_xor_b32 v85, v57, v188
    v_xor_b32 v86, v58, v188
    v_xor_b32 v87, v59, v188
    v_xor_b32 v88, v60, v188
    v_xor_b32 v89, v61, v188
    v_xor_b32 v90, v62, v188
    v_xor_b32 v91, v63, v188
    v_xor_b32 v92, v64, v188
    v_xor_b32 v93, v65, v188
    v_xor_b32 v94, v66, v188
    v_xor_b32 v95, v67, v188
    s_lshl2_add_u32 s57, s2, s26
    s_mul_i32 s57, s57, 1792
    v_lshrrev_b32 v198, 2, v0
    v_min_u32 v198, 13, v198
    v_lshlrev_b32 v198, 7, v198
    buffer_load_dword v13, v198, s[16:19], s57 offen
    v_xor_b32 v96, v68, v188
    v_xor_b32 v97, v69, v188
    v_xor_b32 v98, v70, v188
    v_xor_b32 v99, v71, v188
    v_xor_b32 v100, v72, v188
    v_xor_b32 v101, v73, v188
    v_xor_b32 v102, v74, v188
    v_xor_b32 v103, v75, v188
    v_xor_b32 v104, v76, v188
    v_xor_b32 v105, v77, v188
    v_xor_b32 v106, v78, v188
    v_xor_b32 v107, v79, v188
    v_xor_b32 v108, v80, v188
    v_xor_b32 v109, v81, v188
    v_xor_b32 v110, v82, v188
    v_xor_b32 v111, v83, v188
    v_and_b32 v22, 0xffff0000, v56
    v_cmp_eq_u32 vcc, 0, v3
    s_nop 1
    v_cndmask_b32 v56, v56, v22, vcc
    v_cvt_f32_u32 v160, v2
    v_mul_f32 v160, 0x3d000000, v160
    v_mfma_f32_16x16x32_bf16 v[216:219], v[208:211], v[56:59], 0
    v_lshlrev_b32 v148, 2, v3
    v_cvt_f32_u32 v148, v148
    s_cmp_eq_u32 s24, 0
    s_cselect_b32 s34, 0.5, 0
    s_cselect_b32 s35, 0, 0xbe800000
    v_mfma_f32_16x16x32_bf16 v[216:219], v[208:211], v[60:63], v[216:219]
    s_bitcmp1_b32 s26, 1
    s_cselect_b32 s34, s34, 0
    s_cselect_b32 s35, s35, 0
    s_bitcmp1_b32 s26, 0
    s_cselect_b32 s36, 0x3e800000, 0
    v_mfma_f32_16x16x32_bf16 v[216:219], v[208:211], v[64:67], v[216:219]
    v_add_f32 v148, s34, v148
    v_mov_b32 v161, s35
    v_add_f32 v161, s36, v161
    v_fma_f32 v148, v148, v160, v161
    v_mfma_f32_16x16x32_bf16 v[216:219], v[208:211], v[68:71], v[216:219]
    v_fmamk_f32 v149, v160, 0x3f800000, v148
    v_fmamk_f32 v150, v160, 0x40000000, v148
    v_fmamk_f32 v151, v160, 0x40400000, v148
    v_fmamk_f32 v152, v160, 0x41800000, v148
    v_mfma_f32_16x16x32_bf16 v[216:219], v[208:211], v[72:75], v[216:219]
    v_fmamk_f32 v153, v160, 0x41880000, v148
    v_fmamk_f32 v154, v160, 0x41900000, v148
    v_fmamk_f32 v155, v160, 0x41980000, v148
    v_cos_f32 v148, v148
    v_mfma_f32_16x16x32_bf16 v[216:219], v[208:211], v[76:79], v[216:219]
    v_cos_f32 v149, v149
    v_cos_f32 v150, v150
    v_mfma_f32_16x16x32_bf16 v[216:219], v[208:211], v[80:83], v[216:219]
    v_cos_f32 v151, v151
    v_cos_f32 v152, v152
    v_cos_f32 v153, v153
    v_mfma_f32_16x16x32_bf16 v[216:219], v[208:211], v[84:87], v[216:219]
    v_cos_f32 v154, v154
    v_cos_f32 v155, v155
    v_mfma_f32_16x16x32_bf16 v[216:219], v[208:211], v[88:91], v[216:219]
    s_lshl_b32 s34, s26, 10
    s_add_u32 s34, s34, 159744
    v_add_u32 v161, s34, v1
    v_cvt_pk_f16_f32 v156, v148, v149
    v_mfma_f32_16x16x32_bf16 v[216:219], v[208:211], v[92:95], v[216:219]
    v_cvt_pk_f16_f32 v157, v150, v151
    v_cvt_pk_f16_f32 v158, v152, v153
    v_cvt_pk_f16_f32 v159, v154, v155
    ds_write_b128 v161, v[156:159]
    v_add_u32 v214, 159744, v1
    v_mfma_f32_16x16x32_bf16 v[216:219], v[208:211], v[96:99], v[216:219]
    v_mov_b32 v128, 0xbc003c00
    v_mov_b32 v129, 0xbc003c00
    v_mov_b32 v130, 0xbc003c00
    v_mov_b32 v131, 0xbc003c00
    v_mfma_f32_16x16x32_bf16 v[216:219], v[208:211], v[100:103], v[216:219]
    v_mov_b32 v40, 0
    v_mov_b32 v41, 0
    v_mov_b32 v42, 0
    v_mov_b32 v43, 0
    v_mov_b32 v44, 0
    v_mfma_f32_16x16x32_bf16 v[216:219], v[208:211], v[104:107], v[216:219]
    v_mov_b32 v45, 0
    v_mov_b32 v46, 0
    v_mov_b32 v47, 0
    s_cmp_eq_u32 s31, 0
    s_cselect_b32 s40, 0xfefefefe, -1
    v_mfma_f32_16x16x32_bf16 v[216:219], v[208:211], v[108:111], v[216:219]
    s_mov_b32 s41, s40
    s_mov_b32 s42, 0x22222222
    s_mov_b32 s43, 0x22222222
    s_mov_b32 s44, 0x44444444
    s_mov_b32 s45, 0x44444444
    s_mov_b32 s46, 0x88888888
    s_mov_b32 s47, 0x88888888
    s_waitcnt vmcnt(9)
    ds_read_b128 v[168:171], v133 offset:0
    ds_read_b128 v[172:175], v133 offset:64
    ds_read_b128 v[176:179], v133 offset:128
    ds_read_b128 v[180:183], v133 offset:192
    ds_read_b128 v[184:187], v133 offset:256
    ds_read_b128 v[188:191], v133 offset:320
    ds_read_b128 v[192:195], v196 offset:768
    s_waitcnt lgkmcnt(7)
    s_barrier
    s_waitcnt lgkmcnt(6)
    v_mfma_f32_16x16x32_bf16 v[200:203], v[168:171], v[168:171], 0
    s_add_u32 m0, s60, 0
    s_mov_b32 s57, 0
    buffer_load_dwordx4 v248, s[16:19], s57 offen offset:0 lds
    v_mfma_f32_16x16x32_bf16 v[204:207], v[168:171], v[208:211], 0
    s_waitcnt lgkmcnt(5)
    ds_read_b128 v[136:139], v132 offset:0
    v_lshlrev_b32 v135, 4, v3
    v_mfma_f32_16x16x32_bf16 v[200:203], v[172:175], v[172:175], v[200:203]
    ds_read_b128 v[140:143], v132 offset:64
    v_add_u32 v135, 157696, v135
    v_mfma_f32_16x16x32_bf16 v[204:207], v[172:175], v[208:211], v[204:207]
    s_waitcnt lgkmcnt(6)
    ds_read_b128 v[144:147], v132 offset:128
    v_mfma_f32_16x16x32_bf16 v[200:203], v[176:179], v[176:179], v[200:203]
    ds_read_b128 v[148:151], v132 offset:192
    v_mfma_f32_16x16x32_bf16 v[204:207], v[176:179], v[208:211], v[204:207]
    s_waitcnt lgkmcnt(7)
    ds_read_b128 v[152:155], v132 offset:256
    v_mfma_f32_16x16x32_bf16 v[200:203], v[180:183], v[180:183], v[200:203]
    ds_read_b128 v[156:159], v132 offset:320
    v_mfma_f32_16x16x32_bf16 v[204:207], v[180:183], v[208:211], v[204:207]
    s_waitcnt lgkmcnt(8)
    s_mov_b32 s57, 13312
    buffer_load_dwordx4 v248, s[16:19], s57 offen offset:1024 lds
    v_mfma_f32_16x16x32_bf16 v[200:203], v[184:187], v[184:187], v[200:203]
    ds_read_b128 v[112:115], v214 offset:0
    v_mfma_f32_16x16x32_bf16 v[204:207], v[184:187], v[208:211], v[204:207]
    s_waitcnt lgkmcnt(8)
    ds_read_b128 v[160:163], v132 offset:384
    v_mfma_f32_16x16x32_bf16 v[200:203], v[188:191], v[188:191], v[200:203]
    ds_read_b128 v[116:119], v214 offset:1024
    v_mfma_f32_16x16x32_bf16 v[204:207], v[188:191], v[208:211], v[204:207]
    s_waitcnt lgkmcnt(9)
    ds_read_b128 v[164:167], v132 offset:448
    v_mfma_f32_16x16x32_bf16 v[200:203], v[192:195], v[192:195], v[200:203]
    ds_read_b128 v[120:123], v214 offset:2048
    v_mfma_f32_16x16x32_bf16 v[204:207], v[192:195], v[208:211], v[204:207]
    s_waitcnt lgkmcnt(10)
    ds_read_b128 v[124:127], v214 offset:3072
    v_mfma_f32_16x16x32_bf16 v[24:27], v[136:139], v[56:59], 0
    s_waitcnt lgkmcnt(10)
    ds_read_b128 v[136:139], v132 offset:512
    v_mfma_f32_16x16x32_bf16 v[24:27], v[140:143], v[60:63], v[24:27]
    s_waitcnt lgkmcnt(10)
    ds_read_b128 v[140:143], v132 offset:576
    v_mfma_f32_16x16x32_bf16 v[24:27], v[144:147], v[64:67], v[24:27]
    s_waitcnt lgkmcnt(10)
    ds_read_b128 v[144:147], v132 offset:640
    v_cndmask_b32 v200, v200, v201, s[42:43]
    v_mfma_f32_16x16x32_bf16 v[24:27], v[148:151], v[68:71], v[24:27]
    s_waitcnt lgkmcnt(10)
    ds_read_b128 v[148:151], v132 offset:704
    v_cndmask_b32 v204, v204, v205, s[42:43]
    v_mfma_f32_16x16x32_bf16 v[24:27], v[152:155], v[72:75], v[24:27]
    s_waitcnt lgkmcnt(10)
    s_mov_b32 s57, 1536
    buffer_load_dwordx4 v250, s[16:19], s57 offen offset:2048 lds
    v_mfma_f32_16x16x32_bf16 v[24:27], v[156:159], v[76:79], v[24:27]
    s_waitcnt lgkmcnt(8)
    ds_read_b128 v[152:155], v132 offset:768
    v_cndmask_b32 v200, v200, v202, s[44:45]
    v_mfma_f32_16x16x32_bf16 v[24:27], v[160:163], v[80:83], v[24:27]
    s_waitcnt lgkmcnt(7)
    ds_read_b128 v[156:159], v132 offset:832
    v_cndmask_b32 v204, v204, v206, s[44:45]
    v_mfma_f32_16x16x32_bf16 v[24:27], v[164:167], v[84:87], v[24:27]
    s_waitcnt lgkmcnt(5)
    ds_read_b128 v[160:163], v132 offset:14848
    v_cndmask_b32 v200, v200, v203, s[46:47]
    v_mfma_f32_16x16x32_bf16 v[24:27], v[136:139], v[88:91], v[24:27]
    s_waitcnt lgkmcnt(5)
    ds_read_b128 v[164:167], v132 offset:14912
    v_cndmask_b32 v204, v204, v207, s[46:47]
    v_mfma_f32_16x16x32_bf16 v[24:27], v[140:143], v[92:95], v[24:27]
    s_waitcnt lgkmcnt(5)
    ds_read_b128 v[136:139], v132 offset:14976
    v_permlane32_swap_b32 v204, v200
    v_mfma_f32_16x16x32_bf16 v[24:27], v[144:147], v[96:99], v[24:27]
    s_waitcnt lgkmcnt(5)
    ds_read_b128 v[140:143], v132 offset:15040
    v_add_f32_dpp v204, v200, v204 row_ror:8 row_mask:0xf bank_mask:0xf
    v_mfma_f32_16x16x32_bf16 v[24:27], v[148:151], v[100:103], v[24:27]
    s_waitcnt lgkmcnt(5)
    ds_read_b128 v[144:147], v132 offset:15104
    v_mul_f32 v204, 0x3b124925, v204
    v_mfma_f32_16x16x32_bf16 v[24:27], v[152:155], v[104:107], v[24:27]
    s_waitcnt lgkmcnt(5)
    ds_read_b128 v[148:151], v132 offset:15168
    s_mov_b32 s57, 1548800
    buffer_load_dwordx4 v249, s[16:19], s57 offen offset:3072 lds
    v_mov_b32 v200, v204
    v_mfma_f32_16x16x32_bf16 v[24:27], v[156:159], v[108:111], v[24:27]
    s_waitcnt lgkmcnt(5)
    ds_read_b128 v[152:155], v132 offset:15232
    v_permlane32_swap_b32 v204, v200
    v_mfma_f32_16x16x32_bf16 v[28:31], v[160:163], v[56:59], 0
    s_waitcnt lgkmcnt(5)
    ds_read_b128 v[156:159], v132 offset:15296
    v_fma_f32 v200, -v204, v204, v200
    v_mfma_f32_16x16x32_bf16 v[28:31], v[164:167], v[60:63], v[28:31]
    s_waitcnt lgkmcnt(5)
    ds_read_b128 v[160:163], v132 offset:15360
    v_max_f32 v200, 0, v200
    v_mfma_f32_16x16x32_bf16 v[28:31], v[136:139], v[64:67], v[28:31]
    s_waitcnt lgkmcnt(5)
    ds_read_b128 v[164:167], v132 offset:15424
    v_add_f32 v200, 0x3727c5ac, v200
    v_mfma_f32_16x16x32_bf16 v[28:31], v[140:143], v[68:71], v[28:31]
    s_waitcnt lgkmcnt(5)
    ds_read_b128 v[136:139], v132 offset:15488
    v_rsq_f32 v200, v200
    v_mfma_f32_16x16x32_bf16 v[28:31], v[144:147], v[72:75], v[28:31]
    s_waitcnt lgkmcnt(5)
    ds_read_b128 v[140:143], v132 offset:15552
    v_mul_f32 v201, v200, v204
    v_mfma_f32_16x16x32_bf16 v[28:31], v[148:151], v[76:79], v[28:31]
    ds_read_b128 v[144:147], v132 offset:15616
    s_mov_b64 exec, 0x00f0000f
    ds_write2st64_b32 v215, v200, v201 offset1:1
    ds_write_b32 v215, v204 offset:512
    s_mov_b64 exec, -1
    s_add_u32 m0, s60, 4096
    s_mov_b32 s57, 172032
    buffer_load_dwordx4 v248, s[16:19], s57 offen offset:0 lds
    s_waitcnt lgkmcnt(8)
    v_mfma_f32_16x16x32_bf16 v[28:31], v[152:155], v[80:83], v[28:31]
    s_waitcnt vmcnt(6) lgkmcnt(7)
    ds_read_b128 v[148:151], v132 offset:15680
    ds_read_b128 v[168:171], v133 offset:29696
    v_mfma_f32_16x16x32_bf16 v[28:31], v[156:159], v[84:87], v[28:31]
    s_waitcnt lgkmcnt(8)
    ds_read_b128 v[172:175], v133 offset:29760
    v_mfma_f32_16x16x32_bf16 v[28:31], v[160:163], v[88:91], v[28:31]
    s_waitcnt lgkmcnt(8)
    ds_read_b128 v[176:179], v133 offset:29824
    v_mfma_f32_16x16x32_bf16 v[28:31], v[164:167], v[92:95], v[28:31]
    s_waitcnt lgkmcnt(8)
    ds_read_b128 v[180:183], v133 offset:29888
    v_mfma_f32_16x16x32_bf16 v[28:31], v[136:139], v[96:99], v[28:31]
    s_waitcnt lgkmcnt(8)
    ds_read_b128 v[184:187], v133 offset:29952
    v_mfma_f32_16x16x32_bf16 v[28:31], v[140:143], v[100:103], v[28:31]
    s_waitcnt lgkmcnt(8)
    ds_read_b128 v[188:191], v133 offset:30016
    v_mfma_f32_16x16x32_bf16 v[28:31], v[144:147], v[104:107], v[28:31]
    s_waitcnt lgkmcnt(6)
    ds_read_b128 v[192:195], v196 offset:30464
    v_mfma_f32_16x16x32_bf16 v[28:31], v[148:151], v[108:111], v[28:31]
    s_mov_b32 s57, 185344
    buffer_load_dwordx4 v248, s[16:19], s57 offen offset:1024 lds
    s_barrier
    s_waitcnt lgkmcnt(6)
    v_mfma_f32_16x16x32_bf16 v[200:203], v[168:171], v[168:171], 0
    ds_read_b128 v[232:235], v135 offset:0
    v_mfma_f32_16x16x32_bf16 v[204:207], v[168:171], v[208:211], 0
    s_waitcnt lgkmcnt(6)
    ds_read_b128 v[236:239], v135 offset:256
    v_mfma_f32_16x16x32_bf16 v[200:203], v[172:175], v[172:175], v[200:203]
    ds_read_b128 v[240:243], v135 offset:64
    v_mfma_f32_16x16x32_bf16 v[204:207], v[172:175], v[208:211], v[204:207]
    s_waitcnt lgkmcnt(7)
    ds_read_b128 v[244:247], v135 offset:320
    v_mfma_f32_16x16x32_bf16 v[200:203], v[176:179], v[176:179], v[200:203]
    s_mov_b32 s57, 1392128
    buffer_load_dwordx4 v249, s[16:19], s57 offen offset:2048 lds
    v_mfma_f32_16x16x32_bf16 v[204:207], v[176:179], v[208:211], v[204:207]
    s_waitcnt lgkmcnt(3)
    ds_read_b128 v[152:155], v132 offset:29696
    v_mul_f32 v24, v24, v232
    v_mfma_f32_16x16x32_bf16 v[200:203], v[180:183], v[180:183], v[200:203]
    ds_read_b128 v[156:159], v132 offset:29760
    v_mul_f32 v25, v25, v233
    v_mfma_f32_16x16x32_bf16 v[204:207], v[180:183], v[208:211], v[204:207]
    ds_read_b128 v[160:163], v132 offset:29824
    v_mul_f32 v26, v26, v234
    v_mfma_f32_16x16x32_bf16 v[200:203], v[184:187], v[184:187], v[200:203]
    ds_read_b128 v[164:167], v132 offset:29888
    v_mul_f32 v27, v27, v235
    v_mfma_f32_16x16x32_bf16 v[204:207], v[184:187], v[208:211], v[204:207]
    s_waitcnt lgkmcnt(6)
    ds_read_b128 v[136:139], v132 offset:29952
    v_fma_f32 v24, -v236, v216, v24
    v_mfma_f32_16x16x32_bf16 v[200:203], v[188:191], v[188:191], v[200:203]
    ds_read_b128 v[140:143], v132 offset:30016
    v_fma_f32 v25, -v237, v216, v25
    v_mfma_f32_16x16x32_bf16 v[204:207], v[188:191], v[208:211], v[204:207]
    ds_read_b128 v[144:147], v132 offset:30080
    v_fma_f32 v26, -v238, v216, v26
    v_mfma_f32_16x16x32_bf16 v[200:203], v[192:195], v[192:195], v[200:203]
    ds_read_b128 v[148:151], v132 offset:30144
    v_fma_f32 v27, -v239, v216, v27
    v_mfma_f32_16x16x32_bf16 v[204:207], v[192:195], v[208:211], v[204:207]
    s_waitcnt lgkmcnt(7)
    s_mov_b32 s57, 1376768
    buffer_load_dwordx4 v249, s[16:19], s57 offen offset:3072 lds
    v_mfma_f32_16x16x32_bf16 v[32:35], v[152:155], v[56:59], 0
    s_waitcnt lgkmcnt(6)
    ds_read_b128 v[152:155], v132 offset:30208
    v_mul_f32 v28, v28, v240
    v_mfma_f32_16x16x32_bf16 v[32:35], v[156:159], v[60:63], v[32:35]
    s_waitcnt lgkmcnt(6)
    ds_read_b128 v[156:159], v132 offset:30272
    v_cndmask_b32 v200, v200, v201, s[42:43]
    v_mfma_f32_16x16x32_bf16 v[32:35], v[160:163], v[64:67], v[32:35]
    s_waitcnt lgkmcnt(6)
    ds_read_b128 v[160:163], v132 offset:30336
    v_cndmask_b32 v204, v204, v205, s[42:43]
    v_mfma_f32_16x16x32_bf16 v[32:35], v[164:167], v[68:71], v[32:35]
    s_waitcnt lgkmcnt(6)
    ds_read_b128 v[164:167], v132 offset:30400
    v_cndmask_b32 v200, v200, v202, s[44:45]
    v_mfma_f32_16x16x32_bf16 v[32:35], v[136:139], v[72:75], v[32:35]
    s_waitcnt lgkmcnt(6)
    ds_read_b128 v[136:139], v132 offset:30464
    v_cndmask_b32 v204, v204, v206, s[44:45]
    v_mfma_f32_16x16x32_bf16 v[32:35], v[140:143], v[76:79], v[32:35]
    s_waitcnt lgkmcnt(6)
    ds_read_b128 v[140:143], v132 offset:30528
    v_cndmask_b32 v200, v200, v203, s[46:47]
    v_mfma_f32_16x16x32_bf16 v[32:35], v[144:147], v[80:83], v[32:35]
    s_waitcnt lgkmcnt(6)
    ds_read_b128 v[144:147], v132 offset:44544
    v_cndmask_b32 v204, v204, v207, s[46:47]
    v_mfma_f32_16x16x32_bf16 v[32:35], v[148:151], v[84:87], v[32:35]
    s_waitcnt lgkmcnt(6)
    s_add_u32 m0, s60, 8192
    s_mov_b32 s57, 344064
    buffer_load_dwordx4 v248, s[16:19], s57 offen offset:0 lds
    v_mfma_f32_16x16x32_bf16 v[32:35], v[152:155], v[88:91], v[32:35]
    s_waitcnt lgkmcnt(5)
    ds_read_b128 v[148:151], v132 offset:44608
    v_permlane32_swap_b32 v204, v200
    v_mfma_f32_16x16x32_bf16 v[32:35], v[156:159], v[92:95], v[32:35]
    s_waitcnt lgkmcnt(5)
    ds_read_b128 v[152:155], v132 offset:44672
    v_add_f32_dpp v204, v200, v204 row_ror:8 row_mask:0xf bank_mask:0xf
    v_mfma_f32_16x16x32_bf16 v[32:35], v[160:163], v[96:99], v[32:35]
    s_waitcnt lgkmcnt(5)
    ds_read_b128 v[156:159], v132 offset:44736
    v_mul_f32 v204, 0x3b124925, v204
    v_mfma_f32_16x16x32_bf16 v[32:35], v[164:167], v[100:103], v[32:35]
    s_waitcnt lgkmcnt(5)
    ds_read_b128 v[160:163], v132 offset:44800
    v_mov_b32 v200, v204
    v_mfma_f32_16x16x32_bf16 v[32:35], v[136:139], v[104:107], v[32:35]
    s_waitcnt lgkmcnt(5)
    ds_read_b128 v[164:167], v132 offset:44864
    v_permlane32_swap_b32 v204, v200
    v_mfma_f32_16x16x32_bf16 v[32:35], v[140:143], v[108:111], v[32:35]
    s_waitcnt lgkmcnt(5)
    ds_read_b128 v[136:139], v132 offset:44928
    v_fma_f32 v200, -v204, v204, v200
    v_mfma_f32_16x16x32_bf16 v[36:39], v[144:147], v[56:59], 0
    s_waitcnt lgkmcnt(5)
    ds_read_b128 v[140:143], v132 offset:44992
    v_max_f32 v200, 0, v200
    v_mfma_f32_16x16x32_bf16 v[36:39], v[148:151], v[60:63], v[36:39]
    s_waitcnt lgkmcnt(5)
    ds_read_b128 v[144:147], v132 offset:45056
    s_mov_b32 s57, 357376
    buffer_load_dwordx4 v248, s[16:19], s57 offen offset:1024 lds
    v_add_f32 v200, 0x3727c5ac, v200
    v_mfma_f32_16x16x32_bf16 v[36:39], v[152:155], v[64:67], v[36:39]
    s_waitcnt lgkmcnt(5)
    ds_read_b128 v[148:151], v132 offset:45120
    v_rsq_f32 v200, v200
    v_mfma_f32_16x16x32_bf16 v[36:39], v[156:159], v[68:71], v[36:39]
    s_waitcnt lgkmcnt(5)
    ds_read_b128 v[152:155], v132 offset:45184
    v_mul_f32 v201, v200, v204
    v_mfma_f32_16x16x32_bf16 v[36:39], v[160:163], v[72:75], v[36:39]
    s_waitcnt lgkmcnt(5)
    ds_read_b128 v[156:159], v132 offset:45248
    v_add_u32 v215, 128, v215
    v_mfma_f32_16x16x32_bf16 v[36:39], v[164:167], v[76:79], v[36:39]
    s_waitcnt lgkmcnt(5)
    ds_read_b128 v[160:163], v132 offset:45312
    s_mov_b64 exec, 0x00f0000f
    ds_write2st64_b32 v215, v200, v201 offset1:1
    ds_write_b32 v215, v204 offset:512
    s_mov_b64 exec, -1
    v_mfma_f32_16x16x32_bf16 v[36:39], v[136:139], v[80:83], v[36:39]
    s_waitcnt lgkmcnt(7)
    ds_read_b128 v[164:167], v132 offset:45376
    v_mul_f32 v29, v29, v241
    v_mfma_f32_16x16x32_bf16 v[36:39], v[140:143], v[84:87], v[36:39]
    s_waitcnt lgkmcnt(7)
    v_lshlrev_b32 v22, 8, s26
    buffer_load_dword v21, v22, s[92:95], 0 offen sc1
    v_mfma_f32_16x16x32_bf16 v[36:39], v[144:147], v[88:91], v[36:39]
    s_waitcnt lgkmcnt(1)
    s_barrier
    ds_read_b128 v[168:171], v135 offset:128
    v_mfma_f32_16x16x32_bf16 v[36:39], v[148:151], v[92:95], v[36:39]
    ds_read_b128 v[172:175], v135 offset:384
    v_mul_f32 v30, v30, v242
    v_mfma_f32_16x16x32_bf16 v[36:39], v[152:155], v[96:99], v[36:39]
    ds_read_b128 v[176:179], v135 offset:192
    v_mul_f32 v31, v31, v243
    v_mfma_f32_16x16x32_bf16 v[36:39], v[156:159], v[100:103], v[36:39]
    ds_read_b128 v[180:183], v135 offset:448
    v_fma_f32 v28, -v244, v216, v28
    v_mfma_f32_16x16x32_bf16 v[36:39], v[160:163], v[104:107], v[36:39]
    s_waitcnt lgkmcnt(4)
    v_fma_f32 v29, -v245, v216, v29
    v_fma_f32 v30, -v246, v216, v30
    v_mfma_f32_16x16x32_bf16 v[36:39], v[164:167], v[108:111], v[36:39]
    v_fma_f32 v31, -v247, v216, v31
    v_mul_f32 v240, s38, v24
    v_mul_f32 v241, s38, v25
    v_mul_f32 v242, s38, v26
    v_mul_f32 v243, s38, v27
    v_mul_f32 v244, s38, v28
    v_mul_f32 v245, s38, v29
    v_mul_f32 v246, s38, v30
    v_mul_f32 v247, s38, v31
    s_waitcnt lgkmcnt(3)
    v_pk_mul_f32 v[32:33], v[32:33], v[168:169]
    v_pk_mul_f32 v[34:35], v[34:35], v[170:171]
    s_waitcnt lgkmcnt(2)
    v_pk_fma_f32 v[32:33], v[172:173], v[216:217], v[32:33] neg_lo:[1,0,0] neg_hi:[1,0,0]
    v_pk_fma_f32 v[34:35], v[174:175], v[216:217], v[34:35] neg_lo:[1,0,0] neg_hi:[1,0,0]
    v_pk_fma_f32 v[232:233], v[32:33], v[212:213], v[24:25] op_sel_hi:[1,0,1]
    s_mov_b32 s57, 1220096
    buffer_load_dwordx4 v249, s[16:19], s57 offen offset:2048 lds
    v_pk_fma_f32 v[240:241], v[32:33], v[212:213], v[240:241] op_sel:[0,1,0] op_sel_hi:[1,1,1]
    v_pk_fma_f32 v[234:235], v[34:35], v[212:213], v[26:27] op_sel_hi:[1,0,1]
    v_pk_fma_f32 v[242:243], v[34:35], v[212:213], v[242:243] op_sel:[0,1,0] op_sel_hi:[1,1,1]
    s_waitcnt lgkmcnt(1)
    v_pk_mul_f32 v[36:37], v[36:37], v[176:177]
    v_pk_mul_f32 v[38:39], v[38:39], v[178:179]
    s_waitcnt lgkmcnt(0)
    v_pk_fma_f32 v[36:37], v[180:181], v[216:217], v[36:37] neg_lo:[1,0,0] neg_hi:[1,0,0]
    v_pk_fma_f32 v[38:39], v[182:183], v[216:217], v[38:39] neg_lo:[1,0,0] neg_hi:[1,0,0]
    v_pk_fma_f32 v[236:237], v[36:37], v[212:213], v[28:29] op_sel_hi:[1,0,1]
    v_pk_fma_f32 v[244:245], v[36:37], v[212:213], v[244:245] op_sel:[0,1,0] op_sel_hi:[1,1,1]
    v_pk_fma_f32 v[238:239], v[38:39], v[212:213], v[30:31] op_sel_hi:[1,0,1]
    v_pk_fma_f32 v[246:247], v[38:39], v[212:213], v[246:247] op_sel:[0,1,0] op_sel_hi:[1,1,1]
    v_cvt_pk_f16_f32 v48, v232, v233
    v_cvt_pk_f16_f32 v49, v234, v235
    v_cvt_pk_f16_f32 v50, v236, v237
    v_cvt_pk_f16_f32 v51, v238, v239
    v_cvt_pk_f16_f32 v52, v240, v241
    s_mov_b32 s57, 1204736
    buffer_load_dwordx4 v249, s[16:19], s57 offen offset:3072 lds
    v_cvt_pk_f16_f32 v53, v242, v243
    v_cvt_pk_f16_f32 v54, v244, v245
    v_cvt_pk_f16_f32 v55, v246, v247
    s_mov_b64 exec, s[40:41]
    v_xor_b32 v40, 0x80008000, v48
    v_xor_b32 v41, 0x80008000, v49
    v_xor_b32 v42, 0x80008000, v50
    v_xor_b32 v43, 0x80008000, v51
    v_xor_b32 v44, 0x80008000, v52
    v_xor_b32 v45, 0x80008000, v53
    v_xor_b32 v46, 0x80008000, v54
    v_xor_b32 v47, 0x80008000, v55
    v_mov_b32_dpp v40, v48 row_ror:8 row_mask:0xf bank_mask:0x3
    v_mov_b32_dpp v41, v49 row_ror:8 row_mask:0xf bank_mask:0x3
    v_mov_b32_dpp v42, v50 row_ror:8 row_mask:0xf bank_mask:0x3
    v_mov_b32_dpp v43, v51 row_ror:8 row_mask:0xf bank_mask:0x3
    v_mov_b32_dpp v44, v52 row_ror:8 row_mask:0xf bank_mask:0x3
    v_mov_b32_dpp v45, v53 row_ror:8 row_mask:0xf bank_mask:0x3
    v_mov_b32_dpp v46, v54 row_ror:8 row_mask:0xf bank_mask:0x3
    v_mov_b32_dpp v47, v55 row_ror:8 row_mask:0xf bank_mask:0x3
    v_mov_b32_dpp v48, v48 row_ror:8 row_mask:0xf bank_mask:0xc
    v_mov_b32_dpp v49, v49 row_ror:8 row_mask:0xf bank_mask:0xc
    v_mov_b32_dpp v50, v50 row_ror:8 row_mask:0xf bank_mask:0xc
    v_mov_b32_dpp v51, v51 row_ror:8 row_mask:0xf bank_mask:0xc
    v_mov_b32_dpp v52, v52 row_ror:8 row_mask:0xf bank_mask:0xc
    v_mov_b32_dpp v53, v53 row_ror:8 row_mask:0xf bank_mask:0xc
    v_mov_b32_dpp v54, v54 row_ror:8 row_mask:0xf bank_mask:0xc
    v_mov_b32_dpp v55, v55 row_ror:8 row_mask:0xf bank_mask:0xc
    s_mov_b64 exec, -1
    s_add_u32 m0, s60, 12288
    s_mov_b32 s57, 516096
    buffer_load_dwordx4 v248, s[16:19], s57 offen offset:0 lds
    v_mfma_f32_16x16x32_f16 v[24:27], v[40:43], v[116:119], 0
    v_mfma_f32_16x16x32_f16 v[28:31], v[44:47], v[124:127], 0
    s_mov_b32 s57, 529408
    buffer_load_dwordx4 v248, s[16:19], s57 offen offset:1024 lds
    v_mfma_f32_16x16x32_f16 v[24:27], v[48:51], v[112:115], v[24:27]
    v_mfma_f32_16x16x32_f16 v[28:31], v[52:55], v[120:123], v[28:31]
    v_mfma_f32_16x16x32_f16 v[32:35], v[48:51], v[128:131], 0
    v_mfma_f32_16x16x32_f16 v[36:39], v[44:47], v[128:131], 0
    s_mov_b32 s32, 1867776
    s_mov_b32 s33, 2785280
    s_nop 2
    v_cvt_pk_f16_f32 v184, v24, v25
    v_cvt_pk_f16_f32 v185, v26, v27
    v_cvt_pk_f16_f32 v186, v28, v29
    v_cvt_pk_f16_f32 v187, v30, v31
    buffer_store_dwordx4 v[184:187], v134, s[8:11], s32 offen sc1
    v_cvt_pk_f16_f32 v188, v32, v33
    v_cvt_pk_f16_f32 v189, v34, v35
    v_cvt_pk_f16_f32 v190, v36, v37
    v_cvt_pk_f16_f32 v191, v38, v39
    s_mov_b32 exec_lo, 0x00010001
    s_mov_b32 exec_hi, 0x00010001
    buffer_store_dwordx4 v[188:191], v134, s[8:11], s33 offen sc1
    s_mov_b64 exec, -1
    s_mov_b32 s57, 1048064
    buffer_load_dwordx4 v249, s[16:19], s57 offen offset:2048 lds
    s_and_b32 s32, s26, 1
    v_lshl_add_u32 v220, s32, 3, v3
    v_add_u32 v221, 32, v220
    v_add_u32 v222, 4, v220
    v_add_u32 v223, 36, v220
    v_cmp_eq_u32 s[36:37], 0, v220
    s_bitcmp1_b32 s26, 1
    s_cselect_b32 s33, s28, s27
    v_lshl_add_u32 v22, v2, 6, s33
    v_cndmask_b32 v221, v221, 16, s[36:37]
    v_cvt_f32_u32 v22, v22
    v_mul_f32 v22, 0x3a000000, v22
    s_mov_b32 s32, 0xbc003c00
    s_mov_b32 s57, 1032704
    buffer_load_dwordx4 v249, s[16:19], s57 offen offset:3072 lds
    s_cmp_lt_u32 s33, 16
    s_cselect_b32 s32, 0x3c003c00, s32
    v_mov_b32 v23, s32
    v_cvt_f32_u32 v220, v220
    v_cvt_f32_u32 v221, v221
    v_cvt_f32_u32 v222, v222
    v_cvt_f32_u32 v223, v223
    v_mul_f32 v224, v22, v220
    v_mul_f32 v226, v22, v221
    v_mul_f32 v228, v22, v222
    v_mul_f32 v230, v22, v223
    v_sin_f32 v225, -v224
    s_add_u32 m0, s60, 16384
    s_mov_b32 s57, 57344
    buffer_load_dwordx4 v248, s[16:19], s57 offen offset:0 lds
    v_cos_f32 v224, v224
    v_sin_f32 v227, -v226
    v_cos_f32 v226, v226
    v_sin_f32 v229, -v228
    v_cos_f32 v228, v228
    v_sin_f32 v231, -v230
    v_cos_f32 v230, v230
    s_mov_b32 s57, 70656
    buffer_load_dwordx4 v248, s[16:19], s57 offen offset:1024 lds
    s_lshl_b32 s32, s26, 10
    s_add_u32 s32, s32, 159744
    v_cvt_pk_f16_f32 v220, v224, v225
    v_cvt_pk_f16_f32 v221, v226, v227
    v_cvt_pk_f16_f32 v222, v228, v229
    v_cvt_pk_f16_f32 v223, v230, v231
    v_add_u32 v224, s32, v1
    v_cndmask_b32 v220, v220, v23, s[36:37]
    ds_write_b128 v224, v[220:223]
    s_getpc_b64 s[36:37]
L_pf_2:
    s_lshr_b32 s34, s2, 3
    s_lshl_b32 s34, s34, 10
    v_lshrrev_b32 v22, 3, v0
    v_lshl_add_u32 v22, v22, 7, s34
    v_min_u32 v22, L_code_end - L_pf_2 - 64, v22
    global_load_dword v13, v22, s[36:37]
    s_mov_b32 s57, 1506816
    buffer_load_dwordx4 v249, s[16:19], s57 offen offset:2048 lds
    v_lshlrev_b32 v22, 2, v2
    v_add_u32 v22, 158208, v22
    ds_read_b32 v228, v22 offset:0
    ds_read_b32 v229, v22 offset:64
    ds_read_b32 v230, v22 offset:128
    ds_read_b32 v231, v22 offset:192
    s_mul_i32 s34, s26, 96
    v_cmp_gt_u32 vcc, 2, v3
    v_and_b32 v22, 1, v3
    s_mov_b32 s57, 1491456
    buffer_load_dwordx4 v249, s[16:19], s57 offen offset:3072 lds
    v_lshl_add_u32 v22, v22, 4, s34
    v_sub_u32 v23, 880, v22
    v_cndmask_b32 v226, v23, v22, vcc
    v_cndmask_b32 v227, v22, v23, vcc
    v_mul_u32_u24 v22, 928, v2
    v_add_u32 v226, v226, v22
    v_add_u32 v227, v227, v22
    v_mov_b32 v22, 0x01000c0c
    v_mov_b32 v23, 0x05040c0c
    v_cndmask_b32 v222, v23, v22, vcc
    v_cndmask_b32 v224, v22, v23, vcc
    v_add_u32 v223, 0x02020000, v222
    v_add_u32 v225, 0x02020000, v224
    s_waitcnt vmcnt(20)
    ds_read_b64_tr_b16 a[0:1], v252 offset:0
    ds_read_b64_tr_b16 a[2:3], v252 offset:1024
    ds_read_b64_tr_b16 a[4:5], v253 offset:0
    ds_read_b64_tr_b16 a[6:7], v253 offset:1024
    v_mov_b32 v22, -32
    v_cndmask_b32 v200, v22, 32, vcc
    s_cmp_eq_u32 s26, 0
    s_cselect_b32 s34, 0xffff, 0
    s_mov_b32 s35, 0
    s_mov_b32 vcc_lo, 0
    s_mov_b32 vcc_hi, s34
    v_subrev_u32 v22, 448, v226
    v_subrev_u32 v23, 448, v227
    v_cndmask_b32 v201, v226, v22, vcc
    v_cndmask_b32 v202, v227, v23, s[34:35]
    ds_read_b128 v[136:139], v226 offset:0
    ds_read_b32 v140, v201 offset:16
    s_add_u32 m0, s60, 20480
    s_mov_b32 s57, 229376
    buffer_load_dwordx4 v248, s[16:19], s57 offen offset:0 lds
    ds_read_b128 v[142:145], v226 offset:14848
    ds_read_b32 v146, v201 offset:14864
    ds_read_b128 v[148:151], v227 offset:29696
    ds_read_b32 v152, v202 offset:29712
    ds_read_b128 v[154:157], v227 offset:44544
    ds_read_b32 v158, v202 offset:44560
    v_add_u32 v226, v226, v200
    v_sub_u32 v227, v227, v200
    ds_read_b128 v[160:163], v226 offset:0
    ds_read_b32 v164, v226 offset:16
    s_waitcnt lgkmcnt(9)
    v_perm_b32 v25, v139, v136, v223
    v_perm_b32 v26, v139, v137, v222
    v_perm_b32 v27, v138, v137, v223
    s_mov_b32 s57, 242688
    buffer_load_dwordx4 v248, s[16:19], s57 offen offset:1024 lds
    v_perm_b32 v40, v138, v138, v222
    v_perm_b32 v41, v137, v138, v223
    v_perm_b32 v42, v137, v139, v222
    v_perm_b32 v43, v136, v139, v223
    s_waitcnt lgkmcnt(8)
    v_perm_b32 v24, v140, v136, v222
    v_mov_b32 v192, v24
    s_waitcnt lgkmcnt(7)
    v_perm_b32 v29, v145, v142, v223
    v_perm_b32 v30, v145, v143, v222
    v_perm_b32 v31, v144, v143, v223
    v_perm_b32 v44, v144, v144, v222
    v_perm_b32 v45, v143, v144, v223
    v_perm_b32 v46, v143, v145, v222
    v_perm_b32 v47, v142, v145, v223
    s_waitcnt vmcnt(9)
    s_barrier
    s_cmp_lg_u32 s26, 0
    s_cbranch_scc1 L_w0_3
    v_cmp_gt_u32 vcc, 16, v21
    s_cbranch_vccz L_ok_4
L_sp_5:
    buffer_load_dword v21, off, s[92:95], 0 sc1
    s_waitcnt vmcnt(0)
    v_cmp_gt_u32 vcc, 16, v21
    s_sub_i32 s39, s39, 1
    s_max_i32 s39, s39, 0
    s_cbranch_scc0 L_ok_4
    s_cbranch_vccnz L_sp_5
L_ok_4:
    s_lshr_b32 s34, s2, 3
    s_lshl_b32 s34, s34, 7
    s_add_u32 s34, s34, 65536
    v_lshl_add_u32 v22, v0, 12, s34
    v_mov_b32 v20, 1
    s_mov_b64 exec, 0xff
    buffer_atomic_add v20, v22, s[8:11], 0 offen sc1
    s_mov_b64 exec, -1
L_w0_3:
    ds_read_b64_tr_b16 a[8:9], v254 offset:0
    ds_read_b64_tr_b16 a[10:11], v254 offset:1024
    ds_read_b64_tr_b16 a[12:13], v255 offset:0
    ds_read_b64_tr_b16 a[14:15], v255 offset:1024
    s_waitcnt lgkmcnt(10)
    v_perm_b32 v28, v146, v142, v222
    v_mov_b32 v193, v28
    ds_read_b128 v[136:139], v226 offset:14848
    ds_read_b32 v140, v226 offset:14864
    ds_read_b128 v[142:145], v227 offset:29696
    s_mov_b32 s57, 1334784
    buffer_load_dwordx4 v249, s[16:19], s57 offen offset:2048 lds
    ds_read_b32 v146, v227 offset:29712
    s_waitcnt lgkmcnt(13)
    v_perm_b32 v33, v151, v148, v225
    v_perm_b32 v34, v151, v149, v224
    v_perm_b32 v35, v150, v149, v225
    s_mov_b32 s57, 1319424
    buffer_load_dwordx4 v249, s[16:19], s57 offen offset:3072 lds
    v_perm_b32 v48, v150, v150, v224
    v_perm_b32 v49, v149, v150, v225
    v_perm_b32 v50, v149, v151, v224
    v_perm_b32 v51, v148, v151, v225
    s_waitcnt lgkmcnt(12)
    v_perm_b32 v32, v152, v148, v224
    ds_read_b64_tr_b16 a[48:49], v252 offset:4096
    ds_read_b64_tr_b16 a[50:51], v252 offset:5120
    ds_read_b64_tr_b16 a[52:53], v253 offset:4096
    ds_read_b64_tr_b16 a[54:55], v253 offset:5120
    v_mov_b32 v194, v32
    s_waitcnt lgkmcnt(14)
    v_perm_b32 v37, v157, v154, v225
    v_perm_b32 v38, v157, v155, v224
    v_perm_b32 v39, v156, v155, v225
    s_waitcnt lgkmcnt(8)
    s_add_u32 m0, s60, 0
    s_mov_b32 s57, 401408
    buffer_load_dwordx4 v248, s[16:19], s57 offen offset:0 lds
    v_perm_b32 v52, v156, v156, v224
    v_perm_b32 v53, v155, v156, v225
    v_perm_b32 v54, v155, v157, v224
    v_perm_b32 v55, v154, v157, v225
    v_perm_b32 v36, v158, v154, v224
    s_mov_b32 s57, 414720
    buffer_load_dwordx4 v248, s[16:19], s57 offen offset:1024 lds
    v_mov_b32 v195, v36
    ds_read_b128 v[148:151], v227 offset:44544
    ds_read_b32 v152, v227 offset:44560
    v_add_u32 v226, v226, v200
    ds_read_b64_tr_b16 a[56:57], v254 offset:4096
    ds_read_b64_tr_b16 a[58:59], v254 offset:5120
    ds_read_b64_tr_b16 a[60:61], v255 offset:4096
    ds_read_b64_tr_b16 a[62:63], v255 offset:5120
    v_sub_u32 v227, v227, v200
    ds_read_b128 v[154:157], v226 offset:0
    ds_read_b32 v158, v226 offset:16
    v_perm_b32 v57, v163, v160, v223
    v_perm_b32 v58, v163, v161, v222
    s_mov_b32 s57, 1162752
    buffer_load_dwordx4 v249, s[16:19], s57 offen offset:2048 lds
    v_perm_b32 v59, v162, v161, v223
    v_perm_b32 v72, v162, v162, v222
    v_perm_b32 v73, v161, v162, v223
    v_perm_b32 v74, v161, v163, v222
    s_mov_b32 s57, 1147392
    buffer_load_dwordx4 v249, s[16:19], s57 offen offset:3072 lds
    v_perm_b32 v75, v160, v163, v223
    v_perm_b32 v56, v164, v160, v222
    s_waitcnt lgkmcnt(14)
    v_perm_b32 v61, v139, v136, v223
    v_perm_b32 v62, v139, v137, v222
    v_perm_b32 v63, v138, v137, v223
    ds_read_b64_tr_b16 a[96:97], v252 offset:8192
    ds_read_b64_tr_b16 a[98:99], v252 offset:9216
    ds_read_b64_tr_b16 a[100:101], v253 offset:8192
    ds_read_b64_tr_b16 a[102:103], v253 offset:9216
    v_perm_b32 v76, v138, v138, v222
    v_perm_b32 v77, v137, v138, v223
    v_perm_b32 v78, v137, v139, v222
    v_perm_b32 v79, v136, v139, v223
    s_waitcnt lgkmcnt(6)
    s_add_u32 m0, s60, 4096
    s_mov_b32 s57, 573440
    buffer_load_dwordx4 v248, s[16:19], s57 offen offset:0 lds
    v_perm_b32 v60, v140, v136, v222
    ds_read_b128 v[160:163], v226 offset:14848
    ds_read_b32 v164, v226 offset:14864
    ds_read_b128 v[136:139], v227 offset:29696
    ds_read_b32 v140, v227 offset:29712
    s_mov_b32 s57, 586752
    buffer_load_dwordx4 v248, s[16:19], s57 offen offset:1024 lds
    v_perm_b32 v65, v145, v142, v225
    v_perm_b32 v66, v145, v143, v224
    v_perm_b32 v67, v144, v143, v225
    v_perm_b32 v80, v144, v144, v224
    ds_read_b64_tr_b16 a[104:105], v254 offset:8192
    ds_read_b64_tr_b16 a[106:107], v254 offset:9216
    ds_read_b64_tr_b16 a[108:109], v255 offset:8192
    ds_read_b64_tr_b16 a[110:111], v255 offset:9216
    v_perm_b32 v81, v143, v144, v225
    v_perm_b32 v82, v143, v145, v224
    v_perm_b32 v83, v142, v145, v225
    v_perm_b32 v64, v146, v142, v224
    v_perm_b32 v69, v151, v148, v225
    s_mov_b32 s57, 990720
    buffer_load_dwordx4 v249, s[16:19], s57 offen offset:2048 lds
    v_perm_b32 v70, v151, v149, v224
    v_perm_b32 v71, v150, v149, v225
    v_perm_b32 v84, v150, v150, v224
    v_perm_b32 v85, v149, v150, v225
    s_mov_b32 s57, 975360
    buffer_load_dwordx4 v249, s[16:19], s57 offen offset:3072 lds
    v_perm_b32 v86, v149, v151, v224
    v_perm_b32 v87, v148, v151, v225
    v_perm_b32 v68, v152, v148, v224
    ds_read_b128 v[142:145], v227 offset:44544
    ds_read_b32 v146, v227 offset:44560
    s_waitcnt vmcnt(17)
    ds_read_b64_tr_b16 a[144:145], v252 offset:12288
    ds_read_b64_tr_b16 a[146:147], v252 offset:13312
    ds_read_b64_tr_b16 a[148:149], v253 offset:12288
    ds_read_b64_tr_b16 a[150:151], v253 offset:13312
    s_lshr_b32 s34, s26, 1
    s_lshl_b32 s34, s34, 5
    s_and_b32 s35, s26, 1
    s_lshl3_add_u32 s34, s35, s34
    s_waitcnt lgkmcnt(6)
    s_add_u32 m0, s60, 8192
    s_mov_b32 s57, 114688
    buffer_load_dwordx4 v248, s[16:19], s57 offen offset:0 lds
    s_add_u32 s34, s34, 384
    v_cmp_gt_u32 vcc, 2, v3
    v_and_b32 v22, 1, v3
    v_lshl_add_u32 v22, v22, 4, s34
    v_sub_u32 v23, 888, v22
    s_mov_b32 s57, 128000
    buffer_load_dwordx4 v248, s[16:19], s57 offen offset:1024 lds
    v_cndmask_b32 v226, v23, v22, vcc
    v_cndmask_b32 v227, v22, v23, vcc
    v_mul_u32_u24 v22, 928, v2
    v_add_u32 v226, v226, v22
    ds_read_b64_tr_b16 a[152:153], v254 offset:12288
    ds_read_b64_tr_b16 a[154:155], v254 offset:13312
    ds_read_b64_tr_b16 a[156:157], v255 offset:12288
    ds_read_b64_tr_b16 a[158:159], v255 offset:13312
    v_add_u32 v227, v227, v22
    ds_read_b64 v[148:149], v226 offset:0
    ds_read_b32 v152, v226 offset:8
    v_perm_b32 v89, v157, v154, v223
    v_perm_b32 v90, v157, v155, v222
    s_mov_b32 s57, 1449472
    buffer_load_dwordx4 v249, s[16:19], s57 offen offset:2048 lds
    v_perm_b32 v91, v156, v155, v223
    v_perm_b32 v104, v156, v156, v222
    v_perm_b32 v105, v155, v156, v223
    v_perm_b32 v106, v155, v157, v222
    s_mov_b32 s57, 1434112
    buffer_load_dwordx4 v249, s[16:19], s57 offen offset:3072 lds
    v_perm_b32 v107, v154, v157, v223
    v_perm_b32 v88, v158, v154, v222
    v_perm_b32 v93, v163, v160, v223
    v_perm_b32 v94, v163, v161, v222
    v_perm_b32 v95, v162, v161, v223
    s_waitcnt vmcnt(16)
    ds_read_b64_tr_b16 a[16:17], v252 offset:16384
    ds_read_b64_tr_b16 a[18:19], v252 offset:17408
    ds_read_b64_tr_b16 a[20:21], v253 offset:16384
    ds_read_b64_tr_b16 a[22:23], v253 offset:17408
    v_perm_b32 v108, v162, v162, v222
    v_perm_b32 v109, v161, v162, v223
    v_perm_b32 v110, v161, v163, v222
    v_perm_b32 v111, v160, v163, v223
    s_waitcnt lgkmcnt(6)
    s_add_u32 m0, s60, 12288
    s_mov_b32 s57, 286720
    buffer_load_dwordx4 v248, s[16:19], s57 offen offset:0 lds
    v_perm_b32 v92, v164, v160, v222
    ds_read_b64 v[154:155], v226 offset:14848
    ds_read_b32 v158, v226 offset:14856
    ds_read_b64 v[160:161], v227 offset:29696
    ds_read_b32 v164, v227 offset:29704
    s_mov_b32 s57, 300032
    buffer_load_dwordx4 v248, s[16:19], s57 offen offset:1024 lds
    v_perm_b32 v97, v139, v136, v225
    v_perm_b32 v98, v139, v137, v224
    v_perm_b32 v99, v138, v137, v225
    v_perm_b32 v112, v138, v138, v224
    ds_read_b64_tr_b16 a[24:25], v254 offset:16384
    ds_read_b64_tr_b16 a[26:27], v254 offset:17408
    ds_read_b64_tr_b16 a[28:29], v255 offset:16384
    ds_read_b64_tr_b16 a[30:31], v255 offset:17408
    v_perm_b32 v113, v137, v138, v225
    v_perm_b32 v114, v137, v139, v224
    v_perm_b32 v115, v136, v139, v225
    v_perm_b32 v96, v140, v136, v224
    v_perm_b32 v101, v145, v142, v225
    s_mov_b32 s57, 1277440
    buffer_load_dwordx4 v249, s[16:19], s57 offen offset:2048 lds
    v_perm_b32 v102, v145, v143, v224
    v_perm_b32 v103, v144, v143, v225
    v_perm_b32 v116, v144, v144, v224
    v_perm_b32 v117, v143, v144, v225
    s_mov_b32 s57, 1262080
    buffer_load_dwordx4 v249, s[16:19], s57 offen offset:3072 lds
    v_perm_b32 v118, v143, v145, v224
    v_perm_b32 v119, v142, v145, v225
    v_perm_b32 v100, v146, v142, v224
    ds_read_b64 v[136:137], v227 offset:44544
    ds_read_b32 v140, v227 offset:44552
    s_waitcnt vmcnt(16)
    ds_read_b64_tr_b16 a[64:65], v252 offset:20480
    ds_read_b64_tr_b16 a[66:67], v252 offset:21504
    ds_read_b64_tr_b16 a[68:69], v253 offset:20480
    ds_read_b64_tr_b16 a[70:71], v253 offset:21504
    s_waitcnt lgkmcnt(14)
    v_perm_b32 v121, v149, v148, v223
    v_perm_b32 v122, v149, v149, v222
    v_perm_b32 v123, v148, v149, v223
    v_perm_b32 v120, v152, v148, v222
    s_waitcnt lgkmcnt(6)
    s_add_u32 m0, s60, 16384
    s_mov_b32 s57, 458752
    buffer_load_dwordx4 v248, s[16:19], s57 offen offset:0 lds
    v_perm_b32 v125, v155, v154, v223
    v_perm_b32 v126, v155, v155, v222
    v_perm_b32 v127, v154, v155, v223
    v_perm_b32 v124, v158, v154, v222
    v_perm_b32 v129, v161, v160, v225
    s_mov_b32 s57, 472064
    buffer_load_dwordx4 v248, s[16:19], s57 offen offset:1024 lds
    v_perm_b32 v130, v161, v161, v224
    v_perm_b32 v131, v160, v161, v225
    v_perm_b32 v128, v164, v160, v224
    s_waitcnt lgkmcnt(5)
    v_perm_b32 v133, v137, v136, v225
    ds_read_b64_tr_b16 a[72:73], v254 offset:20480
    ds_read_b64_tr_b16 a[74:75], v254 offset:21504
    ds_read_b64_tr_b16 a[76:77], v255 offset:20480
    ds_read_b64_tr_b16 a[78:79], v255 offset:21504
    v_perm_b32 v134, v137, v137, v224
    v_perm_b32 v135, v136, v137, v225
    s_waitcnt lgkmcnt(8)
    v_perm_b32 v132, v140, v136, v224
    s_mul_i32 s56, s31, 57344
    s_add_u32 s56, s56, 262144
    s_mov_b32 s57, 1105408
    buffer_load_dwordx4 v249, s[16:19], s57 offen offset:2048 lds
    s_mov_b32 s62, 0x80008000
    s_cmp_eq_u32 s26, 0
    s_cselect_b32 s96, 0xffff, 0
    s_mov_b32 s97, 2000
    s_mov_b32 s57, 1090048
    buffer_load_dwordx4 v249, s[16:19], s57 offen offset:3072 lds
    s_lshl3_add_u32 s55, s24, s26
    s_mul_i32 s55, s55, 28672
    s_add_u32 s55, s55, 2842624
    s_lshl_b32 s48, s25, 12
    s_cmp_gt_u32 s25, 0
    s_movk_i32 s49, 4096
    s_cmovk_i32 s49, 0
    s_waitcnt vmcnt(16)
    ds_read_b64_tr_b16 a[112:113], v252 offset:0
    ds_read_b64_tr_b16 a[114:115], v252 offset:1024
    ds_read_b64_tr_b16 a[116:117], v253 offset:0
    ds_read_b64_tr_b16 a[118:119], v253 offset:1024
    s_cmp_gt_u32 s25, 1
    s_movk_i32 s50, 8192
    s_cmovk_i32 s50, 4096
    ds_read_b64_tr_b16 a[120:121], v254 offset:0
    ds_read_b64_tr_b16 a[122:123], v254 offset:1024
    ds_read_b64_tr_b16 a[124:125], v255 offset:0
    ds_read_b64_tr_b16 a[126:127], v255 offset:1024
    s_cmp_gt_u32 s25, 2
    s_movk_i32 s51, 12288
    s_cmovk_i32 s51, 8192
    s_cmp_gt_u32 s25, 3
    s_movk_i32 s52, 16384
    s_cmovk_i32 s52, 12288
    s_waitcnt vmcnt(12)
    ds_read_b64_tr_b16 a[160:161], v252 offset:4096
    ds_read_b64_tr_b16 a[162:163], v252 offset:5120
    ds_read_b64_tr_b16 a[164:165], v253 offset:4096
    ds_read_b64_tr_b16 a[166:167], v253 offset:5120
    s_cmp_gt_u32 s25, 4
    s_movk_i32 s53, 20480
    s_cmovk_i32 s53, 16384
    ds_read_b64_tr_b16 a[168:169], v254 offset:4096
    ds_read_b64_tr_b16 a[170:171], v254 offset:5120
    ds_read_b64_tr_b16 a[172:173], v255 offset:4096
    ds_read_b64_tr_b16 a[174:175], v255 offset:5120
    s_cmp_gt_u32 s25, 5
    s_movk_i32 s54, 24576
    s_cmovk_i32 s54, 20480
    s_mul_i32 s3, s29, 57344
    s_add_u32 s3, s3, 1867776
    s_mul_i32 s101, s26, 12288
    s_mul_i32 s100, s26, -10240
    s_add_u32 s100, s100, 40960
    s_add_u32 s3, s3, s101
    s_cmp_lg_u32 s26, 0
    s_cbranch_scc1 L_w0_6
    s_lshl_b32 s34, s30, 12
    s_add_u32 s34, s34, 65536
    v_min_u32 v22, 27, v0
    v_lshl_add_u32 v22, v22, 7, s34
L_sp_8:
    buffer_load_dword v21, v22, s[8:11], 0 offen sc1
    s_waitcnt vmcnt(0)
    v_cmp_ne_u32 vcc, 8, v21
    s_sub_i32 s39, s39, 1
    s_max_i32 s39, s39, 0
    s_cbranch_scc0 L_ok_7
    s_cbranch_vccnz L_sp_8
L_ok_7:
L_w0_6:
    s_waitcnt lgkmcnt(0)
    s_barrier
    s_mov_b32 m0, s101
    s_nop 0
    buffer_load_dwordx4 v1, s[8:11], s3 offen offset:0 sc1 lds
    buffer_load_dwordx4 v1, s[8:11], s3 offen offset:1024 sc1 lds
    buffer_load_dwordx4 v1, s[8:11], s3 offen offset:2048 sc1 lds
    v_and_b32 v22, 3, v0
    v_lshlrev_b32 v216, 4, v22
    v_lshl_add_u32 v216, v3, 7, v216
    v_bfe_u32 v22, v0, 3, 1
    v_lshl_add_u32 v216, v22, 6, v216
    v_bfe_u32 v22, v0, 2, 1
    v_lshl_add_u32 v216, v22, 3, v216
    s_mul_i32 s34, s26, 12288
    s_lshl_b32 s35, s26, 11
    s_add_u32 s35, s35, 49152
    v_add_u32 v217, s35, v216
    v_add_u32 v216, s34, v216
    v_lshlrev_b32 v22, 3, v0
    buffer_load_dwordx4 v1, s[8:11], s3 offen offset:3072 sc1 lds
    v_xor_b32 v23, 256, v22
    v_add_u32 v218, s34, v22
    v_add_u32 v219, s34, v23
    v_add_u32 v220, s35, v22
    v_add_u32 v221, s35, v23
    ds_read_b128 v[232:235], v214 offset:0
    ds_read_b128 v[236:239], v214 offset:1024
    ds_read_b128 v[240:243], v214 offset:2048
    ds_read_b128 v[244:247], v214 offset:3072
    ds_read_b128 a[224:227], v214 offset:0
    ds_read_b128 a[228:231], v214 offset:1024
    ds_read_b128 a[232:235], v214 offset:2048
    s_add_u32 m0, m0, 4096
    s_add_u32 s3, s3, 4096
    buffer_load_dwordx4 v1, s[8:11], s3 offen offset:0 sc1 lds
    ds_read_b128 a[236:239], v214 offset:3072
    v_and_b32 v169, 1, v3
    v_sub_u32 v169, 0, v169
    v_and_b32 v169, 0x80008000, v169
    s_waitcnt lgkmcnt(7)
    v_xor_b32 v232, v232, v169
    v_xor_b32 v233, v233, v169
    v_xor_b32 v234, v234, v169
    v_xor_b32 v235, v235, v169
    s_waitcnt lgkmcnt(6)
    v_xor_b32 v236, v236, v169
    v_xor_b32 v237, v237, v169
    v_xor_b32 v238, v238, v169
    v_xor_b32 v239, v239, v169
    s_waitcnt lgkmcnt(5)
    v_xor_b32 v240, v240, v169
    buffer_load_dwordx4 v1, s[8:11], s3 offen offset:1024 sc1 lds
    v_xor_b32 v241, v241, v169
    v_xor_b32 v242, v242, v169
    v_xor_b32 v243, v243, v169
    s_waitcnt lgkmcnt(4)
    v_xor_b32 v244, v244, v169
    v_xor_b32 v245, v245, v169
    v_xor_b32 v246, v246, v169
    v_xor_b32 v247, v247, v169
    v_accvgpr_write_b32 a240, v232
    v_accvgpr_write_b32 a241, v233
    v_accvgpr_write_b32 a242, v234
    v_accvgpr_write_b32 a243, v235
    v_accvgpr_write_b32 a244, v236
    buffer_load_dwordx4 v1, s[8:11], s3 offen offset:2048 sc1 lds
    v_accvgpr_write_b32 a245, v237
    v_accvgpr_write_b32 a246, v238
    v_accvgpr_write_b32 a247, v239
    v_accvgpr_write_b32 a248, v240
    v_accvgpr_write_b32 a249, v241
    v_accvgpr_write_b32 a250, v242
    v_accvgpr_write_b32 a251, v243
    v_accvgpr_write_b32 a252, v244
    v_accvgpr_write_b32 a253, v245
    v_accvgpr_write_b32 a254, v246
    v_accvgpr_write_b32 a255, v247
    v_pk_add_f32 v[24:25], v[24:25], v[228:229] op_sel_hi:[1,0] neg_lo:[0,1] neg_hi:[0,1]
    v_pk_add_f32 v[26:27], v[26:27], v[228:229] op_sel_hi:[1,0] neg_lo:[0,1] neg_hi:[0,1]
    buffer_load_dwordx4 v1, s[8:11], s3 offen offset:3072 sc1 lds
    v_pk_add_f32 v[40:41], v[40:41], v[228:229] op_sel_hi:[1,0] neg_lo:[0,1] neg_hi:[0,1]
    v_pk_add_f32 v[42:43], v[42:43], v[228:229] op_sel_hi:[1,0] neg_lo:[0,1] neg_hi:[0,1]
    v_pk_add_f32 v[28:29], v[28:29], v[228:229] op_sel:[0,1] op_sel_hi:[1,1] neg_lo:[0,1] neg_hi:[0,1]
    v_pk_add_f32 v[30:31], v[30:31], v[228:229] op_sel:[0,1] op_sel_hi:[1,1] neg_lo:[0,1] neg_hi:[0,1]
    v_pk_add_f32 v[44:45], v[44:45], v[228:229] op_sel:[0,1] op_sel_hi:[1,1] neg_lo:[0,1] neg_hi:[0,1]
    v_pk_add_f32 v[46:47], v[46:47], v[228:229] op_sel:[0,1] op_sel_hi:[1,1] neg_lo:[0,1] neg_hi:[0,1]
    v_pk_add_f32 v[32:33], v[32:33], v[230:231] op_sel_hi:[1,0] neg_lo:[0,1] neg_hi:[0,1]
    v_pk_add_f32 v[34:35], v[34:35], v[230:231] op_sel_hi:[1,0] neg_lo:[0,1] neg_hi:[0,1]
    v_pk_add_f32 v[48:49], v[48:49], v[230:231] op_sel_hi:[1,0] neg_lo:[0,1] neg_hi:[0,1]
    v_pk_add_f32 v[50:51], v[50:51], v[230:231] op_sel_hi:[1,0] neg_lo:[0,1] neg_hi:[0,1]
    v_pk_add_f32 v[36:37], v[36:37], v[230:231] op_sel:[0,1] op_sel_hi:[1,1] neg_lo:[0,1] neg_hi:[0,1]
    v_pk_add_f32 v[38:39], v[38:39], v[230:231] op_sel:[0,1] op_sel_hi:[1,1] neg_lo:[0,1] neg_hi:[0,1]
    s_add_u32 m0, m0, 4096
    s_add_u32 s3, s3, 4096
    buffer_load_dwordx4 v1, s[8:11], s3 offen offset:0 sc1 lds
    v_pk_add_f32 v[52:53], v[52:53], v[230:231] op_sel:[0,1] op_sel_hi:[1,1] neg_lo:[0,1] neg_hi:[0,1]
    v_pk_add_f32 v[54:55], v[54:55], v[230:231] op_sel:[0,1] op_sel_hi:[1,1] neg_lo:[0,1] neg_hi:[0,1]
    v_pk_add_f32 v[56:57], v[56:57], v[228:229] op_sel_hi:[1,0] neg_lo:[0,1] neg_hi:[0,1]
    v_pk_add_f32 v[58:59], v[58:59], v[228:229] op_sel_hi:[1,0] neg_lo:[0,1] neg_hi:[0,1]
    v_pk_add_f32 v[72:73], v[72:73], v[228:229] op_sel_hi:[1,0] neg_lo:[0,1] neg_hi:[0,1]
    v_pk_add_f32 v[74:75], v[74:75], v[228:229] op_sel_hi:[1,0] neg_lo:[0,1] neg_hi:[0,1]
    v_pk_add_f32 v[60:61], v[60:61], v[228:229] op_sel:[0,1] op_sel_hi:[1,1] neg_lo:[0,1] neg_hi:[0,1]
    v_pk_add_f32 v[62:63], v[62:63], v[228:229] op_sel:[0,1] op_sel_hi:[1,1] neg_lo:[0,1] neg_hi:[0,1]
    v_pk_add_f32 v[76:77], v[76:77], v[228:229] op_sel:[0,1] op_sel_hi:[1,1] neg_lo:[0,1] neg_hi:[0,1]
    v_pk_add_f32 v[78:79], v[78:79], v[228:229] op_sel:[0,1] op_sel_hi:[1,1] neg_lo:[0,1] neg_hi:[0,1]
    v_pk_add_f32 v[64:65], v[64:65], v[230:231] op_sel_hi:[1,0] neg_lo:[0,1] neg_hi:[0,1]
    v_pk_add_f32 v[66:67], v[66:67], v[230:231] op_sel_hi:[1,0] neg_lo:[0,1] neg_hi:[0,1]
    v_pk_add_f32 v[80:81], v[80:81], v[230:231] op_sel_hi:[1,0] neg_lo:[0,1] neg_hi:[0,1]
    buffer_load_dwordx4 v1, s[8:11], s3 offen offset:1024 sc1 lds
    v_pk_add_f32 v[82:83], v[82:83], v[230:231] op_sel_hi:[1,0] neg_lo:[0,1] neg_hi:[0,1]
    v_pk_add_f32 v[68:69], v[68:69], v[230:231] op_sel:[0,1] op_sel_hi:[1,1] neg_lo:[0,1] neg_hi:[0,1]
    v_pk_add_f32 v[70:71], v[70:71], v[230:231] op_sel:[0,1] op_sel_hi:[1,1] neg_lo:[0,1] neg_hi:[0,1]
    v_pk_add_f32 v[84:85], v[84:85], v[230:231] op_sel:[0,1] op_sel_hi:[1,1] neg_lo:[0,1] neg_hi:[0,1]
    v_pk_add_f32 v[86:87], v[86:87], v[230:231] op_sel:[0,1] op_sel_hi:[1,1] neg_lo:[0,1] neg_hi:[0,1]
    v_pk_add_f32 v[88:89], v[88:89], v[228:229] op_sel_hi:[1,0] neg_lo:[0,1] neg_hi:[0,1]
    v_pk_add_f32 v[90:91], v[90:91], v[228:229] op_sel_hi:[1,0] neg_lo:[0,1] neg_hi:[0,1]
    v_pk_add_f32 v[104:105], v[104:105], v[228:229] op_sel_hi:[1,0] neg_lo:[0,1] neg_hi:[0,1]
    v_pk_add_f32 v[106:107], v[106:107], v[228:229] op_sel_hi:[1,0] neg_lo:[0,1] neg_hi:[0,1]
    v_pk_add_f32 v[92:93], v[92:93], v[228:229] op_sel:[0,1] op_sel_hi:[1,1] neg_lo:[0,1] neg_hi:[0,1]
    v_pk_add_f32 v[94:95], v[94:95], v[228:229] op_sel:[0,1] op_sel_hi:[1,1] neg_lo:[0,1] neg_hi:[0,1]
    v_pk_add_f32 v[108:109], v[108:109], v[228:229] op_sel:[0,1] op_sel_hi:[1,1] neg_lo:[0,1] neg_hi:[0,1]
    buffer_load_dwordx4 v1, s[8:11], s3 offen offset:2048 sc1 lds
    v_pk_add_f32 v[110:111], v[110:111], v[228:229] op_sel:[0,1] op_sel_hi:[1,1] neg_lo:[0,1] neg_hi:[0,1]
    v_pk_add_f32 v[96:97], v[96:97], v[230:231] op_sel_hi:[1,0] neg_lo:[0,1] neg_hi:[0,1]
    v_pk_add_f32 v[98:99], v[98:99], v[230:231] op_sel_hi:[1,0] neg_lo:[0,1] neg_hi:[0,1]
    v_pk_add_f32 v[112:113], v[112:113], v[230:231] op_sel_hi:[1,0] neg_lo:[0,1] neg_hi:[0,1]
    v_pk_add_f32 v[114:115], v[114:115], v[230:231] op_sel_hi:[1,0] neg_lo:[0,1] neg_hi:[0,1]
    v_pk_add_f32 v[100:101], v[100:101], v[230:231] op_sel:[0,1] op_sel_hi:[1,1] neg_lo:[0,1] neg_hi:[0,1]
    v_pk_add_f32 v[102:103], v[102:103], v[230:231] op_sel:[0,1] op_sel_hi:[1,1] neg_lo:[0,1] neg_hi:[0,1]
    v_pk_add_f32 v[116:117], v[116:117], v[230:231] op_sel:[0,1] op_sel_hi:[1,1] neg_lo:[0,1] neg_hi:[0,1]
    v_pk_add_f32 v[118:119], v[118:119], v[230:231] op_sel:[0,1] op_sel_hi:[1,1] neg_lo:[0,1] neg_hi:[0,1]
    v_pk_add_f32 v[120:121], v[120:121], v[228:229] op_sel_hi:[1,0] neg_lo:[0,1] neg_hi:[0,1]
    v_pk_add_f32 v[122:123], v[122:123], v[228:229] op_sel_hi:[1,0] neg_lo:[0,1] neg_hi:[0,1]
    v_pk_add_f32 v[124:125], v[124:125], v[228:229] op_sel:[0,1] op_sel_hi:[1,1] neg_lo:[0,1] neg_hi:[0,1]
    v_pk_add_f32 v[126:127], v[126:127], v[228:229] op_sel:[0,1] op_sel_hi:[1,1] neg_lo:[0,1] neg_hi:[0,1]
    buffer_load_dwordx4 v1, s[8:11], s3 offen offset:3072 sc1 lds
    v_pk_add_f32 v[128:129], v[128:129], v[230:231] op_sel_hi:[1,0] neg_lo:[0,1] neg_hi:[0,1]
    v_pk_add_f32 v[130:131], v[130:131], v[230:231] op_sel_hi:[1,0] neg_lo:[0,1] neg_hi:[0,1]
    v_pk_add_f32 v[132:133], v[132:133], v[230:231] op_sel:[0,1] op_sel_hi:[1,1] neg_lo:[0,1] neg_hi:[0,1]
    v_pk_add_f32 v[134:135], v[134:135], v[230:231] op_sel:[0,1] op_sel_hi:[1,1] neg_lo:[0,1] neg_hi:[0,1]
    s_lshr_b32 s34, s26, 1
    s_lshl_b32 s35, s34, 9
    v_lshl_add_u32 v4, v0, 3, s35
    v_xor_b32 v5, 512, v4
    s_waitcnt vmcnt(20)
    ds_read_b64_tr_b16 a[32:33], v252 offset:8192
    ds_read_b64_tr_b16 a[34:35], v252 offset:9216
    ds_read_b64_tr_b16 a[36:37], v253 offset:8192
    ds_read_b64_tr_b16 a[38:39], v253 offset:9216
    ds_read_b64_tr_b16 a[40:41], v254 offset:8192
    ds_read_b64_tr_b16 a[42:43], v254 offset:9216
    ds_read_b64_tr_b16 a[44:45], v255 offset:8192
    ds_read_b64_tr_b16 a[46:47], v255 offset:9216
    s_add_u32 m0, m0, s100
    s_add_u32 s3, s3, s100
    buffer_load_dwordx4 v1, s[8:11], s3 offen offset:0 sc1 lds
    s_waitcnt vmcnt(17)
    ds_read_b64_tr_b16 a[80:81], v252 offset:12288
    ds_read_b64_tr_b16 a[82:83], v252 offset:13312
    ds_read_b64_tr_b16 a[84:85], v253 offset:12288
    ds_read_b64_tr_b16 a[86:87], v253 offset:13312
    ds_read_b64_tr_b16 a[88:89], v254 offset:12288
    ds_read_b64_tr_b16 a[90:91], v254 offset:13312
    ds_read_b64_tr_b16 a[92:93], v255 offset:12288
    ds_read_b64_tr_b16 a[94:95], v255 offset:13312
    s_waitcnt vmcnt(13)
    ds_read_b64_tr_b16 a[128:129], v252 offset:16384
    ds_read_b64_tr_b16 a[130:131], v252 offset:17408
    ds_read_b64_tr_b16 a[132:133], v253 offset:16384
    ds_read_b64_tr_b16 a[134:135], v253 offset:17408
    ds_read_b64_tr_b16 a[136:137], v254 offset:16384
    ds_read_b64_tr_b16 a[138:139], v254 offset:17408
    ds_read_b64_tr_b16 a[140:141], v255 offset:16384
    ds_read_b64_tr_b16 a[142:143], v255 offset:17408
    buffer_load_dwordx4 v1, s[8:11], s3 offen offset:1024 sc1 lds
    s_mov_b32 s34, s55
    s_add_u32 s35, s34, 114688
    s_add_u32 s32, s34, s48
    s_add_u32 s33, s35, s48
    v_mov_b32 v20, 1
    s_lshl_b32 s37, s30, 7
    s_add_u32 s37, s37, 16384
    s_waitcnt vmcnt(13)
    ds_read_b64_tr_b16 v[136:137], v216 offset:0
    ds_read_b64_tr_b16 v[138:139], v216 offset:512
    s_waitcnt vmcnt(12)
    ds_read_b64_tr_b16 v[140:141], v216 offset:1024
    ds_read_b64_tr_b16 v[142:143], v216 offset:1536
    s_waitcnt lgkmcnt(2)
    v_mfma_f32_16x16x32_f16 v[24:27], v[136:139], a[224:227], v[24:27]
    s_waitcnt vmcnt(11)
    ds_read_b64_tr_b16 v[144:145], v216 offset:2048
    buffer_load_dword v21, off, s[8:11], s37 sc1
    v_mfma_f32_16x16x32_f16 v[28:31], v[136:139], a[240:243], v[28:31]
    s_waitcnt lgkmcnt(1)
    ds_read_b64_tr_b16 v[146:147], v216 offset:2560
    v_mfma_f32_16x16x32_f16 v[24:27], v[140:143], a[228:231], v[24:27]
    s_waitcnt vmcnt(11)
    ds_read_b64_tr_b16 v[148:149], v216 offset:3072
    v_mfma_f32_16x16x32_f16 v[28:31], v[140:143], a[244:247], v[28:31]
    ds_read_b64_tr_b16 v[150:151], v216 offset:3584
    s_cmp_lg_u32 s26, 0
    s_cbranch_scc1 L_w0_9
    s_mov_b32 exec_lo, 0x01010101
    s_mov_b32 exec_hi, 0x01010101
    v_mov_b32_dpp v136, v136 row_ror:8 row_mask:0xf bank_mask:0xf
    v_mov_b32_dpp v137, v137 row_ror:8 row_mask:0xf bank_mask:0xf
    v_mov_b32_dpp v138, v138 row_ror:8 row_mask:0xf bank_mask:0xf
    v_mov_b32_dpp v139, v139 row_ror:8 row_mask:0xf bank_mask:0xf
    v_mov_b32_dpp v140, v140 row_ror:8 row_mask:0xf bank_mask:0xf
    v_mov_b32_dpp v141, v141 row_ror:8 row_mask:0xf bank_mask:0xf
    v_mov_b32_dpp v142, v142 row_ror:8 row_mask:0xf bank_mask:0xf
    v_mov_b32_dpp v143, v143 row_ror:8 row_mask:0xf bank_mask:0xf
    s_mov_b64 exec, -1
L_w0_9:
    v_mfma_f32_16x16x32_f16 v[32:35], v[136:139], a[232:235], v[32:35]
    s_add_u32 m0, s60, 20480
    s_mov_b32 s57, 630784
    buffer_load_dwordx4 v248, s[16:19], s57 offen offset:0 lds
    v_mfma_f32_16x16x32_f16 v[36:39], v[136:139], a[248:251], v[36:39]
    v_cvt_pk_bf16_f32 v168, v24, v25
    v_cvt_pk_bf16_f32 v169, v26, v27
    v_mfma_f32_16x16x32_f16 v[32:35], v[140:143], a[236:239], v[32:35]
    s_mov_b32 s57, 644096
    buffer_load_dwordx4 v248, s[16:19], s57 offen offset:1024 lds
    v_mfma_f32_16x16x32_f16 v[36:39], v[140:143], a[252:255], v[36:39]
    s_waitcnt lgkmcnt(2)
    v_cvt_pk_bf16_f32 v170, v28, v29
    v_cvt_pk_bf16_f32 v171, v30, v31
    v_mfma_f32_16x16x32_f16 v[40:43], v[144:147], a[224:227], v[40:43]
    s_waitcnt vmcnt(12)
    ds_read_b64_tr_b16 v[152:153], v216 offset:4096
    v_mfma_f32_16x16x32_f16 v[44:47], v[144:147], a[240:243], v[44:47]
    s_waitcnt lgkmcnt(1)
    ds_read_b64_tr_b16 v[154:155], v216 offset:4608
    v_cvt_pk_bf16_f32 v176, v32, v33
    v_mfma_f32_16x16x32_f16 v[40:43], v[148:151], a[228:231], v[40:43]
    s_waitcnt vmcnt(11)
    ds_read_b64_tr_b16 v[156:157], v216 offset:5120
    v_cvt_pk_bf16_f32 v177, v34, v35
    v_mfma_f32_16x16x32_f16 v[44:47], v[148:151], a[244:247], v[44:47]
    ds_read_b64_tr_b16 v[158:159], v216 offset:5632
    v_cvt_pk_bf16_f32 v178, v36, v37
    v_mfma_f32_16x16x32_f16 v[48:51], v[144:147], a[232:235], v[48:51]
    ds_write2st64_b64 v218, v[168:169], v[170:171] offset0:0 offset1:1
    s_mov_b32 s57, 933376
    buffer_load_dwordx4 v249, s[16:19], s57 offen offset:2048 lds
    v_mfma_f32_16x16x32_f16 v[52:55], v[144:147], a[248:251], v[52:55]
    v_cvt_pk_bf16_f32 v172, v40, v41
    v_cvt_pk_bf16_f32 v173, v42, v43
    v_mfma_f32_16x16x32_f16 v[48:51], v[148:151], a[236:239], v[48:51]
    s_mov_b32 s57, 918016
    buffer_load_dwordx4 v249, s[16:19], s57 offen offset:3072 lds
    v_mfma_f32_16x16x32_f16 v[52:55], v[148:151], a[252:255], v[52:55]
    s_waitcnt lgkmcnt(3)
    v_cvt_pk_bf16_f32 v174, v44, v45
    v_cvt_pk_bf16_f32 v175, v46, v47
    v_mfma_f32_16x16x32_f16 v[56:59], v[152:155], a[224:227], v[56:59]
    s_waitcnt vmcnt(12)
    ds_read_b64_tr_b16 v[160:161], v216 offset:6144
    v_cvt_pk_bf16_f32 v179, v38, v39
    v_mfma_f32_16x16x32_f16 v[60:63], v[152:155], a[240:243], v[60:63]
    s_waitcnt lgkmcnt(2)
    ds_read_b64_tr_b16 v[162:163], v216 offset:6656
    v_sub_f32 v192, v192, v24
    v_mfma_f32_16x16x32_f16 v[56:59], v[156:159], a[228:231], v[56:59]
    s_waitcnt vmcnt(11)
    ds_read_b64_tr_b16 v[164:165], v216 offset:7168
    v_sub_f32 v193, v193, v28
    v_mfma_f32_16x16x32_f16 v[60:63], v[156:159], a[244:247], v[60:63]
    ds_read_b64_tr_b16 v[166:167], v216 offset:7680
    v_sub_f32 v194, v194, v32
    v_mfma_f32_16x16x32_f16 v[64:67], v[152:155], a[232:235], v[64:67]
    ds_write2st64_b64 v218, v[172:173], v[174:175] offset0:4 offset1:5
    s_add_u32 m0, s60, 0
    s_mov_b32 s57, 688128
    buffer_load_dwordx4 v248, s[16:19], s57 offen offset:0 lds
    v_mfma_f32_16x16x32_f16 v[68:71], v[152:155], a[248:251], v[68:71]
    ds_write2st64_b64 v219, v[176:177], v[178:179] offset0:2 offset1:3
    v_mfma_f32_16x16x32_f16 v[64:67], v[156:159], a[236:239], v[64:67]
    s_mov_b32 s57, 701440
    buffer_load_dwordx4 v248, s[16:19], s57 offen offset:1024 lds
    v_mfma_f32_16x16x32_f16 v[68:71], v[156:159], a[252:255], v[68:71]
    s_waitcnt lgkmcnt(4)
    v_cvt_pk_bf16_f32 v168, v56, v57
    v_cvt_pk_bf16_f32 v169, v58, v59
    v_mfma_f32_16x16x32_f16 v[72:75], v[160:163], a[224:227], v[72:75]
    s_waitcnt vmcnt(12)
    ds_read_b64_tr_b16 v[136:137], v216 offset:8192
    v_cvt_pk_bf16_f32 v170, v60, v61
    v_mfma_f32_16x16x32_f16 v[76:79], v[160:163], a[240:243], v[76:79]
    s_waitcnt lgkmcnt(3)
    ds_read_b64_tr_b16 v[138:139], v216 offset:8704
    v_cvt_pk_bf16_f32 v171, v62, v63
    v_mfma_f32_16x16x32_f16 v[72:75], v[164:167], a[228:231], v[72:75]
    s_waitcnt vmcnt(11)
    ds_read_b64_tr_b16 v[140:141], v216 offset:9216
    v_cvt_pk_bf16_f32 v180, v48, v49
    v_mfma_f32_16x16x32_f16 v[76:79], v[164:167], a[244:247], v[76:79]
    ds_read_b64_tr_b16 v[142:143], v216 offset:9728
    v_cvt_pk_bf16_f32 v181, v50, v51
    v_mfma_f32_16x16x32_f16 v[80:83], v[160:163], a[232:235], v[80:83]
    ds_write2st64_b64 v218, v[168:169], v[170:171] offset0:8 offset1:9
    s_mov_b32 s57, 876032
    buffer_load_dwordx4 v249, s[16:19], s57 offen offset:2048 lds
    v_mfma_f32_16x16x32_f16 v[84:87], v[160:163], a[248:251], v[84:87]
    v_cvt_pk_bf16_f32 v182, v52, v53
    v_cvt_pk_bf16_f32 v183, v54, v55
    v_mfma_f32_16x16x32_f16 v[80:83], v[164:167], a[236:239], v[80:83]
    s_mov_b32 s57, 860672
    buffer_load_dwordx4 v249, s[16:19], s57 offen offset:3072 lds
    v_mfma_f32_16x16x32_f16 v[84:87], v[164:167], a[252:255], v[84:87]
    s_waitcnt lgkmcnt(3)
    ds_write2st64_b64 v219, v[180:181], v[182:183] offset0:6 offset1:7
    v_mfma_f32_16x16x32_f16 v[88:91], v[136:139], a[224:227], v[88:91]
    s_waitcnt vmcnt(12)
    ds_read_b64_tr_b16 v[144:145], v216 offset:10240
    v_cvt_pk_bf16_f32 v172, v72, v73
    v_mfma_f32_16x16x32_f16 v[92:95], v[136:139], a[240:243], v[92:95]
    s_waitcnt lgkmcnt(3)
    ds_read_b64_tr_b16 v[146:147], v216 offset:10752
    v_cvt_pk_bf16_f32 v173, v74, v75
    v_mfma_f32_16x16x32_f16 v[88:91], v[140:143], a[228:231], v[88:91]
    s_waitcnt vmcnt(11)
    ds_read_b64_tr_b16 v[148:149], v216 offset:11264
    v_cvt_pk_bf16_f32 v174, v76, v77
    v_mfma_f32_16x16x32_f16 v[92:95], v[140:143], a[244:247], v[92:95]
    ds_read_b64_tr_b16 v[150:151], v216 offset:11776
    v_cvt_pk_bf16_f32 v175, v78, v79
    v_mfma_f32_16x16x32_f16 v[96:99], v[136:139], a[232:235], v[96:99]
    ds_write2st64_b64 v218, v[172:173], v[174:175] offset0:12 offset1:13
    s_add_u32 m0, s60, 4096
    s_mov_b32 s57, 745472
    buffer_load_dwordx4 v248, s[16:19], s57 offen offset:0 lds
    v_mfma_f32_16x16x32_f16 v[100:103], v[136:139], a[248:251], v[100:103]
    v_cvt_pk_bf16_f32 v176, v64, v65
    v_cvt_pk_bf16_f32 v177, v66, v67
    v_mfma_f32_16x16x32_f16 v[96:99], v[140:143], a[236:239], v[96:99]
    s_mov_b32 s57, 758784
    buffer_load_dwordx4 v248, s[16:19], s57 offen offset:1024 lds
    v_mfma_f32_16x16x32_f16 v[100:103], v[140:143], a[252:255], v[100:103]
    s_waitcnt lgkmcnt(3)
    v_cvt_pk_bf16_f32 v178, v68, v69
    v_cvt_pk_bf16_f32 v179, v70, v71
    v_mfma_f32_16x16x32_f16 v[104:107], v[144:147], a[224:227], v[104:107]
    s_waitcnt vmcnt(12)
    ds_read_b64_tr_b16 v[152:153], v217 offset:0
    ds_write2st64_b64 v219, v[176:177], v[178:179] offset0:10 offset1:11
    v_mfma_f32_16x16x32_f16 v[108:111], v[144:147], a[240:243], v[108:111]
    s_waitcnt lgkmcnt(3)
    ds_read_b64_tr_b16 v[154:155], v217 offset:512
    v_cvt_pk_bf16_f32 v168, v88, v89
    v_mfma_f32_16x16x32_f16 v[104:107], v[148:151], a[228:231], v[104:107]
    s_waitcnt vmcnt(11)
    ds_read_b64_tr_b16 v[156:157], v217 offset:1024
    v_cvt_pk_bf16_f32 v169, v90, v91
    v_mfma_f32_16x16x32_f16 v[108:111], v[148:151], a[244:247], v[108:111]
    ds_read_b64_tr_b16 v[158:159], v217 offset:1536
    s_mov_b32 s57, 818688
    buffer_load_dwordx4 v249, s[16:19], s57 offen offset:2048 lds
    v_mfma_f32_16x16x32_f16 v[112:115], v[144:147], a[232:235], v[112:115]
    v_cvt_pk_bf16_f32 v170, v92, v93
    v_cvt_pk_bf16_f32 v171, v94, v95
    ds_write2st64_b64 v218, v[168:169], v[170:171] offset0:16 offset1:17
    v_mfma_f32_16x16x32_f16 v[116:119], v[144:147], a[248:251], v[116:119]
    v_cvt_pk_bf16_f32 v180, v80, v81
    v_cvt_pk_bf16_f32 v181, v82, v83
    v_cvt_pk_bf16_f32 v182, v84, v85
    v_cvt_pk_bf16_f32 v183, v86, v87
    ds_write2st64_b64 v219, v[180:181], v[182:183] offset0:14 offset1:15
    v_mfma_f32_16x16x32_f16 v[112:115], v[148:151], a[236:239], v[112:115]
    s_waitcnt lgkmcnt(7)
    s_barrier
    ds_read2st64_b64 v[232:235], v4 offset0:0 offset1:4
    v_mfma_f32_16x16x32_f16 v[116:119], v[148:151], a[252:255], v[116:119]
    s_waitcnt lgkmcnt(5)
    s_mov_b32 s57, 803328
    buffer_load_dwordx4 v249, s[16:19], s57 offen offset:3072 lds
    v_mfma_f32_16x16x32_f16 v[120:123], v[152:155], a[224:227], v[120:123]
    ds_read2st64_b64 v[236:239], v4 offset0:24 offset1:28
    v_cvt_pk_bf16_f32 v176, v96, v97
    v_mfma_f32_16x16x32_f16 v[124:127], v[152:155], a[240:243], v[124:127]
    s_waitcnt lgkmcnt(4)
    v_cvt_pk_bf16_f32 v177, v98, v99
    v_cvt_pk_bf16_f32 v178, v100, v101
    v_mfma_f32_16x16x32_f16 v[120:123], v[156:159], a[228:231], v[120:123]
    v_cvt_pk_bf16_f32 v179, v102, v103
    ds_write2st64_b64 v219, v[176:177], v[178:179] offset0:18 offset1:19
    v_mfma_f32_16x16x32_f16 v[124:127], v[156:159], a[244:247], v[124:127]
    s_waitcnt vmcnt(12)
    v_cmp_ne_u32 vcc, 32, v21
    v_cvt_pk_bf16_f32 v172, v104, v105
    v_mfma_f32_16x16x32_f16 v[128:131], v[152:155], a[232:235], v[128:131]
    v_cvt_pk_bf16_f32 v173, v106, v107
    v_cvt_pk_bf16_f32 v174, v108, v109
    v_cvt_pk_bf16_f32 v175, v110, v111
    ds_write2st64_b64 v218, v[172:173], v[174:175] offset0:20 offset1:21
    v_mfma_f32_16x16x32_f16 v[132:135], v[152:155], a[248:251], v[132:135]
    ds_read2st64_b64 v[240:243], v4 offset0:48 offset1:52
    v_cvt_pk_bf16_f32 v180, v112, v113
    v_mfma_f32_16x16x32_f16 v[128:131], v[156:159], a[236:239], v[128:131]
    s_cbranch_vccnz L_slow_10
L_back_11:
    s_add_u32 m0, s60, 8192
    s_add_u32 s57, s56, 40960
    buffer_load_dwordx4 v1, s[8:11], s57 offen offset:0 sc1 lds
    s_lshl3_add_u32 s100, s24, s26
    s_lshl_b32 s100, s100, 7
    s_add_u32 s100, s100, 32768
    v_mfma_f32_16x16x32_f16 v[132:135], v[156:159], a[252:255], v[132:135]
    s_waitcnt lgkmcnt(4)
    ds_read2st64_b64 v[244:247], v4 offset0:72 offset1:76
    buffer_load_dwordx4 v1, s[8:11], s57 offen offset:1024 sc1 lds
    v_mfma_f32_16x16x32_bf16 v[200:203], a[0:3], v[232:235], 0
    v_cvt_pk_bf16_f32 v181, v114, v115
    v_cvt_pk_bf16_f32 v182, v116, v117
    v_cvt_pk_bf16_f32 v183, v118, v119
    ds_write2st64_b64 v219, v[180:181], v[182:183] offset0:22 offset1:23
    v_mfma_f32_16x16x32_bf16 v[204:207], a[4:7], v[232:235], 0
    buffer_load_dwordx4 v1, s[8:11], s57 offen offset:2048 sc1 lds
    v_cvt_pk_bf16_f32 v168, v120, v121
    v_mfma_f32_16x16x32_bf16 v[208:211], a[8:11], v[232:235], 0
    v_cvt_pk_bf16_f32 v169, v122, v123
    v_cvt_pk_bf16_f32 v170, v124, v125
    v_mfma_f32_16x16x32_bf16 v[212:215], a[12:15], v[232:235], 0
    s_waitcnt lgkmcnt(5)
    ds_read2st64_b64 v[232:235], v4 offset0:8 offset1:12
    v_cvt_pk_bf16_f32 v171, v126, v127
    v_mfma_f32_16x16x32_bf16 v[200:203], a[48:51], v[236:239], v[200:203]
    ds_write2st64_b64 v220, v[168:169], v[170:171] offset0:0 offset1:1
    v_mfma_f32_16x16x32_bf16 v[204:207], a[52:55], v[236:239], v[204:207]
    buffer_load_dwordx4 v1, s[8:11], s57 offen offset:3072 sc1 lds
    v_cvt_pk_bf16_f32 v176, v128, v129
    v_mfma_f32_16x16x32_bf16 v[208:211], a[56:59], v[236:239], v[208:211]
    v_cvt_pk_bf16_f32 v177, v130, v131
    v_cvt_pk_bf16_f32 v178, v132, v133
    v_mfma_f32_16x16x32_bf16 v[212:215], a[60:63], v[236:239], v[212:215]
    s_waitcnt lgkmcnt(4)
    ds_read2st64_b64 v[236:239], v4 offset0:32 offset1:36
    v_cvt_pk_bf16_f32 v179, v134, v135
    v_mfma_f32_16x16x32_bf16 v[200:203], a[96:99], v[240:243], v[200:203]
    ds_write2st64_b64 v221, v[176:177], v[178:179] offset0:2 offset1:3
    v_mfma_f32_16x16x32_bf16 v[204:207], a[100:103], v[240:243], v[204:207]
    s_add_u32 m0, s60, 12288
    s_add_u32 s57, s56, 45056
    buffer_load_dwordx4 v1, s[8:11], s57 offen offset:0 sc1 lds
    v_mfma_f32_16x16x32_bf16 v[208:211], a[104:107], v[240:243], v[208:211]
    s_waitcnt vmcnt(13)
    ds_read_b64_tr_b16 a[176:177], v252 offset:20480
    v_sub_f32 v195, v195, v36
    v_mfma_f32_16x16x32_bf16 v[212:215], a[108:111], v[240:243], v[212:215]
    s_waitcnt lgkmcnt(6)
    ds_read2st64_b64 v[240:243], v4 offset0:56 offset1:60
    buffer_load_dword v21, off, s[8:11], s100 offset:0 sc1
    v_mfma_f32_16x16x32_bf16 v[200:203], a[144:147], v[244:247], v[200:203]
    ds_read_b64_tr_b16 a[178:179], v252 offset:21504
    v_mul_f32 v184, v24, v24
    v_mfma_f32_16x16x32_bf16 v[204:207], a[148:151], v[244:247], v[204:207]
    ds_read_b64_tr_b16 a[180:181], v253 offset:20480
    v_mul_f32 v185, v28, v28
    v_mfma_f32_16x16x32_bf16 v[208:211], a[152:155], v[244:247], v[208:211]
    buffer_load_dwordx4 v1, s[8:11], s57 offen offset:1024 sc1 lds
    ds_read_b64_tr_b16 a[182:183], v253 offset:21504
    v_mfma_f32_16x16x32_bf16 v[212:215], a[156:159], v[244:247], v[212:215]
    s_waitcnt lgkmcnt(8)
    ds_read2st64_b64 v[244:247], v4 offset0:80 offset1:84
    v_mul_f32 v186, v32, v32
    v_mfma_f32_16x16x32_bf16 v[200:203], a[16:19], v[232:235], v[200:203]
    ds_read_b64_tr_b16 a[184:185], v254 offset:20480
    v_mul_f32 v187, v36, v36
    v_mfma_f32_16x16x32_bf16 v[204:207], a[20:23], v[232:235], v[204:207]
    buffer_load_dwordx4 v1, s[8:11], s57 offen offset:2048 sc1 lds
    ds_read_b64_tr_b16 a[186:187], v254 offset:21504
    v_mfma_f32_16x16x32_bf16 v[208:211], a[24:27], v[232:235], v[208:211]
    ds_read_b64_tr_b16 a[188:189], v255 offset:20480
    v_fmac_f32 v184, v25, v25
    v_mfma_f32_16x16x32_bf16 v[212:215], a[28:31], v[232:235], v[212:215]
    s_waitcnt lgkmcnt(9)
    s_barrier
    ds_read2st64_b64 v[232:235], v4 offset0:16 offset1:20
    v_mfma_f32_16x16x32_bf16 v[200:203], a[64:67], v[236:239], v[200:203]
    buffer_load_dwordx4 v1, s[8:11], s57 offen offset:3072 sc1 lds
    ds_read_b64_tr_b16 a[190:191], v255 offset:21504
    v_mfma_f32_16x16x32_bf16 v[204:207], a[68:71], v[236:239], v[204:207]
    s_waitcnt vmcnt(13)
    ds_read_b64_tr_b16 a[192:193], v252 offset:0
    v_fmac_f32 v185, v29, v29
    v_mfma_f32_16x16x32_bf16 v[208:211], a[72:75], v[236:239], v[208:211]
    ds_read_b64_tr_b16 a[194:195], v252 offset:1024
    v_fmac_f32 v186, v33, v33
    v_mfma_f32_16x16x32_bf16 v[212:215], a[76:79], v[236:239], v[212:215]
    s_waitcnt lgkmcnt(11)
    ds_read2st64_b64 v[236:239], v4 offset0:40 offset1:44
    v_fmac_f32 v187, v37, v37
    v_mfma_f32_16x16x32_bf16 v[200:203], a[112:115], v[240:243], v[200:203]
    ds_read_b64_tr_b16 a[196:197], v253 offset:0
    v_fmac_f32 v184, v26, v26
    v_mfma_f32_16x16x32_bf16 v[204:207], a[116:119], v[240:243], v[204:207]
    ds_read_b64_tr_b16 a[198:199], v253 offset:1024
    v_fmac_f32 v185, v30, v30
    v_mfma_f32_16x16x32_bf16 v[208:211], a[120:123], v[240:243], v[208:211]
    ds_read_b64_tr_b16 a[200:201], v254 offset:0
    v_fmac_f32 v186, v34, v34
    v_mfma_f32_16x16x32_bf16 v[212:215], a[124:127], v[240:243], v[212:215]
    s_waitcnt lgkmcnt(11)
    ds_read2st64_b64 v[240:243], v4 offset0:64 offset1:68
    v_fmac_f32 v187, v38, v38
    v_mfma_f32_16x16x32_bf16 v[200:203], a[160:163], v[244:247], v[200:203]
    ds_read_b64_tr_b16 a[202:203], v254 offset:1024
    v_fmac_f32 v184, v27, v27
    v_mfma_f32_16x16x32_bf16 v[204:207], a[164:167], v[244:247], v[204:207]
    ds_read_b64_tr_b16 a[204:205], v255 offset:0
    v_fmac_f32 v185, v31, v31
    v_mfma_f32_16x16x32_bf16 v[208:211], a[168:171], v[244:247], v[208:211]
    ds_read_b64_tr_b16 a[206:207], v255 offset:1024
    v_fmac_f32 v186, v35, v35
    v_mfma_f32_16x16x32_bf16 v[212:215], a[172:175], v[244:247], v[212:215]
    s_waitcnt lgkmcnt(11)
    ds_read2st64_b64 v[244:247], v4 offset0:88 offset1:92
    v_fmac_f32 v187, v39, v39
    s_add_u32 s57, s56, 0
    buffer_load_dwordx4 v[24:27], v1, s[8:11], s57 offen offset:0 sc1
    v_mfma_f32_16x16x32_bf16 v[200:203], a[32:35], v[232:235], v[200:203]
    s_waitcnt vmcnt(10)
    ds_read_b64_tr_b16 a[208:209], v252 offset:4096
    v_fmac_f32 v184, v40, v40
    v_mfma_f32_16x16x32_bf16 v[204:207], a[36:39], v[232:235], v[204:207]
    buffer_load_dwordx4 v[28:31], v1, s[8:11], s57 offen offset:1024 sc1
    ds_read_b64_tr_b16 a[210:211], v252 offset:5120
    v_mfma_f32_16x16x32_bf16 v[208:211], a[40:43], v[232:235], v[208:211]
    ds_read_b64_tr_b16 a[212:213], v253 offset:4096
    v_fmac_f32 v185, v44, v44
    v_mfma_f32_16x16x32_bf16 v[212:215], a[44:47], v[232:235], v[212:215]
    s_waitcnt lgkmcnt(11)
    ds_read2st64_b64 v[232:235], v4 offset0:96 offset1:100
    v_fmac_f32 v186, v48, v48
    v_mfma_f32_16x16x32_bf16 v[200:203], a[80:83], v[236:239], v[200:203]
    buffer_load_dwordx4 v[32:35], v1, s[8:11], s57 offen offset:2048 sc1
    ds_read_b64_tr_b16 a[214:215], v253 offset:5120
    v_mfma_f32_16x16x32_bf16 v[204:207], a[84:87], v[236:239], v[204:207]
    ds_read_b64_tr_b16 a[216:217], v254 offset:4096
    v_fmac_f32 v187, v52, v52
    v_mfma_f32_16x16x32_bf16 v[208:211], a[88:91], v[236:239], v[208:211]
    ds_read_b64_tr_b16 a[218:219], v254 offset:5120
    v_fmac_f32 v184, v41, v41
    v_mfma_f32_16x16x32_bf16 v[212:215], a[92:95], v[236:239], v[212:215]
    s_waitcnt lgkmcnt(11)
    buffer_load_dwordx4 v[36:39], v1, s[8:11], s57 offen offset:3072 sc1
    ds_read2st64_b64 v[236:239], v4 offset0:104 offset1:108
    v_mfma_f32_16x16x32_bf16 v[200:203], a[128:131], v[240:243], v[200:203]
    ds_read_b64_tr_b16 a[220:221], v255 offset:4096
    v_fmac_f32 v185, v45, v45
    v_mfma_f32_16x16x32_bf16 v[204:207], a[132:135], v[240:243], v[204:207]
    ds_read_b64_tr_b16 a[222:223], v255 offset:5120
    v_fmac_f32 v186, v49, v49
    v_mfma_f32_16x16x32_bf16 v[208:211], a[136:139], v[240:243], v[208:211]
    v_fmac_f32 v187, v53, v53
    v_fmac_f32 v184, v42, v42
    v_mfma_f32_16x16x32_bf16 v[212:215], a[140:143], v[240:243], v[212:215]
    s_waitcnt lgkmcnt(10)
    ds_read2st64_b64 v[240:243], v5 offset0:0 offset1:4
    v_fmac_f32 v185, v46, v46
    v_mfma_f32_16x16x32_bf16 v[200:203], a[176:179], v[244:247], v[200:203]
    v_fmac_f32 v186, v50, v50
    v_fmac_f32 v187, v54, v54
    v_mfma_f32_16x16x32_bf16 v[204:207], a[180:183], v[244:247], v[204:207]
    v_fmac_f32 v184, v43, v43
    v_fmac_f32 v185, v47, v47
    v_mfma_f32_16x16x32_bf16 v[208:211], a[184:187], v[244:247], v[208:211]
    v_fmac_f32 v186, v51, v51
    v_fmac_f32 v187, v55, v55
    s_add_u32 s57, s56, 4096
    buffer_load_dwordx4 v[40:43], v1, s[8:11], s57 offen offset:0 sc1
    v_mfma_f32_16x16x32_bf16 v[212:215], a[188:191], v[244:247], v[212:215]
    s_waitcnt lgkmcnt(7)
    ds_read2st64_b64 v[244:247], v5 offset0:24 offset1:28
    v_fmac_f32 v184, v56, v56
    v_mfma_f32_16x16x32_bf16 v[200:203], a[192:195], v[232:235], v[200:203]
    buffer_load_dwordx4 v[44:47], v1, s[8:11], s57 offen offset:1024 sc1
    v_fmac_f32 v185, v60, v60
    v_mfma_f32_16x16x32_bf16 v[204:207], a[196:199], v[232:235], v[204:207]
    v_fmac_f32 v186, v64, v64
    v_fmac_f32 v187, v68, v68
    v_mfma_f32_16x16x32_bf16 v[208:211], a[200:203], v[232:235], v[208:211]
    v_fmac_f32 v184, v57, v57
    v_fmac_f32 v185, v61, v61
    v_mfma_f32_16x16x32_bf16 v[212:215], a[204:207], v[232:235], v[212:215]
    s_waitcnt lgkmcnt(4)
    buffer_load_dwordx4 v[48:51], v1, s[8:11], s57 offen offset:2048 sc1
    ds_read2st64_b64 v[232:235], v5 offset0:48 offset1:52
    v_mfma_f32_16x16x32_bf16 v[200:203], a[208:211], v[236:239], v[200:203]
    s_waitcnt vmcnt(10)
    v_cmp_ne_u32 vcc, 1, v21
    v_fmac_f32 v186, v65, v65
    v_mfma_f32_16x16x32_bf16 v[204:207], a[212:215], v[236:239], v[204:207]
    v_fmac_f32 v187, v69, v69
    v_fmac_f32 v184, v58, v58
    v_mfma_f32_16x16x32_bf16 v[208:211], a[216:219], v[236:239], v[208:211]
    s_waitcnt lgkmcnt(3)
    buffer_load_dwordx4 v[52:55], v1, s[8:11], s57 offen offset:3072 sc1
    v_fmac_f32 v185, v62, v62
    v_mfma_f32_16x16x32_bf16 v[212:215], a[220:223], v[236:239], v[212:215]
    s_waitcnt lgkmcnt(2)
    ds_read2st64_b64 v[236:239], v5 offset0:72 offset1:76
    v_fmac_f32 v186, v66, v66
    v_mfma_f32_16x16x32_bf16 v[216:219], a[0:3], v[240:243], 0
    s_cbranch_vccnz L_slow_14
L_back_15:
    v_cvt_pk_bf16_f32 v152, v200, v201
    v_mfma_f32_16x16x32_bf16 v[220:223], a[4:7], v[240:243], 0
    s_add_u32 m0, s60, 0
    s_add_u32 s57, s56, 32768
    buffer_load_dwordx4 v1, s[8:11], s57 offen offset:0 sc1 lds
    v_mfma_f32_16x16x32_bf16 v[224:227], a[8:11], v[240:243], 0
    v_cvt_pk_bf16_f32 v153, v202, v203
    v_cvt_pk_bf16_f32 v154, v204, v205
    v_mfma_f32_16x16x32_bf16 v[228:231], a[12:15], v[240:243], 0
    s_waitcnt lgkmcnt(2)
    ds_read2st64_b64 v[240:243], v5 offset0:8 offset1:12
    buffer_load_dwordx4 v1, s[8:11], s57 offen offset:1024 sc1 lds
    v_mfma_f32_16x16x32_bf16 v[216:219], a[48:51], v[244:247], v[216:219]
    v_cvt_pk_bf16_f32 v155, v206, v207
    v_pk_max_i16 v152, v152, 0
    v_mfma_f32_16x16x32_bf16 v[220:223], a[52:55], v[244:247], v[220:223]
    v_pk_max_i16 v153, v153, 0
    v_pk_max_i16 v154, v154, 0
    v_mfma_f32_16x16x32_bf16 v[224:227], a[56:59], v[244:247], v[224:227]
    buffer_load_dwordx4 v1, s[8:11], s57 offen offset:2048 sc1 lds
    v_mfma_f32_16x16x32_bf16 v[228:231], a[60:63], v[244:247], v[228:231]
    s_waitcnt lgkmcnt(2)
    ds_read2st64_b64 v[244:247], v5 offset0:32 offset1:36
    v_pk_max_i16 v155, v155, 0
    v_mfma_f32_16x16x32_bf16 v[216:219], a[96:99], v[232:235], v[216:219]
    v_fmac_f32 v187, v70, v70
    v_fmac_f32 v184, v59, v59
    v_mfma_f32_16x16x32_bf16 v[220:223], a[100:103], v[232:235], v[220:223]
    buffer_store_dwordx4 v[152:155], v1, s[8:11], s32 offen offset:0 sc1
    v_mfma_f32_16x16x32_bf16 v[224:227], a[104:107], v[232:235], v[224:227]
    v_cvt_pk_bf16_f32 v156, v208, v209
    v_cvt_pk_bf16_f32 v157, v210, v211
    v_mfma_f32_16x16x32_bf16 v[228:231], a[108:111], v[232:235], v[228:231]
    s_waitcnt lgkmcnt(2)
    ds_read2st64_b64 v[232:235], v5 offset0:56 offset1:60
    buffer_load_dwordx4 v1, s[8:11], s57 offen offset:3072 sc1 lds
    v_mfma_f32_16x16x32_bf16 v[216:219], a[144:147], v[236:239], v[216:219]
    v_cvt_pk_bf16_f32 v158, v212, v213
    v_cvt_pk_bf16_f32 v159, v214, v215
    v_mfma_f32_16x16x32_bf16 v[220:223], a[148:151], v[236:239], v[220:223]
    v_pk_max_i16 v156, v156, 0
    v_pk_max_i16 v157, v157, 0
    v_mfma_f32_16x16x32_bf16 v[224:227], a[152:155], v[236:239], v[224:227]
    v_pk_max_i16 v158, v158, 0
    v_pk_max_i16 v159, v159, 0
    v_mfma_f32_16x16x32_bf16 v[228:231], a[156:159], v[236:239], v[228:231]
    s_waitcnt lgkmcnt(2)
    buffer_store_dwordx4 v[156:159], v1, s[8:11], s32 offen offset:2048 sc1
    v_mfma_f32_16x16x32_bf16 v[216:219], a[16:19], v[240:243], v[216:219]
    ds_read2st64_b64 v[236:239], v5 offset0:80 offset1:84
    v_fmac_f32 v185, v63, v63
    v_mfma_f32_16x16x32_bf16 v[220:223], a[20:23], v[240:243], v[220:223]
    v_fmac_f32 v186, v67, v67
    v_fmac_f32 v187, v71, v71
    v_mfma_f32_16x16x32_bf16 v[224:227], a[24:27], v[240:243], v[224:227]
    s_add_u32 s57, s56, 8192
    buffer_load_dwordx4 v[56:59], v1, s[8:11], s57 offen offset:0 sc1
    v_mfma_f32_16x16x32_bf16 v[228:231], a[28:31], v[240:243], v[228:231]
    s_waitcnt lgkmcnt(2)
    ds_read2st64_b64 v[240:243], v5 offset0:16 offset1:20
    v_fmac_f32 v184, v72, v72
    v_mfma_f32_16x16x32_bf16 v[216:219], a[64:67], v[244:247], v[216:219]
    buffer_load_dwordx4 v[60:63], v1, s[8:11], s57 offen offset:1024 sc1
    v_fmac_f32 v185, v76, v76
    v_mfma_f32_16x16x32_bf16 v[220:223], a[68:71], v[244:247], v[220:223]
    v_fmac_f32 v186, v80, v80
    v_fmac_f32 v187, v84, v84
    v_mfma_f32_16x16x32_bf16 v[224:227], a[72:75], v[244:247], v[224:227]
    v_fmac_f32 v184, v73, v73
    v_fmac_f32 v185, v77, v77
    v_mfma_f32_16x16x32_bf16 v[228:231], a[76:79], v[244:247], v[228:231]
    s_waitcnt lgkmcnt(2)
    ds_read2st64_b64 v[244:247], v5 offset0:40 offset1:44
    buffer_load_dwordx4 v[64:67], v1, s[8:11], s57 offen offset:2048 sc1
    v_mfma_f32_16x16x32_bf16 v[216:219], a[112:115], v[232:235], v[216:219]
    v_fmac_f32 v186, v81, v81
    v_fmac_f32 v187, v85, v85
    v_mfma_f32_16x16x32_bf16 v[220:223], a[116:119], v[232:235], v[220:223]
    v_fmac_f32 v184, v74, v74
    v_fmac_f32 v185, v78, v78
    v_mfma_f32_16x16x32_bf16 v[224:227], a[120:123], v[232:235], v[224:227]
    buffer_load_dwordx4 v[68:71], v1, s[8:11], s57 offen offset:3072 sc1
    v_fmac_f32 v186, v82, v82
    v_mfma_f32_16x16x32_bf16 v[228:231], a[124:127], v[232:235], v[228:231]
    s_waitcnt lgkmcnt(2)
    ds_read2st64_b64 v[232:235], v5 offset0:64 offset1:68
    v_fmac_f32 v187, v86, v86
    v_mfma_f32_16x16x32_bf16 v[216:219], a[160:163], v[236:239], v[216:219]
    v_fmac_f32 v184, v75, v75
    v_fmac_f32 v185, v79, v79
    v_mfma_f32_16x16x32_bf16 v[220:223], a[164:167], v[236:239], v[220:223]
    s_add_u32 m0, s60, 4096
    s_add_u32 s57, s56, 36864
    buffer_load_dwordx4 v1, s[8:11], s57 offen offset:0 sc1 lds
    v_mfma_f32_16x16x32_bf16 v[224:227], a[168:171], v[236:239], v[224:227]
    v_fmac_f32 v186, v83, v83
    v_fmac_f32 v187, v87, v87
    v_mfma_f32_16x16x32_bf16 v[228:231], a[172:175], v[236:239], v[228:231]
    s_waitcnt lgkmcnt(2)
    ds_read2st64_b64 v[236:239], v5 offset0:88 offset1:92
    v_fmac_f32 v184, v88, v88
    v_mfma_f32_16x16x32_bf16 v[216:219], a[32:35], v[240:243], v[216:219]
    v_fmac_f32 v185, v92, v92
    v_fmac_f32 v186, v96, v96
    v_mfma_f32_16x16x32_bf16 v[220:223], a[36:39], v[240:243], v[220:223]
    buffer_load_dwordx4 v1, s[8:11], s57 offen offset:1024 sc1 lds
    v_fmac_f32 v187, v100, v100
    v_mfma_f32_16x16x32_bf16 v[224:227], a[40:43], v[240:243], v[224:227]
    v_permlane32_swap_b32 v194, v196
    v_permlane32_swap_b32 v195, v197
    v_mfma_f32_16x16x32_bf16 v[228:231], a[44:47], v[240:243], v[228:231]
    s_waitcnt lgkmcnt(2)
    ds_read2st64_b64 v[240:243], v5 offset0:96 offset1:100
    v_lshlrev_b32 v198, 2, v2
    v_mfma_f32_16x16x32_bf16 v[216:219], a[80:83], v[244:247], v[216:219]
    v_add_u32 v198, 158464, v198
    v_fmac_f32 v184, v89, v89
    v_mfma_f32_16x16x32_bf16 v[220:223], a[84:87], v[244:247], v[220:223]
    buffer_load_dwordx4 v1, s[8:11], s57 offen offset:2048 sc1 lds
    v_fmac_f32 v185, v93, v93
    v_mfma_f32_16x16x32_bf16 v[224:227], a[88:91], v[244:247], v[224:227]
    s_mov_b32 exec_lo, s96
    s_mov_b32 exec_hi, 0
    ds_write2_b32 v198, v192, v193 offset0:0 offset1:16
    s_mov_b64 exec, -1
    v_mfma_f32_16x16x32_bf16 v[228:231], a[92:95], v[244:247], v[228:231]
    s_waitcnt lgkmcnt(3)
    ds_read2st64_b64 v[244:247], v5 offset0:104 offset1:108
    v_fmac_f32 v186, v97, v97
    v_mfma_f32_16x16x32_bf16 v[216:219], a[128:131], v[232:235], v[216:219]
    s_mov_b32 exec_lo, s96
    s_mov_b32 exec_hi, 0
    ds_write2_b32 v198, v196, v197 offset0:32 offset1:48
    s_mov_b64 exec, -1
    v_mfma_f32_16x16x32_bf16 v[220:223], a[132:135], v[232:235], v[220:223]
    buffer_load_dwordx4 v1, s[8:11], s57 offen offset:3072 sc1 lds
    v_fmac_f32 v187, v101, v101
    v_mfma_f32_16x16x32_bf16 v[224:227], a[136:139], v[232:235], v[224:227]
    v_fmac_f32 v184, v90, v90
    v_fmac_f32 v185, v94, v94
    v_mfma_f32_16x16x32_bf16 v[228:231], a[140:143], v[232:235], v[228:231]
    s_waitcnt lgkmcnt(4)
    ds_read2st64_b64 v[232:235], v4 offset0:2 offset1:6
    v_fmac_f32 v186, v98, v98
    v_mfma_f32_16x16x32_bf16 v[216:219], a[176:179], v[236:239], v[216:219]
    v_fmac_f32 v187, v102, v102
    v_fmac_f32 v184, v91, v91
    v_mfma_f32_16x16x32_bf16 v[220:223], a[180:183], v[236:239], v[220:223]
    s_add_u32 s57, s56, 12288
    buffer_load_dwordx4 v[72:75], v1, s[8:11], s57 offen offset:0 sc1
    v_mfma_f32_16x16x32_bf16 v[224:227], a[184:187], v[236:239], v[224:227]
    v_fmac_f32 v185, v95, v95
    v_fmac_f32 v186, v99, v99
    v_mfma_f32_16x16x32_bf16 v[228:231], a[188:191], v[236:239], v[228:231]
    s_waitcnt lgkmcnt(4)
    ds_read2st64_b64 v[236:239], v4 offset0:26 offset1:30
    v_fmac_f32 v187, v103, v103
    v_mfma_f32_16x16x32_bf16 v[216:219], a[192:195], v[240:243], v[216:219]
    buffer_load_dwordx4 v[76:79], v1, s[8:11], s57 offen offset:1024 sc1
    v_fmac_f32 v184, v104, v104
    v_mfma_f32_16x16x32_bf16 v[220:223], a[196:199], v[240:243], v[220:223]
    v_fmac_f32 v185, v108, v108
    v_fmac_f32 v186, v112, v112
    v_mfma_f32_16x16x32_bf16 v[224:227], a[200:203], v[240:243], v[224:227]
    v_fmac_f32 v187, v116, v116
    v_fmac_f32 v184, v105, v105
    v_mfma_f32_16x16x32_bf16 v[228:231], a[204:207], v[240:243], v[228:231]
    s_waitcnt lgkmcnt(3)
    ds_read2st64_b64 v[240:243], v4 offset0:50 offset1:54
    v_fmac_f32 v185, v109, v109
    v_mfma_f32_16x16x32_bf16 v[216:219], a[208:211], v[244:247], v[216:219]
    buffer_load_dwordx4 v[80:83], v1, s[8:11], s57 offen offset:2048 sc1
    v_fmac_f32 v186, v113, v113
    v_mfma_f32_16x16x32_bf16 v[220:223], a[212:215], v[244:247], v[220:223]
    v_fmac_f32 v187, v117, v117
    v_fmac_f32 v184, v106, v106
    v_mfma_f32_16x16x32_bf16 v[224:227], a[216:219], v[244:247], v[224:227]
    v_fmac_f32 v185, v110, v110
    v_fmac_f32 v186, v114, v114
    v_mfma_f32_16x16x32_bf16 v[228:231], a[220:223], v[244:247], v[228:231]
    s_waitcnt lgkmcnt(2)
    ds_read2st64_b64 v[244:247], v4 offset0:74 offset1:78
    v_fmac_f32 v187, v118, v118
    v_mfma_f32_16x16x32_bf16 v[200:203], a[0:3], v[232:235], 0
    buffer_load_dwordx4 v[84:87], v1, s[8:11], s57 offen offset:3072 sc1
    v_cvt_pk_bf16_f32 v192, v216, v217
    v_mfma_f32_16x16x32_bf16 v[204:207], a[4:7], v[232:235], 0
    v_cvt_pk_bf16_f32 v193, v218, v219
    v_cvt_pk_bf16_f32 v194, v220, v221
    v_mfma_f32_16x16x32_bf16 v[208:211], a[8:11], v[232:235], 0
    v_cvt_pk_bf16_f32 v195, v222, v223
    v_fmac_f32 v184, v107, v107
    v_mfma_f32_16x16x32_bf16 v[212:215], a[12:15], v[232:235], 0
    s_waitcnt lgkmcnt(2)
    ds_read2st64_b64 v[232:235], v4 offset0:10 offset1:14
    v_pk_max_i16 v192, v192, 0
    v_mfma_f32_16x16x32_bf16 v[200:203], a[48:51], v[236:239], v[200:203]
    s_add_u32 s57, s56, 16384
    buffer_load_dwordx4 v[88:91], v1, s[8:11], s57 offen offset:0 sc1
    v_mfma_f32_16x16x32_bf16 v[204:207], a[52:55], v[236:239], v[204:207]
    v_pk_max_i16 v193, v193, 0
    v_fmac_f32 v185, v111, v111
    v_mfma_f32_16x16x32_bf16 v[208:211], a[56:59], v[236:239], v[208:211]
    v_pk_max_i16 v194, v194, 0
    v_pk_max_i16 v195, v195, 0
    v_mfma_f32_16x16x32_bf16 v[212:215], a[60:63], v[236:239], v[212:215]
    s_waitcnt lgkmcnt(2)
    ds_read2st64_b64 v[236:239], v4 offset0:34 offset1:38
    v_fmac_f32 v186, v115, v115
    v_mfma_f32_16x16x32_bf16 v[200:203], a[96:99], v[240:243], v[200:203]
    buffer_store_dwordx4 v[192:195], v1, s[8:11], s32 offen offset:1024 sc1
    v_mfma_f32_16x16x32_bf16 v[204:207], a[100:103], v[240:243], v[204:207]
    buffer_load_dword v21, off, s[8:11], s100 offset:512 sc1
    v_cvt_pk_bf16_f32 v196, v224, v225
    v_mfma_f32_16x16x32_bf16 v[208:211], a[104:107], v[240:243], v[208:211]
    v_fmac_f32 v187, v119, v119
    v_fmac_f32 v184, v120, v120
    v_mfma_f32_16x16x32_bf16 v[212:215], a[108:111], v[240:243], v[212:215]
    s_waitcnt lgkmcnt(2)
    ds_read2st64_b64 v[240:243], v4 offset0:58 offset1:62
    v_fmac_f32 v185, v124, v124
    v_mfma_f32_16x16x32_bf16 v[200:203], a[144:147], v[244:247], v[200:203]
    buffer_load_dwordx4 v[92:95], v1, s[8:11], s57 offen offset:1024 sc1
    v_cvt_pk_bf16_f32 v197, v226, v227
    v_mfma_f32_16x16x32_bf16 v[204:207], a[148:151], v[244:247], v[204:207]
    v_cvt_pk_bf16_f32 v198, v228, v229
    v_fmac_f32 v186, v128, v128
    v_mfma_f32_16x16x32_bf16 v[208:211], a[152:155], v[244:247], v[208:211]
    v_cvt_pk_bf16_f32 v199, v230, v231
    v_pk_max_i16 v196, v196, 0
    v_mfma_f32_16x16x32_bf16 v[212:215], a[156:159], v[244:247], v[212:215]
    s_waitcnt lgkmcnt(2)
    v_fmac_f32 v187, v132, v132
    v_pk_max_i16 v197, v197, 0
    v_pk_max_i16 v198, v198, 0
    v_mfma_f32_16x16x32_bf16 v[200:203], a[16:19], v[232:235], v[200:203]
    v_fmac_f32 v184, v121, v121
    v_pk_max_i16 v199, v199, 0
    buffer_store_dwordx4 v[196:199], v1, s[8:11], s32 offen offset:3072 sc1
    v_mfma_f32_16x16x32_bf16 v[204:207], a[20:23], v[232:235], v[204:207]
    v_fmac_f32 v185, v125, v125
    v_fmac_f32 v186, v129, v129
    v_mfma_f32_16x16x32_bf16 v[208:211], a[24:27], v[232:235], v[208:211]
    ds_read2st64_b64 v[244:247], v4 offset0:82 offset1:86
    buffer_load_dwordx4 v[96:99], v1, s[8:11], s57 offen offset:2048 sc1
    v_mfma_f32_16x16x32_bf16 v[212:215], a[28:31], v[232:235], v[212:215]
    s_waitcnt lgkmcnt(2)
    v_fmac_f32 v187, v133, v133
    v_fmac_f32 v184, v122, v122
    v_mfma_f32_16x16x32_bf16 v[200:203], a[64:67], v[236:239], v[200:203]
    ds_read2st64_b64 v[232:235], v4 offset0:18 offset1:22
    buffer_load_dwordx4 v[100:103], v1, s[8:11], s57 offen offset:3072 sc1
    v_mfma_f32_16x16x32_bf16 v[204:207], a[68:71], v[236:239], v[204:207]
    v_fmac_f32 v185, v126, v126
    v_fmac_f32 v186, v130, v130
    v_mfma_f32_16x16x32_bf16 v[208:211], a[72:75], v[236:239], v[208:211]
    v_fmac_f32 v187, v134, v134
    v_fmac_f32 v184, v123, v123
    v_mfma_f32_16x16x32_bf16 v[212:215], a[76:79], v[236:239], v[212:215]
    s_waitcnt lgkmcnt(2)
    ds_read2st64_b64 v[236:239], v4 offset0:42 offset1:46
    v_fmac_f32 v185, v127, v127
    v_mfma_f32_16x16x32_bf16 v[200:203], a[112:115], v[240:243], v[200:203]
    s_add_u32 s57, s56, 20480
    buffer_load_dwordx4 v[104:107], v1, s[8:11], s57 offen offset:0 sc1
    v_mfma_f32_16x16x32_bf16 v[204:207], a[116:119], v[240:243], v[204:207]
    v_fmac_f32 v186, v131, v131
    v_fmac_f32 v187, v135, v135
    v_permlane32_swap_b32 v184, v185
    s_nop 0
    v_permlane32_swap_b32 v186, v187
    v_add_f32 v184, v184, v185
    v_mfma_f32_16x16x32_bf16 v[208:211], a[120:123], v[240:243], v[208:211]
    v_add_f32 v186, v186, v187
    v_and_b32 v185, 1, v3
    v_mfma_f32_16x16x32_bf16 v[212:215], a[124:127], v[240:243], v[212:215]
    s_waitcnt lgkmcnt(2)
    buffer_load_dwordx4 v[108:111], v1, s[8:11], s57 offen offset:1024 sc1
    ds_read2st64_b64 v[240:243], v4 offset0:66 offset1:70
    v_mfma_f32_16x16x32_bf16 v[200:203], a[160:163], v[244:247], v[200:203]
    v_lshlrev_b32 v185, 9, v185
    v_lshrrev_b32 v187, 1, v3
    v_mfma_f32_16x16x32_bf16 v[204:207], a[164:167], v[244:247], v[204:207]
    buffer_load_dwordx4 v[112:115], v1, s[8:11], s57 offen offset:2048 sc1
    v_lshl_add_u32 v185, v187, 8, v185
    v_mfma_f32_16x16x32_bf16 v[208:211], a[168:171], v[244:247], v[208:211]
    v_permlane16_swap_b32 v184, v186
    v_lshl_add_u32 v185, v2, 4, v185
    v_mfma_f32_16x16x32_bf16 v[212:215], a[172:175], v[244:247], v[212:215]
    s_waitcnt lgkmcnt(2)
    ds_read2st64_b64 v[244:247], v4 offset0:90 offset1:94
    v_mfma_f32_16x16x32_bf16 v[200:203], a[32:35], v[232:235], v[200:203]
    buffer_load_dwordx4 v[116:119], v1, s[8:11], s57 offen offset:3072 sc1
    v_mfma_f32_16x16x32_bf16 v[204:207], a[36:39], v[232:235], v[204:207]
    s_lshl_b32 s36, s26, 2
    s_add_u32 s36, s36, 158720
    v_add_u32 v185, s36, v185
    v_mfma_f32_16x16x32_bf16 v[208:211], a[40:43], v[232:235], v[208:211]
    v_add_f32 v184, v184, v186
    v_mfma_f32_16x16x32_bf16 v[212:215], a[44:47], v[232:235], v[212:215]
    s_waitcnt lgkmcnt(2)
    ds_write_b32 v185, v184
    v_mfma_f32_16x16x32_bf16 v[200:203], a[80:83], v[236:239], v[200:203]
    ds_read2st64_b64 v[232:235], v4 offset0:98 offset1:102
    s_lshr_b32 s44, s26, 1
    v_mfma_f32_16x16x32_bf16 v[204:207], a[84:87], v[236:239], v[204:207]
    s_add_u32 m0, s60, 16384
    s_add_u32 s57, s56, 49152
    buffer_load_dwordx4 v1, s[8:11], s57 offen offset:0 sc1 lds
    v_mfma_f32_16x16x32_bf16 v[208:211], a[88:91], v[236:239], v[208:211]
    s_lshl_b32 s45, s26, 11
    v_add_u32 v6, s45, v1
    v_xor_b32 v15, 2048, v6
    v_mfma_f32_16x16x32_bf16 v[212:215], a[92:95], v[236:239], v[212:215]
    s_waitcnt lgkmcnt(3)
    v_xor_b32 v16, 4096, v6
    v_xor_b32 v17, 6144, v6
    v_mfma_f32_16x16x32_bf16 v[200:203], a[128:131], v[240:243], v[200:203]
    v_add_u32 v14, s60, v1
    s_lshl_b32 s45, s44, 4
    v_mfma_f32_16x16x32_bf16 v[204:207], a[132:135], v[240:243], v[204:207]
    v_add_u32 v22, s45, v2
    v_mul_u32_u24 v22, 57344, v22
    v_mfma_f32_16x16x32_bf16 v[208:211], a[136:139], v[240:243], v[208:211]
    ds_read2st64_b64 v[236:239], v4 offset0:106 offset1:110
    s_and_b32 s45, s26, 1
    v_mfma_f32_16x16x32_bf16 v[212:215], a[140:143], v[240:243], v[212:215]
    s_waitcnt lgkmcnt(3)
    s_lshl1_add_u32 s45, s25, s45
    s_lshl_b32 s46, s45, 6
    ds_read2st64_b64 v[240:243], v5 offset0:2 offset1:6
    v_mfma_f32_16x16x32_bf16 v[200:203], a[176:179], v[244:247], v[200:203]
    v_and_b32 v23, 1, v3
    v_lshl_add_u32 v23, v23, 5, s46
    v_mfma_f32_16x16x32_bf16 v[204:207], a[180:183], v[244:247], v[204:207]
    buffer_load_dwordx4 v1, s[8:11], s57 offen offset:1024 sc1 lds
    v_lshrrev_b32 v151, 1, v3
    v_lshl_add_u32 v23, v151, 4, v23
    v_mfma_f32_16x16x32_bf16 v[208:211], a[184:187], v[244:247], v[208:211]
    s_mul_i32 s46, s27, 896
    v_add3_u32 v7, v22, v23, s46
    s_sub_u32 s46, 2048, s28
    v_mfma_f32_16x16x32_bf16 v[212:215], a[188:191], v[244:247], v[212:215]
    s_waitcnt lgkmcnt(2)
    s_mul_i32 s46, s46, 896
    buffer_load_dwordx4 v1, s[8:11], s57 offen offset:2048 sc1 lds
    v_mfma_f32_16x16x32_bf16 v[200:203], a[192:195], v[232:235], v[200:203]
    s_barrier
    v_add_u32 v23, s46, v23
    v_sub_u32 v8, v23, v22
    v_mfma_f32_16x16x32_bf16 v[204:207], a[196:199], v[232:235], v[204:207]
    s_mov_b32 s46, 0x05040c0c
    s_cmp_lt_u32 s45, 7
    s_cselect_b64 s[42:43], -1, 0
    s_cselect_b32 s58, 0x01000c0c, s46
    s_cselect_b32 s47, 0, 256
    v_mfma_f32_16x16x32_bf16 v[208:211], a[200:203], v[232:235], v[208:211]
    ds_read2st64_b64 v[244:247], v5 offset0:26 offset1:30
    s_add_u32 s59, s58, 0x02020000
    s_lshl_b32 s46, s44, 9
    v_mfma_f32_16x16x32_bf16 v[212:215], a[204:207], v[232:235], v[212:215]
    s_waitcnt lgkmcnt(2)
    s_add_u32 s47, s47, s46
    s_lshl_b32 s45, s45, 3
    ds_read2st64_b64 v[232:235], v5 offset0:50 offset1:54
    v_mfma_f32_16x16x32_bf16 v[200:203], a[208:211], v[236:239], v[200:203]
    v_add3_u32 v22, s45, v3, 0
    v_sub_u32 v23, 111, v22
    v_mfma_f32_16x16x32_bf16 v[204:207], a[212:215], v[236:239], v[204:207]
    s_waitcnt vmcnt(11)
    buffer_load_dwordx4 v1, s[8:11], s57 offen offset:3072 sc1 lds
    v_cmp_ne_u32 vcc, 1, v21
    v_cndmask_b32 v22, v23, v22, s[42:43]
    v_subrev_u32 v151, 55, v23
    v_mfma_f32_16x16x32_bf16 v[208:211], a[216:219], v[236:239], v[208:211]
    v_ashrrev_i32 v151, 31, v151
    v_add_u32 v23, 1, v23
    v_mfma_f32_16x16x32_bf16 v[212:215], a[220:223], v[236:239], v[212:215]
    s_waitcnt lgkmcnt(2)
    v_and_b32 v23, v23, v151
    v_lshrrev_b32 v151, 2, v22
    v_mfma_f32_16x16x32_bf16 v[160:163], a[0:3], v[240:243], 0
    s_cbranch_vccnz L_slow_18
L_back_19:
    v_lshl_add_u32 v9, v151, 12, s47
    v_and_b32 v151, 1, v22
    v_mfma_f32_16x16x32_bf16 v[164:167], a[4:7], v[240:243], 0
    s_add_u32 s57, s56, 24576
    buffer_load_dwordx4 v[120:123], v1, s[8:11], s57 offen offset:0 sc1
    v_lshl_add_u32 v9, v151, 11, v9
    v_bfe_u32 v151, v22, 1, 1
    v_mfma_f32_16x16x32_bf16 v[176:179], a[8:11], v[240:243], 0
    ds_read2st64_b64 v[236:239], v5 offset0:74 offset1:78
    v_lshl_add_u32 v9, v151, 7, v9
    v_lshl_add_u32 v9, v2, 3, v9
    v_mfma_f32_16x16x32_bf16 v[180:183], a[12:15], v[240:243], 0
    s_waitcnt lgkmcnt(2)
    v_lshrrev_b32 v151, 2, v23
    v_lshl_add_u32 v10, v151, 12, s47
    v_mfma_f32_16x16x32_bf16 v[160:163], a[48:51], v[244:247], v[160:163]
    buffer_load_dwordx4 v[124:127], v1, s[8:11], s57 offen offset:1024 sc1
    v_and_b32 v151, 1, v23
    v_lshl_add_u32 v10, v151, 11, v10
    v_mfma_f32_16x16x32_bf16 v[164:167], a[52:55], v[244:247], v[164:167]
    v_bfe_u32 v151, v23, 1, 1
    v_lshl_add_u32 v10, v151, 7, v10
    v_mfma_f32_16x16x32_bf16 v[176:179], a[56:59], v[244:247], v[176:179]
    ds_read2st64_b64 v[240:243], v5 offset0:10 offset1:14
    v_lshl_add_u32 v10, v2, 3, v10
    v_add3_u32 v22, s45, v3, 4
    v_mfma_f32_16x16x32_bf16 v[180:183], a[60:63], v[244:247], v[180:183]
    s_waitcnt lgkmcnt(2)
    v_sub_u32 v23, 111, v22
    v_cndmask_b32 v22, v23, v22, s[42:43]
    v_mfma_f32_16x16x32_bf16 v[160:163], a[96:99], v[232:235], v[160:163]
    buffer_load_dwordx4 v[128:131], v1, s[8:11], s57 offen offset:2048 sc1
    v_subrev_u32 v151, 55, v23
    v_ashrrev_i32 v151, 31, v151
    v_cvt_pk_bf16_f32 v184, v200, v201
    v_cvt_pk_bf16_f32 v185, v202, v203
    v_mfma_f32_16x16x32_bf16 v[164:167], a[100:103], v[232:235], v[164:167]
    v_add_u32 v23, 1, v23
    v_and_b32 v23, v23, v151
    v_cvt_pk_bf16_f32 v186, v204, v205
    v_cvt_pk_bf16_f32 v187, v206, v207
    v_mfma_f32_16x16x32_bf16 v[176:179], a[104:107], v[232:235], v[176:179]
    ds_read2st64_b64 v[244:247], v5 offset0:34 offset1:38
    v_lshrrev_b32 v151, 2, v22
    v_lshl_add_u32 v11, v151, 12, s47
    v_pk_max_i16 v184, v184, 0
    v_pk_max_i16 v185, v185, 0
    v_mfma_f32_16x16x32_bf16 v[180:183], a[108:111], v[232:235], v[180:183]
    s_waitcnt lgkmcnt(2)
    v_and_b32 v151, 1, v22
    v_lshl_add_u32 v11, v151, 11, v11
    v_pk_max_i16 v186, v186, 0
    v_pk_max_i16 v187, v187, 0
    v_mfma_f32_16x16x32_bf16 v[160:163], a[144:147], v[236:239], v[160:163]
    buffer_load_dwordx4 v[132:135], v1, s[8:11], s57 offen offset:3072 sc1
    buffer_store_dwordx4 v[184:187], v1, s[8:11], s33 offen offset:0 sc1
    v_bfe_u32 v151, v22, 1, 1
    v_lshl_add_u32 v11, v151, 7, v11
    v_cvt_pk_bf16_f32 v188, v208, v209
    v_mfma_f32_16x16x32_bf16 v[164:167], a[148:151], v[236:239], v[164:167]
    v_lshl_add_u32 v11, v2, 3, v11
    v_lshrrev_b32 v151, 2, v23
    v_cvt_pk_bf16_f32 v189, v210, v211
    v_cvt_pk_bf16_f32 v190, v212, v213
    v_mfma_f32_16x16x32_bf16 v[176:179], a[152:155], v[236:239], v[176:179]
    ds_read2st64_b64 v[232:235], v5 offset0:58 offset1:62
    v_lshl_add_u32 v12, v151, 12, s47
    v_and_b32 v151, 1, v23
    v_cvt_pk_bf16_f32 v191, v214, v215
    v_pk_max_i16 v188, v188, 0
    v_mfma_f32_16x16x32_bf16 v[180:183], a[156:159], v[236:239], v[180:183]
    s_waitcnt lgkmcnt(2)
    v_lshl_add_u32 v12, v151, 11, v12
    v_bfe_u32 v151, v23, 1, 1
    v_pk_max_i16 v189, v189, 0
    v_pk_max_i16 v190, v190, 0
    v_mfma_f32_16x16x32_bf16 v[160:163], a[16:19], v[240:243], v[160:163]
    s_add_u32 m0, s60, 20480
    s_add_u32 s57, s56, 53248
    buffer_load_dwordx4 v1, s[8:11], s57 offen offset:0 sc1 lds
    v_lshl_add_u32 v12, v151, 7, v12
    v_lshl_add_u32 v12, v2, 3, v12
    v_pk_max_i16 v191, v191, 0
    buffer_store_dwordx4 v[188:191], v1, s[8:11], s33 offen offset:2048 sc1
    v_mfma_f32_16x16x32_bf16 v[164:167], a[20:23], v[240:243], v[164:167]
    s_lshr_b32 s36, s26, 1
    s_lshl_b32 s36, s36, 6
    v_lshl_add_u32 v22, v2, 2, s36
    v_lshlrev_b32 v23, 2, v22
    v_mfma_f32_16x16x32_bf16 v[176:179], a[24:27], v[240:243], v[176:179]
    ds_read2st64_b64 v[236:239], v5 offset0:82 offset1:86
    v_add_u32 v23, 158720, v23
    v_add_u32 v22, 158464, v22
    v_mfma_f32_16x16x32_bf16 v[180:183], a[28:31], v[240:243], v[180:183]
    s_waitcnt lgkmcnt(2)
    ds_read_b128 v[140:143], v23
    ds_read_b32 v150, v22
    v_mfma_f32_16x16x32_bf16 v[160:163], a[64:67], v[244:247], v[160:163]
    ds_read_b64 v[144:145], v9 offset:0
    buffer_load_dwordx4 v1, s[8:11], s57 offen offset:1024 sc1 lds
    v_mfma_f32_16x16x32_bf16 v[164:167], a[68:71], v[244:247], v[164:167]
    ds_read_b32 v148, v10 offset:0
    ds_read_b64 v[146:147], v11 offset:0
    v_mfma_f32_16x16x32_bf16 v[176:179], a[72:75], v[244:247], v[176:179]
    ds_read2st64_b64 v[240:243], v5 offset0:18 offset1:22
    ds_read_b32 v149, v12 offset:0
    v_mov_b32 v151, 0x3727c5ac
    v_mfma_f32_16x16x32_bf16 v[180:183], a[76:79], v[244:247], v[180:183]
    s_waitcnt lgkmcnt(8)
    buffer_load_dwordx4 v1, s[8:11], s57 offen offset:2048 sc1 lds
    ds_read2st64_b64 v[244:247], v5 offset0:42 offset1:46
    v_mfma_f32_16x16x32_bf16 v[160:163], a[112:115], v[232:235], v[160:163]
    v_mfma_f32_16x16x32_bf16 v[164:167], a[116:119], v[232:235], v[164:167]
    buffer_load_dwordx4 v1, s[8:11], s57 offen offset:3072 sc1 lds
    v_mfma_f32_16x16x32_bf16 v[176:179], a[120:123], v[232:235], v[176:179]
    s_waitcnt lgkmcnt(7)
    v_add_f32 v140, v140, v141
    v_add_f32 v142, v142, v143
    v_add_f32 v140, v140, v142
    v_fmac_f32 v151, 0x3b124925, v140
    v_rsq_f32 v18, v151
    v_mfma_f32_16x16x32_bf16 v[180:183], a[124:127], v[232:235], v[180:183]
    ds_read2st64_b64 v[232:235], v5 offset0:66 offset1:70
    v_mfma_f32_16x16x32_bf16 v[160:163], a[160:163], v[236:239], v[160:163]
    s_waitcnt lgkmcnt(5)
    v_perm_b32 v136, v148, v144, s58
    v_perm_b32 v137, v145, v144, s59
    v_perm_b32 v138, v145, v145, s58
    v_perm_b32 v139, v144, v145, s59
    v_mfma_f32_16x16x32_bf16 v[164:167], a[164:167], v[236:239], v[164:167]
    s_waitcnt lgkmcnt(2)
    v_perm_b32 v140, v149, v146, s58
    v_perm_b32 v141, v147, v146, s59
    v_perm_b32 v142, v147, v147, s58
    v_mfma_f32_16x16x32_bf16 v[176:179], a[168:171], v[236:239], v[176:179]
    v_perm_b32 v143, v146, v147, s59
    v_mul_f32 v151, v151, v18
    v_mfma_f32_16x16x32_bf16 v[180:183], a[172:175], v[236:239], v[180:183]
    v_mul_f32 v150, v150, v151
    v_fma_f32 v136, v136, v151, v150
    v_mfma_f32_16x16x32_bf16 v[160:163], a[32:35], v[240:243], v[160:163]
    s_add_u32 s57, s56, 28672
    buffer_load_dwordx4 a[240:243], v1, s[8:11], s57 offen offset:0 sc1
    v_fma_f32 v137, v137, v151, v150
    v_mfma_f32_16x16x32_bf16 v[164:167], a[36:39], v[240:243], v[164:167]
    v_fma_f32 v138, v138, v151, v150
    v_fma_f32 v139, v139, v151, v150
    v_mfma_f32_16x16x32_bf16 v[176:179], a[40:43], v[240:243], v[176:179]
    ds_read2st64_b64 v[236:239], v5 offset0:90 offset1:94
    v_fma_f32 v140, v140, v151, v150
    v_mfma_f32_16x16x32_bf16 v[180:183], a[44:47], v[240:243], v[180:183]
    s_waitcnt lgkmcnt(2)
    v_fma_f32 v141, v141, v151, v150
    v_fma_f32 v142, v142, v151, v150
    v_mfma_f32_16x16x32_bf16 v[160:163], a[80:83], v[244:247], v[160:163]
    buffer_load_dwordx4 a[244:247], v1, s[8:11], s57 offen offset:1024 sc1
    v_fma_f32 v143, v143, v151, v150
    v_mfma_f32_16x16x32_bf16 v[164:167], a[84:87], v[244:247], v[164:167]
    s_lshr_b32 s36, s26, 1
    s_lshl_b32 s36, s36, 6
    v_lshl_add_u32 v22, v2, 2, s36
    v_lshlrev_b32 v23, 2, v22
    v_mfma_f32_16x16x32_bf16 v[176:179], a[88:91], v[244:247], v[176:179]
    ds_read2st64_b64 v[240:243], v5 offset0:98 offset1:102
    v_add_u32 v23, 159232, v23
    v_add_u32 v22, 158592, v22
    v_mfma_f32_16x16x32_bf16 v[180:183], a[92:95], v[244:247], v[180:183]
    s_waitcnt lgkmcnt(2)
    ds_read_b128 v[172:175], v23
    ds_read_b32 v150, v22
    v_mfma_f32_16x16x32_bf16 v[160:163], a[128:131], v[232:235], v[160:163]
    ds_read_b64 v[144:145], v9 offset:1024
    ds_read_b32 v148, v10 offset:1024
    buffer_load_dwordx4 a[248:251], v1, s[8:11], s57 offen offset:2048 sc1
    v_mfma_f32_16x16x32_bf16 v[164:167], a[132:135], v[232:235], v[164:167]
    ds_read_b64 v[146:147], v11 offset:1024
    ds_read_b32 v149, v12 offset:1024
    v_mfma_f32_16x16x32_bf16 v[176:179], a[136:139], v[232:235], v[176:179]
    ds_read2st64_b64 v[244:247], v5 offset0:106 offset1:110
    v_mov_b32 v151, 0x3727c5ac
    v_mfma_f32_16x16x32_bf16 v[180:183], a[140:143], v[232:235], v[180:183]
    s_waitcnt lgkmcnt(8)
    s_add_u32 s63, s34, s49
    buffer_load_dwordx4 v[216:219], v1, s[8:11], s63 offen offset:0 sc1
    v_mfma_f32_16x16x32_bf16 v[160:163], a[176:179], v[236:239], v[160:163]
    buffer_load_dwordx4 a[252:255], v1, s[8:11], s57 offen offset:3072 sc1
    v_mfma_f32_16x16x32_bf16 v[164:167], a[180:183], v[236:239], v[164:167]
    v_mfma_f32_16x16x32_bf16 v[176:179], a[184:187], v[236:239], v[176:179]
    s_waitcnt lgkmcnt(6)
    v_add_f32 v172, v172, v173
    v_add_f32 v174, v174, v175
    v_add_f32 v172, v172, v174
    v_fmac_f32 v151, 0x3b124925, v172
    v_rsq_f32 v19, v151
    v_mfma_f32_16x16x32_bf16 v[180:183], a[188:191], v[236:239], v[180:183]
    s_waitcnt lgkmcnt(3)
    buffer_load_dwordx4 v[220:223], v1, s[8:11], s63 offen offset:2048 sc1
    v_perm_b32 v168, v148, v144, s58
    v_perm_b32 v169, v145, v144, s59
    v_perm_b32 v170, v145, v145, s58
    v_perm_b32 v171, v144, v145, s59
    v_mfma_f32_16x16x32_bf16 v[160:163], a[192:195], v[240:243], v[160:163]
    s_waitcnt lgkmcnt(1)
    v_perm_b32 v172, v149, v146, s58
    v_perm_b32 v173, v147, v146, s59
    v_perm_b32 v174, v147, v147, s58
    v_perm_b32 v175, v146, v147, s59
    v_mfma_f32_16x16x32_bf16 v[164:167], a[196:199], v[240:243], v[164:167]
    v_mul_f32 v151, v151, v19
    v_mul_f32 v150, v150, v151
    v_mfma_f32_16x16x32_bf16 v[176:179], a[200:203], v[240:243], v[176:179]
    v_fma_f32 v168, v168, v151, v150
    v_fma_f32 v169, v169, v151, v150
    v_mfma_f32_16x16x32_bf16 v[180:183], a[204:207], v[240:243], v[180:183]
    s_waitcnt lgkmcnt(0)
    s_add_u32 s63, s34, s50
    buffer_load_dwordx4 v[224:227], v1, s[8:11], s63 offen offset:0 sc1
    v_fma_f32 v170, v170, v151, v150
    v_fma_f32 v171, v171, v151, v150
    v_mfma_f32_16x16x32_bf16 v[160:163], a[208:211], v[244:247], v[160:163]
    v_fma_f32 v172, v172, v151, v150
    v_fma_f32 v173, v173, v151, v150
    v_mfma_f32_16x16x32_bf16 v[164:167], a[212:215], v[244:247], v[164:167]
    v_fma_f32 v174, v174, v151, v150
    v_fma_f32 v175, v175, v151, v150
    v_mfma_f32_16x16x32_bf16 v[176:179], a[216:219], v[244:247], v[176:179]
    buffer_load_dwordx4 v[228:231], v1, s[8:11], s63 offen offset:2048 sc1
    v_mfma_f32_16x16x32_bf16 v[180:183], a[220:223], v[244:247], v[180:183]
    v_mfma_f32_16x16x32_bf16 v[136:139], v[24:27], v[152:155], v[136:139]
    s_add_u32 s63, s34, s49
    buffer_load_dwordx4 v[200:203], v1, s[8:11], s63 offen offset:1024 sc1
    v_mfma_f32_16x16x32_bf16 v[140:143], v[28:31], v[152:155], v[140:143]
    v_cvt_pk_bf16_f32 v248, v160, v161
    v_cvt_pk_bf16_f32 v249, v162, v163
    v_mfma_f32_16x16x32_bf16 v[144:147], v[32:35], v[152:155], 0
    v_cvt_pk_bf16_f32 v250, v164, v165
    v_cvt_pk_bf16_f32 v251, v166, v167
    v_mfma_f32_16x16x32_bf16 v[148:151], v[36:39], v[152:155], 0
    buffer_load_dwordx4 v[204:207], v1, s[8:11], s63 offen offset:3072 sc1
    v_pk_max_i16 v248, v248, 0
    v_mfma_f32_16x16x32_bf16 v[136:139], v[40:43], v[156:159], v[136:139]
    v_pk_max_i16 v249, v249, 0
    v_pk_max_i16 v250, v250, 0
    v_mfma_f32_16x16x32_bf16 v[140:143], v[44:47], v[156:159], v[140:143]
    v_pk_max_i16 v251, v251, 0
    v_cvt_pk_bf16_f32 v252, v176, v177
    v_mfma_f32_16x16x32_bf16 v[144:147], v[48:51], v[156:159], v[144:147]
    s_add_u32 s63, s34, s50
    buffer_load_dwordx4 v[208:211], v1, s[8:11], s63 offen offset:1024 sc1
    v_mfma_f32_16x16x32_bf16 v[148:151], v[52:55], v[156:159], v[148:151]
    v_cvt_pk_bf16_f32 v253, v178, v179
    v_cvt_pk_bf16_f32 v254, v180, v181
    v_mfma_f32_16x16x32_bf16 v[152:155], v[24:27], v[192:195], 0
    v_cvt_pk_bf16_f32 v255, v182, v183
    v_pk_max_i16 v252, v252, 0
    v_mfma_f32_16x16x32_bf16 v[156:159], v[28:31], v[192:195], 0
    buffer_load_dwordx4 v[212:215], v1, s[8:11], s63 offen offset:3072 sc1
    v_pk_max_i16 v253, v253, 0
    v_mfma_f32_16x16x32_bf16 v[160:163], v[32:35], v[192:195], 0
    ds_read_b128 v[232:235], v14 offset:0
    v_pk_max_i16 v254, v254, 0
    v_mfma_f32_16x16x32_bf16 v[164:167], v[36:39], v[192:195], 0
    v_pk_max_i16 v255, v255, 0
    v_mfma_f32_16x16x32_bf16 v[152:155], v[40:43], v[196:199], v[152:155]
    buffer_store_dwordx4 v[248:251], v1, s[8:11], s33 offen offset:1024 sc1
    v_mfma_f32_16x16x32_bf16 v[156:159], v[44:47], v[196:199], v[156:159]
    ds_read_b128 v[236:239], v14 offset:1024
    v_mfma_f32_16x16x32_bf16 v[160:163], v[48:51], v[196:199], v[160:163]
    buffer_store_dwordx4 v[252:255], v1, s[8:11], s33 offen offset:3072 sc1
    v_mfma_f32_16x16x32_bf16 v[164:167], v[52:55], v[196:199], v[164:167]
    v_mfma_f32_16x16x32_bf16 v[168:171], v[24:27], v[184:187], v[168:171]
    ds_read_b128 v[240:243], v14 offset:2048
    v_mfma_f32_16x16x32_bf16 v[172:175], v[28:31], v[184:187], v[172:175]
    s_mov_b32 s3, s37
    buffer_load_dword v23, off, s[8:11], s3 offset:1024 sc1
    v_mfma_f32_16x16x32_bf16 v[176:179], v[32:35], v[184:187], 0
    v_mfma_f32_16x16x32_bf16 v[180:183], v[36:39], v[184:187], 0
    ds_read_b128 v[244:247], v14 offset:3072
    v_mfma_f32_16x16x32_bf16 v[168:171], v[40:43], v[188:191], v[168:171]
    s_barrier
    v_mfma_f32_16x16x32_bf16 v[172:175], v[44:47], v[188:191], v[172:175]
    v_mfma_f32_16x16x32_bf16 v[176:179], v[48:51], v[188:191], v[176:179]
    v_mfma_f32_16x16x32_bf16 v[180:183], v[52:55], v[188:191], v[180:183]
    s_waitcnt vmcnt(11)
    v_or_b32 v21, v216, v217
    v_mfma_f32_16x16x32_bf16 v[184:187], v[24:27], v[248:251], 0
    v_or3_b32 v21, v21, v218, v219
    v_mfma_f32_16x16x32_bf16 v[188:191], v[28:31], v[248:251], 0
    s_waitcnt vmcnt(6)
    v_or3_b32 v21, v21, v200, v201
    v_mfma_f32_16x16x32_bf16 v[192:195], v[32:35], v[248:251], 0
    v_or3_b32 v21, v21, v202, v203
    v_mfma_f32_16x16x32_bf16 v[196:199], v[36:39], v[248:251], 0
    v_cmp_gt_i32 vcc, 0, v21
    v_mfma_f32_16x16x32_bf16 v[184:187], v[40:43], v[252:255], v[184:187]
    v_mfma_f32_16x16x32_bf16 v[188:191], v[44:47], v[252:255], v[188:191]
    s_cbranch_vccnz L_slow_22
L_back_23:
    v_mfma_f32_16x16x32_bf16 v[192:195], v[48:51], v[252:255], v[192:195]
    v_mfma_f32_16x16x32_bf16 v[196:199], v[52:55], v[252:255], v[196:199]
    s_waitcnt lgkmcnt(3)
    s_add_u32 s63, s34, s51
    buffer_load_dwordx4 v[24:27], v1, s[8:11], s63 offen offset:0 sc1
    v_mfma_f32_16x16x32_bf16 v[136:139], v[232:235], v[216:219], v[136:139]
    s_waitcnt lgkmcnt(2)
    v_or_b32 v21, v220, v221
    v_or3_b32 v21, v21, v222, v223
    v_mfma_f32_16x16x32_bf16 v[140:143], v[236:239], v[216:219], v[140:143]
    s_waitcnt vmcnt(6) lgkmcnt(1)
    buffer_load_dwordx4 v[28:31], v1, s[8:11], s63 offen offset:1024 sc1
    v_or3_b32 v21, v21, v204, v205
    v_mfma_f32_16x16x32_bf16 v[144:147], v[240:243], v[216:219], v[144:147]
    s_waitcnt lgkmcnt(0)
    v_or3_b32 v21, v21, v206, v207
    v_mfma_f32_16x16x32_bf16 v[148:151], v[244:247], v[216:219], v[148:151]
    v_cmp_gt_i32 vcc, 0, v21
    v_mfma_f32_16x16x32_bf16 v[152:155], v[232:235], v[200:203], v[152:155]
    ds_read_b128 v[232:235], v14 offset:4096
    buffer_load_dwordx4 v[32:35], v1, s[8:11], s63 offen offset:2048 sc1
    v_mfma_f32_16x16x32_bf16 v[156:159], v[236:239], v[200:203], v[156:159]
    ds_read_b128 v[236:239], v14 offset:5120
    v_mfma_f32_16x16x32_bf16 v[160:163], v[240:243], v[200:203], v[160:163]
    ds_read_b128 v[240:243], v14 offset:6144
    v_mfma_f32_16x16x32_bf16 v[164:167], v[244:247], v[200:203], v[164:167]
    s_cbranch_vccnz L_slow_25
L_back_26:
    ds_read_b128 v[244:247], v14 offset:7168
    v_mfma_f32_16x16x32_bf16 v[136:139], v[56:59], v[220:223], v[136:139]
    buffer_load_dwordx4 v[36:39], v1, s[8:11], s63 offen offset:3072 sc1
    v_or_b32 v21, v224, v225
    v_mfma_f32_16x16x32_bf16 v[140:143], v[60:63], v[220:223], v[140:143]
    s_waitcnt vmcnt(8)
    v_or3_b32 v21, v21, v226, v227
    v_or3_b32 v21, v21, v208, v209
    v_mfma_f32_16x16x32_bf16 v[144:147], v[64:67], v[220:223], v[144:147]
    s_add_u32 s63, s34, s52
    buffer_load_dwordx4 v[40:43], v1, s[8:11], s63 offen offset:0 sc1
    v_mfma_f32_16x16x32_bf16 v[148:151], v[68:71], v[220:223], v[148:151]
    v_or3_b32 v21, v21, v210, v211
    v_cmp_gt_i32 vcc, 0, v21
    v_mfma_f32_16x16x32_bf16 v[152:155], v[56:59], v[204:207], v[152:155]
    v_mfma_f32_16x16x32_bf16 v[156:159], v[60:63], v[204:207], v[156:159]
    buffer_load_dwordx4 v[44:47], v1, s[8:11], s63 offen offset:1024 sc1
    v_mfma_f32_16x16x32_bf16 v[160:163], v[64:67], v[204:207], v[160:163]
    s_cbranch_vccnz L_slow_28
L_back_29:
    v_mfma_f32_16x16x32_bf16 v[164:167], v[68:71], v[204:207], v[164:167]
    s_waitcnt lgkmcnt(3)
    v_or_b32 v21, v228, v229
    v_mfma_f32_16x16x32_bf16 v[136:139], v[232:235], v[224:227], v[136:139]
    s_waitcnt lgkmcnt(2)
    buffer_load_dwordx4 v[48:51], v1, s[8:11], s63 offen offset:2048 sc1
    v_or3_b32 v21, v21, v230, v231
    v_mfma_f32_16x16x32_bf16 v[140:143], v[236:239], v[224:227], v[140:143]
    s_waitcnt vmcnt(10) lgkmcnt(1)
    v_or3_b32 v21, v21, v212, v213
    v_mfma_f32_16x16x32_bf16 v[144:147], v[240:243], v[224:227], v[144:147]
    s_waitcnt lgkmcnt(0)
    v_or3_b32 v21, v21, v214, v215
    v_mfma_f32_16x16x32_bf16 v[148:151], v[244:247], v[224:227], v[148:151]
    buffer_load_dwordx4 v[52:55], v1, s[8:11], s63 offen offset:3072 sc1
    v_cmp_gt_i32 vcc, 0, v21
    v_mfma_f32_16x16x32_bf16 v[152:155], v[232:235], v[208:211], v[152:155]
    ds_read_b128 v[232:235], v14 offset:8192
    v_mfma_f32_16x16x32_bf16 v[156:159], v[236:239], v[208:211], v[156:159]
    ds_read_b128 v[236:239], v14 offset:9216
    v_mfma_f32_16x16x32_bf16 v[160:163], v[240:243], v[208:211], v[160:163]
    ds_read_b128 v[240:243], v14 offset:10240
    v_mfma_f32_16x16x32_bf16 v[164:167], v[244:247], v[208:211], v[164:167]
    s_cbranch_vccnz L_slow_31
L_back_32:
    ds_read_b128 v[244:247], v14 offset:11264
    v_mfma_f32_16x16x32_bf16 v[136:139], v[72:75], v[228:231], v[136:139]
    s_add_u32 s63, s34, s53
    buffer_load_dwordx4 v[248:251], v1, s[8:11], s63 offen offset:0 sc1
    v_mfma_f32_16x16x32_bf16 v[140:143], v[76:79], v[228:231], v[140:143]
    s_waitcnt vmcnt(8)
    v_or_b32 v21, v24, v25
    v_or3_b32 v21, v21, v26, v27
    v_mfma_f32_16x16x32_bf16 v[144:147], v[80:83], v[228:231], v[144:147]
    s_waitcnt vmcnt(7)
    buffer_load_dwordx4 v[252:255], v1, s[8:11], s63 offen offset:1024 sc1
    v_or3_b32 v21, v21, v28, v29
    v_mfma_f32_16x16x32_bf16 v[148:151], v[84:87], v[228:231], v[148:151]
    v_or3_b32 v21, v21, v30, v31
    v_cmp_gt_i32 vcc, 0, v21
    v_mfma_f32_16x16x32_bf16 v[152:155], v[72:75], v[212:215], v[152:155]
    v_mfma_f32_16x16x32_bf16 v[156:159], v[76:79], v[212:215], v[156:159]
    buffer_load_dwordx4 v[216:219], v1, s[8:11], s63 offen offset:2048 sc1
    v_mfma_f32_16x16x32_bf16 v[160:163], v[80:83], v[212:215], v[160:163]
    s_cbranch_vccnz L_slow_34
L_back_35:
    v_mfma_f32_16x16x32_bf16 v[164:167], v[84:87], v[212:215], v[164:167]
    s_waitcnt vmcnt(8) lgkmcnt(3)
    v_or_b32 v21, v32, v33
    v_mfma_f32_16x16x32_bf16 v[136:139], v[232:235], v[24:27], v[136:139]
    s_waitcnt lgkmcnt(2)
    buffer_load_dwordx4 v[200:203], v1, s[8:11], s63 offen offset:3072 sc1
    v_or3_b32 v21, v21, v34, v35
    v_mfma_f32_16x16x32_bf16 v[140:143], v[236:239], v[24:27], v[140:143]
    s_waitcnt vmcnt(8) lgkmcnt(1)
    v_or3_b32 v21, v21, v36, v37
    v_mfma_f32_16x16x32_bf16 v[144:147], v[240:243], v[24:27], v[144:147]
    s_waitcnt lgkmcnt(0)
    v_or3_b32 v21, v21, v38, v39
    v_mfma_f32_16x16x32_bf16 v[148:151], v[244:247], v[24:27], v[148:151]
    s_add_u32 s63, s34, s54
    buffer_load_dwordx4 v[220:223], v1, s[8:11], s63 offen offset:0 sc1
    v_mfma_f32_16x16x32_bf16 v[152:155], v[232:235], v[28:31], v[152:155]
    v_cmp_gt_i32 vcc, 0, v21
    v_mfma_f32_16x16x32_bf16 v[156:159], v[236:239], v[28:31], v[156:159]
    ds_read_b128 v[232:235], v14 offset:12288
    v_mfma_f32_16x16x32_bf16 v[160:163], v[240:243], v[28:31], v[160:163]
    ds_read_b128 v[236:239], v14 offset:13312
    v_mfma_f32_16x16x32_bf16 v[164:167], v[244:247], v[28:31], v[164:167]
    s_cbranch_vccnz L_slow_37
L_back_38:
    ds_read_b128 v[240:243], v14 offset:14336
    v_mfma_f32_16x16x32_bf16 v[136:139], v[88:91], v[32:35], v[136:139]
    ds_read_b128 v[244:247], v14 offset:15360
    buffer_load_dwordx4 v[204:207], v1, s[8:11], s63 offen offset:1024 sc1
    v_mfma_f32_16x16x32_bf16 v[140:143], v[92:95], v[32:35], v[140:143]
    s_waitcnt vmcnt(9)
    v_or_b32 v21, v40, v41
    v_or3_b32 v21, v21, v42, v43
    v_mfma_f32_16x16x32_bf16 v[144:147], v[96:99], v[32:35], v[144:147]
    s_waitcnt vmcnt(8)
    v_or3_b32 v21, v21, v44, v45
    v_or3_b32 v21, v21, v46, v47
    v_mfma_f32_16x16x32_bf16 v[148:151], v[100:103], v[32:35], v[148:151]
    buffer_load_dwordx4 v[224:227], v1, s[8:11], s63 offen offset:2048 sc1
    v_cmp_gt_i32 vcc, 0, v21
    v_mfma_f32_16x16x32_bf16 v[152:155], v[88:91], v[36:39], v[152:155]
    v_cmp_ne_u32 s[32:33], 32, v23
    v_mfma_f32_16x16x32_bf16 v[156:159], v[92:95], v[36:39], v[156:159]
    v_mfma_f32_16x16x32_bf16 v[160:163], v[96:99], v[36:39], v[160:163]
    s_cbranch_vccnz L_slow_40
L_back_41:
    v_mfma_f32_16x16x32_bf16 v[164:167], v[100:103], v[36:39], v[164:167]
    s_waitcnt vmcnt(8) lgkmcnt(3)
    buffer_load_dwordx4 v[208:211], v1, s[8:11], s63 offen offset:3072 sc1
    v_or_b32 v21, v48, v49
    v_mfma_f32_16x16x32_bf16 v[136:139], v[232:235], v[40:43], v[136:139]
    s_waitcnt lgkmcnt(2)
    v_or3_b32 v21, v21, v50, v51
    v_mfma_f32_16x16x32_bf16 v[140:143], v[236:239], v[40:43], v[140:143]
    s_waitcnt vmcnt(8) lgkmcnt(1)
    v_or3_b32 v21, v21, v52, v53
    v_mfma_f32_16x16x32_bf16 v[144:147], v[240:243], v[40:43], v[144:147]
    s_waitcnt lgkmcnt(0)
    v_or3_b32 v21, v21, v54, v55
    v_mfma_f32_16x16x32_bf16 v[148:151], v[244:247], v[40:43], v[148:151]
    s_add_u32 s63, s35, s49
    buffer_load_dwordx4 v[228:231], v1, s[8:11], s63 offen offset:0 sc1
    v_mfma_f32_16x16x32_bf16 v[152:155], v[232:235], v[44:47], v[152:155]
    v_cmp_gt_i32 vcc, 0, v21
    v_mfma_f32_16x16x32_bf16 v[156:159], v[236:239], v[44:47], v[156:159]
    ds_read_b128 v[232:235], v14 offset:16384
    v_mfma_f32_16x16x32_bf16 v[160:163], v[240:243], v[44:47], v[160:163]
    s_cmp_lg_u64 s[32:33], 0
    s_cbranch_scc1 L_slowh
L_backh:
    v_mfma_f32_16x16x32_bf16 v[164:167], v[244:247], v[44:47], v[164:167]
    s_cbranch_vccnz L_slow_43
L_back_44:
    ds_read_b128 v[236:239], v14 offset:17408
    v_mfma_f32_16x16x32_bf16 v[136:139], v[104:107], v[48:51], v[136:139]
    ds_read_b128 v[240:243], v14 offset:18432
    buffer_load_dwordx4 v[212:215], v1, s[8:11], s63 offen offset:1024 sc1
    v_mfma_f32_16x16x32_bf16 v[140:143], v[108:111], v[48:51], v[140:143]
    s_waitcnt vmcnt(9)
    ds_read_b128 v[244:247], v14 offset:19456
    v_or_b32 v21, v248, v249
    v_mfma_f32_16x16x32_bf16 v[144:147], v[112:115], v[48:51], v[144:147]
    s_waitcnt vmcnt(8)
    v_or3_b32 v21, v21, v250, v251
    v_or3_b32 v21, v21, v252, v253
    v_mfma_f32_16x16x32_bf16 v[148:151], v[116:119], v[48:51], v[148:151]
    buffer_load_dwordx4 v[24:27], v1, s[8:11], s63 offen offset:2048 sc1
    v_or3_b32 v21, v21, v254, v255
    v_mfma_f32_16x16x32_bf16 v[152:155], v[104:107], v[52:55], v[152:155]
    v_cmp_gt_i32 vcc, 0, v21
    v_mfma_f32_16x16x32_bf16 v[156:159], v[108:111], v[52:55], v[156:159]
    s_lshl_b32 s36, s26, 8
    s_add_u32 s3, s36, s27
    s_mul_i32 s3, s3, 896
    s_add_u32 s100, s36, s28
    s_sub_u32 s100, 2048, s100
    s_mul_i32 s100, s100, 896
    s_mul_i32 s101, s26, 3712
    s_add_u32 s3, s3, 10182656
    s_add_u32 s100, s100, 10182656
    v_mfma_f32_16x16x32_bf16 v[160:163], v[112:115], v[52:55], v[160:163]
    s_waitcnt vmcnt(8)
    s_cbranch_vccnz L_slow_46
L_back_47:
    v_or_b32 v21, v216, v217
    v_mfma_f32_16x16x32_bf16 v[164:167], v[116:119], v[52:55], v[164:167]
    s_waitcnt lgkmcnt(3)
    buffer_load_dwordx4 v[28:31], v1, s[8:11], s63 offen offset:3072 sc1
    v_or3_b32 v21, v21, v218, v219
    v_mfma_f32_16x16x32_bf16 v[136:139], v[232:235], v[248:251], v[136:139]
    s_waitcnt vmcnt(8) lgkmcnt(2)
    v_or3_b32 v21, v21, v200, v201
    v_or3_b32 v21, v21, v202, v203
    v_mfma_f32_16x16x32_bf16 v[140:143], v[236:239], v[248:251], v[140:143]
    s_waitcnt lgkmcnt(1)
    v_cmp_gt_i32 vcc, 0, v21
    v_mfma_f32_16x16x32_bf16 v[144:147], v[240:243], v[248:251], v[144:147]
    s_waitcnt lgkmcnt(0)
    s_cmp_eq_u32 s31, 0
    s_cselect_b32 s40, 0xfefefefe, -1
    s_mov_b32 s41, s40
    v_mfma_f32_16x16x32_bf16 v[148:151], v[244:247], v[248:251], v[148:151]
    s_add_u32 s63, s35, s50
    buffer_load_dwordx4 v[32:35], v1, s[8:11], s63 offen offset:0 sc1
    v_mfma_f32_16x16x32_bf16 v[152:155], v[232:235], v[252:255], v[152:155]
    ds_read_b128 v[232:235], v14 offset:20480
    s_mov_b32 s42, 0x22222222
    v_mfma_f32_16x16x32_bf16 v[156:159], v[236:239], v[252:255], v[156:159]
    s_cbranch_vccnz L_slow_49
L_back_50:
    ds_read_b128 v[236:239], v14 offset:21504
    v_mfma_f32_16x16x32_bf16 v[160:163], v[240:243], v[252:255], v[160:163]
    s_waitcnt vmcnt(8)
    ds_read_b128 v[240:243], v14 offset:22528
    v_or_b32 v21, v220, v221
    v_mfma_f32_16x16x32_bf16 v[164:167], v[244:247], v[252:255], v[164:167]
    ds_read_b128 v[244:247], v14 offset:23552
    buffer_load_dwordx4 v[36:39], v1, s[8:11], s63 offen offset:1024 sc1
    v_mfma_f32_16x16x32_bf16 v[152:155], v[120:123], v[200:203], v[152:155]
    v_or3_b32 v21, v21, v222, v223
    s_waitcnt vmcnt(8)
    v_or3_b32 v21, v21, v204, v205
    v_or3_b32 v21, v21, v206, v207
    s_waitcnt vmcnt(7)
    v_or3_b32 v21, v21, v224, v225
    v_or3_b32 v21, v21, v226, v227
    s_waitcnt vmcnt(6)
    v_or3_b32 v21, v21, v208, v209
    v_or3_b32 v21, v21, v210, v211
    v_cmp_gt_i32 vcc, 0, v21
    v_mfma_f32_16x16x32_bf16 v[156:159], v[124:127], v[200:203], v[156:159]
    s_mov_b32 s43, 0x22222222
    s_mov_b32 s44, 0x44444444
    s_mov_b32 s45, 0x44444444
    v_mfma_f32_16x16x32_bf16 v[160:163], v[128:131], v[200:203], v[160:163]
    s_cbranch_vccnz L_slow_52
L_back_53:
    v_mfma_f32_16x16x32_bf16 v[164:167], v[132:135], v[200:203], v[164:167]
    buffer_load_dwordx4 v[40:43], v1, s[8:11], s63 offen offset:2048 sc1
    s_mov_b32 s46, 0x88888888
    v_mfma_f32_16x16x32_bf16 v[152:155], a[240:243], v[208:211], v[152:155]
    s_mov_b32 s47, 0x88888888
    v_mfma_f32_16x16x32_bf16 v[156:159], a[244:247], v[208:211], v[156:159]
    v_mfma_f32_16x16x32_bf16 v[160:163], a[248:251], v[208:211], v[160:163]
    v_mfma_f32_16x16x32_bf16 v[164:167], a[252:255], v[208:211], v[164:167]
    s_waitcnt lgkmcnt(3)
    buffer_load_dwordx4 v[44:47], v1, s[8:11], s63 offen offset:3072 sc1
    v_mfma_f32_16x16x32_bf16 v[152:155], v[232:235], v[204:207], v[152:155]
    s_waitcnt lgkmcnt(2)
    v_mfma_f32_16x16x32_bf16 v[156:159], v[236:239], v[204:207], v[156:159]
    s_waitcnt lgkmcnt(1)
    v_mfma_f32_16x16x32_bf16 v[160:163], v[240:243], v[204:207], v[160:163]
    s_waitcnt lgkmcnt(0)
    v_mfma_f32_16x16x32_bf16 v[164:167], v[244:247], v[204:207], v[164:167]
    s_add_u32 s63, s35, s51
    buffer_load_dwordx4 v[48:51], v1, s[8:11], s63 offen offset:0 sc1
    v_mfma_f32_16x16x32_bf16 v[144:147], v[240:243], v[220:223], v[144:147]
    ds_read_b128 v[240:243], v14 offset:2048
    v_mfma_f32_16x16x32_bf16 v[148:151], v[244:247], v[220:223], v[148:151]
    ds_write_b128 v16, v[152:155] offset:8192
    v_mfma_f32_16x16x32_bf16 v[144:147], v[128:131], v[216:219], v[144:147]
    ds_read_b128 v[244:247], v14 offset:3072
    v_mfma_f32_16x16x32_bf16 v[148:151], v[132:135], v[216:219], v[148:151]
    ds_write_b128 v16, v[156:159] offset:9216
    v_mfma_f32_16x16x32_bf16 v[144:147], a[248:251], v[224:227], v[144:147]
    s_waitcnt vmcnt(8)
    buffer_load_dwordx4 v[52:55], v1, s[8:11], s63 offen offset:1024 sc1
    v_or_b32 v21, v228, v229
    v_mfma_f32_16x16x32_bf16 v[148:151], a[252:255], v[224:227], v[148:151]
    s_waitcnt vmcnt(8)
    v_or3_b32 v21, v21, v230, v231
    v_or3_b32 v21, v21, v212, v213
    v_mfma_f32_16x16x32_bf16 v[136:139], v[232:235], v[220:223], v[136:139]
    ds_read_b128 v[232:235], v14 offset:0
    v_or3_b32 v21, v21, v214, v215
    v_mfma_f32_16x16x32_bf16 v[140:143], v[236:239], v[220:223], v[140:143]
    ds_read_b128 v[236:239], v14 offset:1024
    buffer_load_dwordx4 v[248:251], v1, s[8:11], s63 offen offset:2048 sc1
    v_mfma_f32_16x16x32_bf16 v[136:139], v[120:123], v[216:219], v[136:139]
    v_cmp_gt_i32 vcc, 0, v21
    v_mfma_f32_16x16x32_bf16 v[140:143], v[124:127], v[216:219], v[140:143]
    ds_write_b128 v17, v[160:163] offset:16384
    v_mfma_f32_16x16x32_bf16 v[136:139], a[240:243], v[224:227], v[136:139]
    ds_write_b128 v17, v[164:167] offset:17408
    v_mfma_f32_16x16x32_bf16 v[140:143], a[244:247], v[224:227], v[140:143]
    s_waitcnt lgkmcnt(3)
    s_cbranch_vccnz L_slow_55
L_back_56:
    buffer_load_dwordx4 v[252:255], v1, s[8:11], s63 offen offset:3072 sc1
    v_mfma_f32_16x16x32_bf16 v[168:171], v[232:235], v[228:231], v[168:171]
    s_waitcnt vmcnt(9) lgkmcnt(2)
    v_or_b32 v21, v24, v25
    v_or3_b32 v21, v21, v26, v27
    v_mfma_f32_16x16x32_bf16 v[172:175], v[236:239], v[228:231], v[172:175]
    ds_write_b128 v15, v[144:147] offset:0
    v_mfma_f32_16x16x32_bf16 v[176:179], v[240:243], v[228:231], v[176:179]
    s_waitcnt vmcnt(8)
    v_or3_b32 v21, v21, v28, v29
    v_or3_b32 v21, v21, v30, v31
    v_mfma_f32_16x16x32_bf16 v[180:183], v[244:247], v[228:231], v[180:183]
    ds_write_b128 v15, v[148:151] offset:1024
    v_mfma_f32_16x16x32_bf16 v[184:187], v[232:235], v[212:215], v[184:187]
    v_cmp_gt_i32 vcc, 0, v21
    v_mfma_f32_16x16x32_bf16 v[188:191], v[236:239], v[212:215], v[188:191]
    ds_read_b128 v[232:235], v14 offset:4096
    v_mfma_f32_16x16x32_bf16 v[192:195], v[240:243], v[212:215], v[192:195]
    ds_read_b128 v[236:239], v14 offset:5120
    v_mfma_f32_16x16x32_bf16 v[196:199], v[244:247], v[212:215], v[196:199]
    s_cbranch_vccnz L_slow_58
L_back_59:
    ds_read_b128 v[240:243], v14 offset:6144
    v_mfma_f32_16x16x32_bf16 v[168:171], v[56:59], v[24:27], v[168:171]
    s_waitcnt vmcnt(7)
    ds_read_b128 v[244:247], v14 offset:7168
    v_or_b32 v21, v32, v33
    v_mfma_f32_16x16x32_bf16 v[172:175], v[60:63], v[24:27], v[172:175]
    s_add_u32 s63, s35, s52
    buffer_load_dwordx4 v[216:219], v1, s[8:11], s63 offen offset:0 sc1
    v_mfma_f32_16x16x32_bf16 v[176:179], v[64:67], v[24:27], v[176:179]
    s_waitcnt vmcnt(7)
    v_or3_b32 v21, v21, v34, v35
    v_or3_b32 v21, v21, v36, v37
    v_mfma_f32_16x16x32_bf16 v[180:183], v[68:71], v[24:27], v[180:183]
    buffer_load_dwordx4 v[200:203], v1, s[8:11], s63 offen offset:1024 sc1
    v_or3_b32 v21, v21, v38, v39
    v_mfma_f32_16x16x32_bf16 v[184:187], v[56:59], v[28:31], v[184:187]
    v_cmp_gt_i32 vcc, 0, v21
    v_mfma_f32_16x16x32_bf16 v[188:191], v[60:63], v[28:31], v[188:191]
    s_waitcnt lgkmcnt(4)
    s_barrier
    ds_read_b128 v[144:147], v6 offset:0
    v_mfma_f32_16x16x32_bf16 v[192:195], v[64:67], v[28:31], v[192:195]
    ds_read_b128 v[148:151], v6 offset:1024
    buffer_load_dwordx4 v[220:223], v1, s[8:11], s63 offen offset:2048 sc1
    v_mfma_f32_16x16x32_bf16 v[196:199], v[68:71], v[28:31], v[196:199]
    s_waitcnt lgkmcnt(5)
    s_cbranch_vccnz L_slow_61
L_back_62:
    ds_read_b128 v[152:155], v6 offset:8192
    v_mfma_f32_16x16x32_bf16 v[168:171], v[232:235], v[32:35], v[168:171]
    s_waitcnt vmcnt(8) lgkmcnt(5)
    ds_read_b128 v[156:159], v6 offset:9216
    v_or_b32 v21, v40, v41
    v_mfma_f32_16x16x32_bf16 v[172:175], v[236:239], v[32:35], v[172:175]
    s_waitcnt lgkmcnt(5)
    ds_read_b128 v[160:163], v6 offset:16384
    buffer_load_dwordx4 v[204:207], v1, s[8:11], s63 offen offset:3072 sc1
    v_mfma_f32_16x16x32_bf16 v[176:179], v[240:243], v[32:35], v[176:179]
    s_waitcnt lgkmcnt(5)
    ds_read_b128 v[164:167], v6 offset:17408
    v_or3_b32 v21, v21, v42, v43
    v_mfma_f32_16x16x32_bf16 v[180:183], v[244:247], v[32:35], v[180:183]
    s_waitcnt vmcnt(8)
    v_or3_b32 v21, v21, v44, v45
    v_or3_b32 v21, v21, v46, v47
    v_mfma_f32_16x16x32_bf16 v[184:187], v[232:235], v[36:39], v[184:187]
    s_waitcnt lgkmcnt(5)
    v_cmp_gt_i32 vcc, 0, v21
    v_add_f32 v136, v136, v144
    v_mfma_f32_16x16x32_bf16 v[188:191], v[236:239], v[36:39], v[188:191]
    ds_read_b128 v[232:235], v14 offset:8192
    v_add_f32 v137, v137, v145
    v_mfma_f32_16x16x32_bf16 v[192:195], v[240:243], v[36:39], v[192:195]
    ds_read_b128 v[236:239], v14 offset:9216
    v_add_f32 v138, v138, v146
    v_mfma_f32_16x16x32_bf16 v[196:199], v[244:247], v[36:39], v[196:199]
    s_cbranch_vccnz L_slow_64
L_back_65:
    ds_read_b128 v[240:243], v14 offset:10240
    v_mfma_f32_16x16x32_bf16 v[168:171], v[72:75], v[40:43], v[168:171]
    ds_read_b128 v[244:247], v14 offset:11264
    v_add_f32 v139, v139, v147
    v_mfma_f32_16x16x32_bf16 v[172:175], v[76:79], v[40:43], v[172:175]
    s_add_u32 s63, s35, s53
    buffer_load_dwordx4 v[224:227], v1, s[8:11], s63 offen offset:0 sc1
    v_mfma_f32_16x16x32_bf16 v[176:179], v[80:83], v[40:43], v[176:179]
    s_waitcnt vmcnt(8)
    v_or_b32 v21, v48, v49
    v_or3_b32 v21, v21, v50, v51
    v_mfma_f32_16x16x32_bf16 v[180:183], v[84:87], v[40:43], v[180:183]
    s_waitcnt vmcnt(7)
    buffer_load_dwordx4 v[208:211], v1, s[8:11], s63 offen offset:1024 sc1
    v_or3_b32 v21, v21, v52, v53
    v_mfma_f32_16x16x32_bf16 v[184:187], v[72:75], v[44:47], v[184:187]
    s_waitcnt lgkmcnt(8)
    v_or3_b32 v21, v21, v54, v55
    v_cmp_gt_i32 vcc, 0, v21
    v_add_f32 v140, v140, v148
    v_mfma_f32_16x16x32_bf16 v[188:191], v[76:79], v[44:47], v[188:191]
    v_add_f32 v141, v141, v149
    v_add_f32 v142, v142, v150
    v_mfma_f32_16x16x32_bf16 v[192:195], v[80:83], v[44:47], v[192:195]
    buffer_load_dwordx4 v[228:231], v1, s[8:11], s63 offen offset:2048 sc1
    v_add_f32 v143, v143, v151
    v_mfma_f32_16x16x32_bf16 v[196:199], v[84:87], v[44:47], v[196:199]
    s_waitcnt lgkmcnt(3)
    s_cbranch_vccnz L_slow_67
L_back_68:
    v_add_f32 v136, v136, v152
    v_mfma_f32_16x16x32_bf16 v[168:171], v[232:235], v[48:51], v[168:171]
    s_waitcnt lgkmcnt(2)
    v_add_f32 v137, v137, v153
    v_add_f32 v138, v138, v154
    v_mfma_f32_16x16x32_bf16 v[172:175], v[236:239], v[48:51], v[172:175]
    s_waitcnt vmcnt(8) lgkmcnt(1)
    buffer_load_dwordx4 v[212:215], v1, s[8:11], s63 offen offset:3072 sc1
    v_or_b32 v21, v248, v249
    v_mfma_f32_16x16x32_bf16 v[176:179], v[240:243], v[48:51], v[176:179]
    s_waitcnt vmcnt(8) lgkmcnt(0)
    v_or3_b32 v21, v21, v250, v251
    v_or3_b32 v21, v21, v252, v253
    v_mfma_f32_16x16x32_bf16 v[180:183], v[244:247], v[48:51], v[180:183]
    v_or3_b32 v21, v21, v254, v255
    v_cmp_gt_i32 vcc, 0, v21
    v_mfma_f32_16x16x32_bf16 v[184:187], v[232:235], v[52:55], v[184:187]
    v_add_f32 v139, v139, v155
    v_add_f32 v140, v140, v156
    v_mfma_f32_16x16x32_bf16 v[188:191], v[236:239], v[52:55], v[188:191]
    ds_read_b128 v[232:235], v14 offset:12288
    v_add_f32 v141, v141, v157
    v_mfma_f32_16x16x32_bf16 v[192:195], v[240:243], v[52:55], v[192:195]
    ds_read_b128 v[236:239], v14 offset:13312
    v_add_f32 v142, v142, v158
    v_mfma_f32_16x16x32_bf16 v[196:199], v[244:247], v[52:55], v[196:199]
    s_cbranch_vccnz L_slow_70
L_back_71:
    ds_read_b128 v[240:243], v14 offset:14336
    v_mfma_f32_16x16x32_bf16 v[168:171], v[88:91], v[248:251], v[168:171]
    v_add_f32 v143, v143, v159
    v_add_f32 v136, v136, v160
    v_mfma_f32_16x16x32_bf16 v[172:175], v[92:95], v[248:251], v[172:175]
    ds_read_b128 v[244:247], v14 offset:15360
    v_add_f32 v137, v137, v161
    v_mfma_f32_16x16x32_bf16 v[176:179], v[96:99], v[248:251], v[176:179]
    s_add_u32 s63, s35, s54
    buffer_load_dwordx4 v[24:27], v1, s[8:11], s63 offen offset:0 sc1
    v_mfma_f32_16x16x32_bf16 v[180:183], v[100:103], v[248:251], v[180:183]
    s_waitcnt vmcnt(8)
    v_or_b32 v21, v216, v217
    v_or3_b32 v21, v21, v218, v219
    v_mfma_f32_16x16x32_bf16 v[184:187], v[88:91], v[252:255], v[184:187]
    s_waitcnt vmcnt(7)
    v_or3_b32 v21, v21, v200, v201
    v_or3_b32 v21, v21, v202, v203
    v_cmp_gt_i32 vcc, 0, v21
    v_add_f32 v138, v138, v162
    v_mfma_f32_16x16x32_bf16 v[188:191], v[92:95], v[252:255], v[188:191]
    v_add_f32 v139, v139, v163
    v_add_f32 v140, v140, v164
    v_mfma_f32_16x16x32_bf16 v[192:195], v[96:99], v[252:255], v[192:195]
    buffer_load_dwordx4 v[28:31], v1, s[8:11], s63 offen offset:1024 sc1
    v_add_f32 v141, v141, v165
    v_mfma_f32_16x16x32_bf16 v[196:199], v[100:103], v[252:255], v[196:199]
    s_waitcnt lgkmcnt(3)
    s_cbranch_vccnz L_slow_73
L_back_74:
    v_add_f32 v142, v142, v166
    v_mfma_f32_16x16x32_bf16 v[168:171], v[232:235], v[216:219], v[168:171]
    s_waitcnt lgkmcnt(2)
    buffer_load_dwordx4 v[32:35], v1, s[8:11], s63 offen offset:2048 sc1
    v_add_f32 v143, v143, v167
    v_mfma_f32_16x16x32_bf16 v[172:175], v[236:239], v[216:219], v[172:175]
    s_waitcnt lgkmcnt(1)
    v_mul_f32 v136, v136, v18
    v_mul_f32 v137, v137, v18
    v_mfma_f32_16x16x32_bf16 v[176:179], v[240:243], v[216:219], v[176:179]
    s_waitcnt vmcnt(8) lgkmcnt(0)
    v_or_b32 v21, v220, v221
    v_or3_b32 v21, v21, v222, v223
    v_mfma_f32_16x16x32_bf16 v[180:183], v[244:247], v[216:219], v[180:183]
    s_waitcnt vmcnt(7)
    buffer_load_dwordx4 v[36:39], v1, s[8:11], s63 offen offset:3072 sc1
    v_or3_b32 v21, v21, v204, v205
    v_mfma_f32_16x16x32_bf16 v[184:187], v[232:235], v[200:203], v[184:187]
    v_or3_b32 v21, v21, v206, v207
    v_cmp_gt_i32 vcc, 0, v21
    v_mul_f32 v138, v138, v18
    v_mfma_f32_16x16x32_bf16 v[188:191], v[236:239], v[200:203], v[188:191]
    ds_read_b128 v[232:235], v14 offset:16384
    v_mul_f32 v139, v139, v18
    v_mfma_f32_16x16x32_bf16 v[192:195], v[240:243], v[200:203], v[192:195]
    ds_read_b128 v[236:239], v14 offset:17408
    v_mul_f32 v140, v140, v18
    v_mfma_f32_16x16x32_bf16 v[196:199], v[244:247], v[200:203], v[196:199]
    s_cbranch_vccnz L_slow_76
L_back_77:
    ds_read_b128 v[240:243], v14 offset:18432
    v_mfma_f32_16x16x32_bf16 v[168:171], v[104:107], v[220:223], v[168:171]
    v_mul_f32 v141, v141, v18
    v_mul_f32 v142, v142, v18
    v_mfma_f32_16x16x32_bf16 v[172:175], v[108:111], v[220:223], v[172:175]
    ds_read_b128 v[244:247], v14 offset:19456
    v_mul_f32 v143, v143, v18
    v_mfma_f32_16x16x32_bf16 v[176:179], v[112:115], v[220:223], v[176:179]
    s_waitcnt vmcnt(7)
    v_cvt_pk_bf16_f32 v144, v136, v137
    v_or_b32 v21, v224, v225
    v_mfma_f32_16x16x32_bf16 v[180:183], v[116:119], v[220:223], v[180:183]
    s_waitcnt vmcnt(6)
    v_or3_b32 v21, v21, v226, v227
    v_or3_b32 v21, v21, v208, v209
    v_mfma_f32_16x16x32_bf16 v[184:187], v[104:107], v[204:207], v[184:187]
    v_or3_b32 v21, v21, v210, v211
    v_cmp_gt_i32 vcc, 0, v21
    v_cvt_pk_bf16_f32 v146, v140, v141
    v_mfma_f32_16x16x32_bf16 v[188:191], v[108:111], v[204:207], v[188:191]
    v_cvt_pk_bf16_f32 v145, v138, v139
    v_cvt_pk_bf16_f32 v147, v142, v143
    v_mfma_f32_16x16x32_bf16 v[192:195], v[112:115], v[204:207], v[192:195]
    s_cbranch_vccnz L_slow_79
L_back_80:
    v_permlane16_swap_b32 v144, v146
    v_mfma_f32_16x16x32_bf16 v[196:199], v[116:119], v[204:207], v[196:199]
    s_waitcnt vmcnt(5) lgkmcnt(3)
    v_permlane16_swap_b32 v145, v147
    v_or_b32 v21, v228, v229
    v_mfma_f32_16x16x32_bf16 v[168:171], v[232:235], v[224:227], v[168:171]
    s_waitcnt lgkmcnt(2)
    s_mov_b32 s36, 10182656
    buffer_store_dwordx4 v[144:147], v7, s[8:11], s36 offen sc1
    v_mfma_f32_16x16x32_bf16 v[172:175], v[236:239], v[224:227], v[172:175]
    s_waitcnt vmcnt(5) lgkmcnt(1)
    v_or3_b32 v21, v21, v230, v231
    v_or3_b32 v21, v21, v212, v213
    v_mfma_f32_16x16x32_bf16 v[176:179], v[240:243], v[224:227], v[176:179]
    s_waitcnt lgkmcnt(0)
    v_or3_b32 v21, v21, v214, v215
    v_cmp_gt_i32 vcc, 0, v21
    v_mfma_f32_16x16x32_bf16 v[180:183], v[244:247], v[224:227], v[180:183]
    v_cvt_f32_u32 v160, v2
    v_mul_f32 v160, 0x3d000000, v160
    v_mfma_f32_16x16x32_bf16 v[184:187], v[232:235], v[208:211], v[184:187]
    ds_read_b128 v[232:235], v14 offset:20480
    v_lshlrev_b32 v148, 2, v3
    v_mfma_f32_16x16x32_bf16 v[188:191], v[236:239], v[208:211], v[188:191]
    s_cbranch_vccnz L_slow_82
L_back_83:
    ds_read_b128 v[236:239], v14 offset:21504
    v_mfma_f32_16x16x32_bf16 v[192:195], v[240:243], v[208:211], v[192:195]
    s_waitcnt vmcnt(4)
    ds_read_b128 v[240:243], v14 offset:22528
    v_or_b32 v21, v24, v25
    v_mfma_f32_16x16x32_bf16 v[196:199], v[244:247], v[208:211], v[196:199]
    ds_read_b128 v[244:247], v14 offset:23552
    v_or3_b32 v21, v21, v26, v27
    v_mfma_f32_16x16x32_bf16 v[184:187], v[120:123], v[212:215], v[184:187]
    s_waitcnt vmcnt(3)
    v_or3_b32 v21, v21, v28, v29
    v_or3_b32 v21, v21, v30, v31
    s_waitcnt vmcnt(2)
    v_or3_b32 v21, v21, v32, v33
    v_or3_b32 v21, v21, v34, v35
    s_waitcnt vmcnt(1)
    v_or3_b32 v21, v21, v36, v37
    v_or3_b32 v21, v21, v38, v39
    v_cmp_gt_i32 vcc, 0, v21
    v_mfma_f32_16x16x32_bf16 v[188:191], v[124:127], v[212:215], v[188:191]
    v_cvt_f32_u32 v148, v148
    v_mfma_f32_16x16x32_bf16 v[192:195], v[128:131], v[212:215], v[192:195]
    s_cbranch_vccnz L_slow_85
L_back_86:
    v_mfma_f32_16x16x32_bf16 v[196:199], v[132:135], v[212:215], v[196:199]
    s_cmp_eq_u32 s24, 0
    s_cselect_b32 s32, 0.5, 0
    s_cselect_b32 s33, 0, 0xbe800000
    v_mfma_f32_16x16x32_bf16 v[184:187], a[240:243], v[36:39], v[184:187]
    s_bitcmp1_b32 s26, 1
    s_cselect_b32 s32, s32, 0
    s_cselect_b32 s33, s33, 0
    v_mfma_f32_16x16x32_bf16 v[188:191], a[244:247], v[36:39], v[188:191]
    s_bitcmp1_b32 s26, 0
    s_cselect_b32 s57, 0x3e800000, 0
    v_add_f32 v148, s32, v148
    v_mfma_f32_16x16x32_bf16 v[192:195], a[248:251], v[36:39], v[192:195]
    v_mov_b32 v161, s33
    v_add_f32 v161, s57, v161
    v_mfma_f32_16x16x32_bf16 v[196:199], a[252:255], v[36:39], v[196:199]
    s_waitcnt lgkmcnt(3)
    v_fma_f32 v148, v148, v160, v161
    v_fmamk_f32 v149, v160, 0x3f800000, v148
    v_mfma_f32_16x16x32_bf16 v[184:187], v[232:235], v[28:31], v[184:187]
    s_waitcnt lgkmcnt(2)
    v_fmamk_f32 v150, v160, 0x40000000, v148
    v_fmamk_f32 v151, v160, 0x40400000, v148
    v_mfma_f32_16x16x32_bf16 v[188:191], v[236:239], v[28:31], v[188:191]
    s_waitcnt lgkmcnt(1)
    v_fmamk_f32 v152, v160, 0x41800000, v148
    v_fmamk_f32 v153, v160, 0x41880000, v148
    v_mfma_f32_16x16x32_bf16 v[192:195], v[240:243], v[28:31], v[192:195]
    s_waitcnt lgkmcnt(0)
    v_fmamk_f32 v154, v160, 0x41900000, v148
    v_fmamk_f32 v155, v160, 0x41980000, v148
    v_mfma_f32_16x16x32_bf16 v[196:199], v[244:247], v[28:31], v[196:199]
    v_cos_f32 v148, v148
    v_mfma_f32_16x16x32_bf16 v[176:179], v[240:243], v[24:27], v[176:179]
    v_cos_f32 v149, v149
    v_mfma_f32_16x16x32_bf16 v[180:183], v[244:247], v[24:27], v[180:183]
    ds_write_b128 v16, v[184:187] offset:37888
    v_mfma_f32_16x16x32_bf16 v[176:179], v[128:131], v[228:231], v[176:179]
    ds_write_b128 v16, v[188:191] offset:38912
    v_mfma_f32_16x16x32_bf16 v[180:183], v[132:135], v[228:231], v[180:183]
    v_cos_f32 v150, v150
    v_mfma_f32_16x16x32_bf16 v[176:179], a[248:251], v[32:35], v[176:179]
    v_cos_f32 v151, v151
    v_mfma_f32_16x16x32_bf16 v[180:183], a[252:255], v[32:35], v[180:183]
    ds_write_b128 v17, v[192:195] offset:46080
    v_mfma_f32_16x16x32_bf16 v[168:171], v[232:235], v[24:27], v[168:171]
    v_cos_f32 v152, v152
    v_mfma_f32_16x16x32_bf16 v[172:175], v[236:239], v[24:27], v[172:175]
    ds_write_b128 v17, v[196:199] offset:47104
    v_mfma_f32_16x16x32_bf16 v[168:171], v[120:123], v[228:231], v[168:171]
    v_cos_f32 v153, v153
    v_mfma_f32_16x16x32_bf16 v[172:175], v[124:127], v[228:231], v[172:175]
    v_cos_f32 v154, v154
    v_mfma_f32_16x16x32_bf16 v[168:171], a[240:243], v[32:35], v[168:171]
    ds_write_b128 v15, v[176:179] offset:29696
    v_mfma_f32_16x16x32_bf16 v[172:175], a[244:247], v[32:35], v[172:175]
    v_cos_f32 v155, v155
    ds_write_b128 v15, v[180:183] offset:30720
    s_waitcnt lgkmcnt(0)
    s_barrier
    ds_read_b128 v[176:179], v6 offset:29696
    ds_read_b128 v[180:183], v6 offset:30720
    ds_read_b128 v[184:187], v6 offset:37888
    ds_read_b128 v[188:191], v6 offset:38912
    ds_read_b128 v[192:195], v6 offset:46080
    ds_read_b128 v[196:199], v6 offset:47104
    s_waitcnt lgkmcnt(5)
    v_pk_add_f32 v[168:169], v[168:169], v[176:177]
    v_pk_add_f32 v[170:171], v[170:171], v[178:179]
    s_waitcnt lgkmcnt(4)
    v_pk_add_f32 v[172:173], v[172:173], v[180:181]
    v_pk_add_f32 v[174:175], v[174:175], v[182:183]
    s_waitcnt lgkmcnt(3)
    v_pk_add_f32 v[168:169], v[168:169], v[184:185]
    v_pk_add_f32 v[170:171], v[170:171], v[186:187]
    s_waitcnt lgkmcnt(2)
    v_pk_add_f32 v[172:173], v[172:173], v[188:189]
    v_pk_add_f32 v[174:175], v[174:175], v[190:191]
    s_waitcnt lgkmcnt(1)
    v_pk_add_f32 v[168:169], v[168:169], v[192:193]
    v_pk_add_f32 v[170:171], v[170:171], v[194:195]
    s_waitcnt lgkmcnt(0)
    v_pk_add_f32 v[172:173], v[172:173], v[196:197]
    v_pk_add_f32 v[174:175], v[174:175], v[198:199]
    v_pk_mul_f32 v[168:169], v[168:169], v[18:19] op_sel:[0,1] op_sel_hi:[1,1]
    v_pk_mul_f32 v[170:171], v[170:171], v[18:19] op_sel:[0,1] op_sel_hi:[1,1]
    v_pk_mul_f32 v[172:173], v[172:173], v[18:19] op_sel:[0,1] op_sel_hi:[1,1]
    v_pk_mul_f32 v[174:175], v[174:175], v[18:19] op_sel:[0,1] op_sel_hi:[1,1]
    v_cvt_pk_bf16_f32 v176, v168, v169
    v_cvt_pk_bf16_f32 v178, v172, v173
    v_cvt_pk_bf16_f32 v177, v170, v171
    v_cvt_pk_bf16_f32 v179, v174, v175
    v_permlane16_swap_b32 v176, v178
    s_nop 0
    v_permlane16_swap_b32 v177, v179
    s_mov_b32 s36, 10182656
    buffer_store_dwordx4 v[176:179], v8, s[8:11], s36 offen sc1
    s_lshl_b32 s32, s26, 10
    s_add_u32 s32, s32, 159744
    v_add_u32 v161, s32, v1
    v_cvt_pk_f16_f32 v156, v148, v149
    v_cvt_pk_f16_f32 v157, v150, v151
    v_cvt_pk_f16_f32 v158, v152, v153
    v_cvt_pk_f16_f32 v159, v154, v155
    ds_write_b128 v161, v[156:159]
    s_getpc_b64 s[36:37]
L_pf_88:
    s_lshr_b32 s34, s2, 3
    s_lshl_b32 s34, s34, 10
    v_lshrrev_b32 v22, 3, v0
    v_lshl_add_u32 v22, v22, 7, s34
    v_min_u32 v22, L_code_end - L_pf_88 - 64, v22
    global_load_dword v13, v22, s[36:37]
    v_mul_u32_u24 v132, 928, v2
    v_lshl_add_u32 v132, v3, 4, v132
    v_and_b32 v22, 3, v2
    v_and_b32 v23, 4, v2
    v_lshl_add_u32 v22, v23, 2, v22
    s_lshl_b32 s34, s26, 2
    v_add_u32 v22, s34, v22
    v_lshlrev_b32 v215, 2, v22
    v_add_u32 v215, 157696, v215
    v_mul_u32_u24 v133, 928, v22
    v_lshrrev_b32 v23, 3, v2
    v_lshl_add_u32 v133, v3, 4, v133
    v_lshl_add_u32 v196, v23, 6, v133
    v_mul_u32_u24 v23, 384, v23
    v_add_u32 v133, v133, v23
    s_lshl_b32 s34, s31, 11
    s_lshl_b32 s35, s24, 6
    s_add_u32 s34, s34, s35
    v_mul_u32_u24 v134, 57344, v2
    v_lshl_add_u32 v134, v3, 4, v134
    v_add_u32 v134, s34, v134
    v_mov_b32 v208, 0x3f803f80
    v_mov_b32 v209, 0x3f803f80
    v_mov_b32 v210, 0x3f803f80
    v_mov_b32 v211, 0x3f803f80
    s_add_u32 m0, s101, 0
    s_add_u32 s57, s3, 0
    s_mov_b32 exec_hi, 0x00ffffff
    buffer_load_dwordx4 v1, s[8:11], s57 offen sc1 lds
    s_mov_b32 exec_hi, -1
    s_lshr_b32 s34, s31, 1
    s_lshl_b32 s34, s34, 4
    s_and_b32 s35, s31, 1
    s_lshl2_add_u32 s34, s35, s34
    v_and_b32 v185, 7, v2
    v_and_b32 v184, 4, v2
    v_add3_u32 v185, v185, v184, s34
    v_cmp_le_u32 vcc, 8, v2
    v_cmp_eq_u32 s[36:37], 0, v185
    s_nop 0
    s_and_b64 s[36:37], s[36:37], vcc
    s_andn2_b64 vcc, vcc, s[36:37]
    v_mov_b32 v184, 224
    v_cndmask_b32 v185, v185, v184, s[36:37]
    v_mov_b32 v184, 0xbe800000
    v_cndmask_b32 v186, 0, v184, vcc
    s_add_u32 m0, s101, 928
    s_add_u32 s57, s3, 57344
    s_mov_b32 exec_hi, 0x00ffffff
    buffer_load_dwordx4 v1, s[8:11], s57 offen sc1 lds
    s_mov_b32 exec_hi, -1
    v_cndmask_b32 v213, 1.0, -1.0, vcc
    v_mul_f32 v212, s38, v213
    v_bfe_i32 v188, v185, 0, 1
    v_and_b32 v188, 0x80008000, v188
    v_cvt_f32_u32 v185, v185
    v_mul_f32 v185, 0x3b124925, v185
    v_lshlrev_b32 v187, 3, v3
    v_cvt_f32_u32 v187, v187
    v_fma_f32 v168, v187, v185, v186
    v_mul_f32 v184, 0x42000000, v185
    v_fmamk_f32 v169, v185, 0x3f800000, v168
    v_fmamk_f32 v170, v185, 0x40000000, v168
    v_fmamk_f32 v171, v185, 0x40400000, v168
    v_fmamk_f32 v172, v185, 0x40800000, v168
    v_fmamk_f32 v173, v185, 0x40a00000, v168
    v_fmamk_f32 v174, v185, 0x40c00000, v168
    s_add_u32 m0, s101, 1856
    s_add_u32 s57, s3, 114688
    s_mov_b32 exec_hi, 0x00ffffff
    buffer_load_dwordx4 v1, s[8:11], s57 offen sc1 lds
    s_mov_b32 exec_hi, -1
    v_fmamk_f32 v175, v185, 0x40e00000, v168
    v_pk_add_f32 v[176:177], v[168:169], v[184:185] op_sel_hi:[1,0]
    v_pk_add_f32 v[178:179], v[170:171], v[184:185] op_sel_hi:[1,0]
    v_pk_add_f32 v[180:181], v[172:173], v[184:185] op_sel_hi:[1,0]
    v_pk_add_f32 v[182:183], v[174:175], v[184:185] op_sel_hi:[1,0]
    v_cos_f32 v184, v184
    v_cos_f32 v168, v168
    v_cos_f32 v169, v169
    v_cos_f32 v170, v170
    v_cos_f32 v171, v171
    s_add_u32 m0, s101, 2784
    s_add_u32 s57, s3, 172032
    s_mov_b32 exec_hi, 0x00ffffff
    buffer_load_dwordx4 v1, s[8:11], s57 offen sc1 lds
    s_mov_b32 exec_hi, -1
    v_cos_f32 v172, v172
    v_cos_f32 v173, v173
    v_cos_f32 v174, v174
    v_cos_f32 v175, v175
    v_cos_f32 v176, v176
    v_cos_f32 v177, v177
    v_cos_f32 v178, v178
    v_cos_f32 v179, v179
    s_add_u32 m0, s101, 14848
    s_add_u32 s57, s3, 917504
    s_mov_b32 exec_hi, 0x00ffffff
    buffer_load_dwordx4 v1, s[8:11], s57 offen sc1 lds
    s_mov_b32 exec_hi, -1
    v_cos_f32 v180, v180
    v_cos_f32 v181, v181
    v_cos_f32 v182, v182
    v_cos_f32 v183, v183
    v_add_f32 v184, v184, v184
    v_cvt_pk_bf16_f32 v56, v168, v169
    v_cvt_pk_bf16_f32 v57, v170, v171
    v_cvt_pk_bf16_f32 v58, v172, v173
    v_cvt_pk_bf16_f32 v59, v174, v175
    v_cvt_pk_bf16_f32 v60, v176, v177
    v_cvt_pk_bf16_f32 v61, v178, v179
    v_cvt_pk_bf16_f32 v62, v180, v181
    s_add_u32 m0, s101, 15776
    s_add_u32 s57, s3, 974848
    s_mov_b32 exec_hi, 0x00ffffff
    buffer_load_dwordx4 v1, s[8:11], s57 offen sc1 lds
    s_mov_b32 exec_hi, -1
    v_cvt_pk_bf16_f32 v63, v182, v183
    v_pk_fma_f32 v[168:169], v[184:185], v[176:177], v[168:169] op_sel_hi:[0,1,1] neg_lo:[0,0,1] neg_hi:[0,0,1]
    v_pk_fma_f32 v[170:171], v[184:185], v[178:179], v[170:171] op_sel_hi:[0,1,1] neg_lo:[0,0,1] neg_hi:[0,0,1]
    v_pk_fma_f32 v[172:173], v[184:185], v[180:181], v[172:173] op_sel_hi:[0,1,1] neg_lo:[0,0,1] neg_hi:[0,0,1]
    v_pk_fma_f32 v[174:175], v[184:185], v[182:183], v[174:175] op_sel_hi:[0,1,1] neg_lo:[0,0,1] neg_hi:[0,0,1]
    v_cvt_pk_bf16_f32 v64, v168, v169
    v_cvt_pk_bf16_f32 v65, v170, v171
    v_cvt_pk_bf16_f32 v66, v172, v173
    v_cvt_pk_bf16_f32 v67, v174, v175
    v_pk_fma_f32 v[176:177], v[184:185], v[168:169], v[176:177] op_sel_hi:[0,1,1] neg_lo:[0,0,1] neg_hi:[0,0,1]
    v_pk_fma_f32 v[178:179], v[184:185], v[170:171], v[178:179] op_sel_hi:[0,1,1] neg_lo:[0,0,1] neg_hi:[0,0,1]
    v_pk_fma_f32 v[180:181], v[184:185], v[172:173], v[180:181] op_sel_hi:[0,1,1] neg_lo:[0,0,1] neg_hi:[0,0,1]
    v_pk_fma_f32 v[182:183], v[184:185], v[174:175], v[182:183] op_sel_hi:[0,1,1] neg_lo:[0,0,1] neg_hi:[0,0,1]
    v_cvt_pk_bf16_f32 v68, v176, v177
    v_cvt_pk_bf16_f32 v69, v178, v179
    s_add_u32 m0, s101, 16704
    s_add_u32 s57, s3, 1032192
    s_mov_b32 exec_hi, 0x00ffffff
    buffer_load_dwordx4 v1, s[8:11], s57 offen sc1 lds
    s_mov_b32 exec_hi, -1
    v_cvt_pk_bf16_f32 v70, v180, v181
    v_cvt_pk_bf16_f32 v71, v182, v183
    v_pk_fma_f32 v[168:169], v[184:185], v[176:177], v[168:169] op_sel_hi:[0,1,1] neg_lo:[0,0,1] neg_hi:[0,0,1]
    v_pk_fma_f32 v[170:171], v[184:185], v[178:179], v[170:171] op_sel_hi:[0,1,1] neg_lo:[0,0,1] neg_hi:[0,0,1]
    v_pk_fma_f32 v[172:173], v[184:185], v[180:181], v[172:173] op_sel_hi:[0,1,1] neg_lo:[0,0,1] neg_hi:[0,0,1]
    v_pk_fma_f32 v[174:175], v[184:185], v[182:183], v[174:175] op_sel_hi:[0,1,1] neg_lo:[0,0,1] neg_hi:[0,0,1]
    v_cvt_pk_bf16_f32 v72, v168, v169
    v_cvt_pk_bf16_f32 v73, v170, v171
    v_cvt_pk_bf16_f32 v74, v172, v173
    v_cvt_pk_bf16_f32 v75, v174, v175
    v_pk_fma_f32 v[176:177], v[184:185], v[168:169], v[176:177] op_sel_hi:[0,1,1] neg_lo:[0,0,1] neg_hi:[0,0,1]
    v_pk_fma_f32 v[178:179], v[184:185], v[170:171], v[178:179] op_sel_hi:[0,1,1] neg_lo:[0,0,1] neg_hi:[0,0,1]
    v_pk_fma_f32 v[180:181], v[184:185], v[172:173], v[180:181] op_sel_hi:[0,1,1] neg_lo:[0,0,1] neg_hi:[0,0,1]
    v_pk_fma_f32 v[182:183], v[184:185], v[174:175], v[182:183] op_sel_hi:[0,1,1] neg_lo:[0,0,1] neg_hi:[0,0,1]
    v_cvt_pk_bf16_f32 v76, v176, v177
    v_cvt_pk_bf16_f32 v77, v178, v179
    s_add_u32 m0, s101, 17632
    s_add_u32 s57, s3, 1089536
    s_mov_b32 exec_hi, 0x00ffffff
    buffer_load_dwordx4 v1, s[8:11], s57 offen sc1 lds
    s_mov_b32 exec_hi, -1
    v_cvt_pk_bf16_f32 v78, v180, v181
    v_cvt_pk_bf16_f32 v79, v182, v183
    v_pk_fma_f32 v[168:169], v[184:185], v[176:177], v[168:169] op_sel_hi:[0,1,1] neg_lo:[0,0,1] neg_hi:[0,0,1]
    v_pk_fma_f32 v[170:171], v[184:185], v[178:179], v[170:171] op_sel_hi:[0,1,1] neg_lo:[0,0,1] neg_hi:[0,0,1]
    v_pk_fma_f32 v[172:173], v[184:185], v[180:181], v[172:173] op_sel_hi:[0,1,1] neg_lo:[0,0,1] neg_hi:[0,0,1]
    v_pk_fma_f32 v[174:175], v[184:185], v[182:183], v[174:175] op_sel_hi:[0,1,1] neg_lo:[0,0,1] neg_hi:[0,0,1]
    v_cvt_pk_bf16_f32 v80, v168, v169
    v_cvt_pk_bf16_f32 v81, v170, v171
    v_cvt_pk_bf16_f32 v82, v172, v173
    v_cvt_pk_bf16_f32 v83, v174, v175
    v_xor_b32 v84, v56, v188
    v_xor_b32 v85, v57, v188
    v_xor_b32 v86, v58, v188
    v_xor_b32 v87, v59, v188
    v_xor_b32 v88, v60, v188
    s_barrier
    v_xor_b32 v89, v61, v188
    v_xor_b32 v90, v62, v188
    v_xor_b32 v91, v63, v188
    v_xor_b32 v92, v64, v188
    v_xor_b32 v93, v65, v188
    v_xor_b32 v94, v66, v188
    v_xor_b32 v95, v67, v188
    v_xor_b32 v96, v68, v188
    v_xor_b32 v97, v69, v188
    s_add_u32 m0, s101, 29696
    s_sub_u32 s57, s100, 0
    s_mov_b32 exec_hi, 0x00ffffff
    buffer_load_dwordx4 v1, s[8:11], s57 offen sc1 lds
    s_mov_b32 exec_hi, -1
    v_xor_b32 v98, v70, v188
    v_xor_b32 v99, v71, v188
    v_xor_b32 v100, v72, v188
    v_xor_b32 v101, v73, v188
    v_xor_b32 v102, v74, v188
    v_xor_b32 v103, v75, v188
    v_xor_b32 v104, v76, v188
    v_xor_b32 v105, v77, v188
    v_xor_b32 v106, v78, v188
    s_add_u32 m0, s101, 30624
    s_sub_u32 s57, s100, 57344
    s_mov_b32 exec_hi, 0x00ffffff
    buffer_load_dwordx4 v1, s[8:11], s57 offen sc1 lds
    s_mov_b32 exec_hi, -1
    v_xor_b32 v107, v79, v188
    v_xor_b32 v108, v80, v188
    v_xor_b32 v109, v81, v188
    v_xor_b32 v110, v82, v188
    v_xor_b32 v111, v83, v188
    v_and_b32 v22, 0xffff0000, v56
    v_cmp_eq_u32 vcc, 0, v3
    s_nop 1
    v_cndmask_b32 v56, v56, v22, vcc
    v_add_u32 v214, 159744, v1
    s_add_u32 m0, s101, 31552
    s_sub_u32 s57, s100, 114688
    s_mov_b32 exec_hi, 0x00ffffff
    buffer_load_dwordx4 v1, s[8:11], s57 offen sc1 lds
    s_mov_b32 exec_hi, -1
    v_mfma_f32_16x16x32_bf16 v[216:219], v[208:211], v[56:59], 0
    v_mov_b32 v128, 0xbc003c00
    v_mfma_f32_16x16x32_bf16 v[216:219], v[208:211], v[60:63], v[216:219]
    v_mfma_f32_16x16x32_bf16 v[216:219], v[208:211], v[64:67], v[216:219]
    s_add_u32 m0, s101, 32480
    s_sub_u32 s57, s100, 172032
    s_mov_b32 exec_hi, 0x00ffffff
    buffer_load_dwordx4 v1, s[8:11], s57 offen sc1 lds
    s_mov_b32 exec_hi, -1
    v_mov_b32 v129, 0xbc003c00
    v_mfma_f32_16x16x32_bf16 v[216:219], v[208:211], v[68:71], v[216:219]
    v_mov_b32 v130, 0xbc003c00
    v_mfma_f32_16x16x32_bf16 v[216:219], v[208:211], v[72:75], v[216:219]
    s_add_u32 m0, s101, 44544
    s_sub_u32 s57, s100, 917504
    s_mov_b32 exec_hi, 0x00ffffff
    buffer_load_dwordx4 v1, s[8:11], s57 offen sc1 lds
    s_mov_b32 exec_hi, -1
    v_mov_b32 v131, 0xbc003c00
    v_mfma_f32_16x16x32_bf16 v[216:219], v[208:211], v[76:79], v[216:219]
    v_mov_b32 v40, 0
    v_mfma_f32_16x16x32_bf16 v[216:219], v[208:211], v[80:83], v[216:219]
    v_mov_b32 v41, 0
    s_add_u32 m0, s101, 45472
    s_sub_u32 s57, s100, 974848
    s_mov_b32 exec_hi, 0x00ffffff
    buffer_load_dwordx4 v1, s[8:11], s57 offen sc1 lds
    s_mov_b32 exec_hi, -1
    v_mfma_f32_16x16x32_bf16 v[216:219], v[208:211], v[84:87], v[216:219]
    v_mov_b32 v42, 0
    v_mfma_f32_16x16x32_bf16 v[216:219], v[208:211], v[88:91], v[216:219]
    v_mov_b32 v43, 0
    v_mfma_f32_16x16x32_bf16 v[216:219], v[208:211], v[92:95], v[216:219]
    s_add_u32 m0, s101, 46400
    s_sub_u32 s57, s100, 1032192
    s_mov_b32 exec_hi, 0x00ffffff
    buffer_load_dwordx4 v1, s[8:11], s57 offen sc1 lds
    s_mov_b32 exec_hi, -1
    v_mfma_f32_16x16x32_bf16 v[216:219], v[208:211], v[96:99], v[216:219]
    v_mov_b32 v44, 0
    v_mfma_f32_16x16x32_bf16 v[216:219], v[208:211], v[100:103], v[216:219]
    s_add_u32 m0, s101, 47328
    s_sub_u32 s57, s100, 1089536
    s_mov_b32 exec_hi, 0x00ffffff
    buffer_load_dwordx4 v1, s[8:11], s57 offen sc1 lds
    s_mov_b32 exec_hi, -1
    v_mov_b32 v45, 0
    v_mfma_f32_16x16x32_bf16 v[216:219], v[208:211], v[104:107], v[216:219]
    v_mov_b32 v46, 0
    v_mfma_f32_16x16x32_bf16 v[216:219], v[208:211], v[108:111], v[216:219]
    v_mov_b32 v47, 0
    s_waitcnt vmcnt(8)
    ds_read_b128 v[168:171], v133 offset:0
    ds_read_b128 v[172:175], v133 offset:64
    ds_read_b128 v[176:179], v133 offset:128
    ds_read_b128 v[180:183], v133 offset:192
    ds_read_b128 v[184:187], v133 offset:256
    ds_read_b128 v[188:191], v133 offset:320
    ds_read_b128 v[192:195], v196 offset:768
    s_waitcnt lgkmcnt(6)
    v_max_u32 v22, v168, v169
    v_max3_u32 v22, v22, v170, v171
    s_waitcnt lgkmcnt(5)
    v_max3_u32 v22, v22, v172, v173
    v_max3_u32 v22, v22, v174, v175
    s_waitcnt lgkmcnt(4)
    v_max3_u32 v22, v22, v176, v177
    v_max3_u32 v22, v22, v178, v179
    s_waitcnt lgkmcnt(3)
    v_max3_u32 v22, v22, v180, v181
    v_max3_u32 v22, v22, v182, v183
    s_waitcnt lgkmcnt(2)
    v_max3_u32 v22, v22, v184, v185
    v_max3_u32 v22, v22, v186, v187
    s_waitcnt lgkmcnt(1)
    v_max3_u32 v22, v22, v188, v189
    v_max3_u32 v22, v22, v190, v191
    s_waitcnt lgkmcnt(0)
    v_max3_u32 v22, v22, v192, v193
    v_max3_u32 v22, v22, v194, v195
    v_cmp_eq_u32 vcc, -1, v22
    s_cbranch_vccnz L_slowx0
L_backx0:
    s_barrier
    v_mfma_f32_16x16x32_bf16 v[200:203], v[168:171], v[168:171], 0
    ds_read_b128 v[136:139], v132 offset:0
    v_lshlrev_b32 v135, 4, v3
    v_mfma_f32_16x16x32_bf16 v[204:207], v[168:171], v[208:211], 0
    ds_read_b128 v[140:143], v132 offset:64
    v_add_u32 v135, 157696, v135
    v_mfma_f32_16x16x32_bf16 v[200:203], v[172:175], v[172:175], v[200:203]
    ds_read_b128 v[144:147], v132 offset:128
    v_mfma_f32_16x16x32_bf16 v[204:207], v[172:175], v[208:211], v[204:207]
    ds_read_b128 v[148:151], v132 offset:192
    v_mfma_f32_16x16x32_bf16 v[200:203], v[176:179], v[176:179], v[200:203]
    ds_read_b128 v[152:155], v132 offset:256
    v_mfma_f32_16x16x32_bf16 v[204:207], v[176:179], v[208:211], v[204:207]
    ds_read_b128 v[156:159], v132 offset:320
    v_mfma_f32_16x16x32_bf16 v[200:203], v[180:183], v[180:183], v[200:203]
    ds_read_b128 v[160:163], v132 offset:384
    v_mfma_f32_16x16x32_bf16 v[204:207], v[180:183], v[208:211], v[204:207]
    ds_read_b128 v[164:167], v132 offset:448
    v_mfma_f32_16x16x32_bf16 v[200:203], v[184:187], v[184:187], v[200:203]
    ds_read_b128 v[112:115], v214 offset:0
    v_mfma_f32_16x16x32_bf16 v[204:207], v[184:187], v[208:211], v[204:207]
    ds_read_b128 v[116:119], v214 offset:1024
    v_mfma_f32_16x16x32_bf16 v[200:203], v[188:191], v[188:191], v[200:203]
    ds_read_b128 v[120:123], v214 offset:2048
    v_mfma_f32_16x16x32_bf16 v[204:207], v[188:191], v[208:211], v[204:207]
    ds_read_b128 v[124:127], v214 offset:3072
    v_mfma_f32_16x16x32_bf16 v[200:203], v[192:195], v[192:195], v[200:203]
    v_mfma_f32_16x16x32_bf16 v[204:207], v[192:195], v[208:211], v[204:207]
    s_waitcnt lgkmcnt(11)
    v_mfma_f32_16x16x32_bf16 v[24:27], v[136:139], v[56:59], 0
    s_waitcnt lgkmcnt(10)
    ds_read_b128 v[136:139], v132 offset:512
    v_mfma_f32_16x16x32_bf16 v[24:27], v[140:143], v[60:63], v[24:27]
    s_waitcnt lgkmcnt(10)
    ds_read_b128 v[140:143], v132 offset:576
    v_mfma_f32_16x16x32_bf16 v[24:27], v[144:147], v[64:67], v[24:27]
    s_waitcnt lgkmcnt(10)
    ds_read_b128 v[144:147], v132 offset:640
    v_mfma_f32_16x16x32_bf16 v[24:27], v[148:151], v[68:71], v[24:27]
    s_waitcnt lgkmcnt(10)
    ds_read_b128 v[148:151], v132 offset:704
    v_cndmask_b32 v200, v200, v201, s[42:43]
    v_mfma_f32_16x16x32_bf16 v[24:27], v[152:155], v[72:75], v[24:27]
    s_waitcnt lgkmcnt(10)
    ds_read_b128 v[152:155], v132 offset:768
    v_cndmask_b32 v204, v204, v205, s[42:43]
    v_mfma_f32_16x16x32_bf16 v[24:27], v[156:159], v[76:79], v[24:27]
    s_waitcnt lgkmcnt(10)
    ds_read_b128 v[156:159], v132 offset:832
    v_cndmask_b32 v200, v200, v202, s[44:45]
    v_mfma_f32_16x16x32_bf16 v[24:27], v[160:163], v[80:83], v[24:27]
    s_waitcnt lgkmcnt(10)
    ds_read_b128 v[160:163], v132 offset:14848
    v_cndmask_b32 v204, v204, v206, s[44:45]
    v_mfma_f32_16x16x32_bf16 v[24:27], v[164:167], v[84:87], v[24:27]
    s_waitcnt lgkmcnt(6)
    ds_read_b128 v[164:167], v132 offset:14912
    v_cndmask_b32 v200, v200, v203, s[46:47]
    v_mfma_f32_16x16x32_bf16 v[24:27], v[136:139], v[88:91], v[24:27]
    s_waitcnt lgkmcnt(6)
    ds_read_b128 v[136:139], v132 offset:14976
    v_cndmask_b32 v204, v204, v207, s[46:47]
    v_mfma_f32_16x16x32_bf16 v[24:27], v[140:143], v[92:95], v[24:27]
    s_waitcnt lgkmcnt(6)
    ds_read_b128 v[140:143], v132 offset:15040
    v_permlane32_swap_b32 v204, v200
    v_mfma_f32_16x16x32_bf16 v[24:27], v[144:147], v[96:99], v[24:27]
    s_waitcnt lgkmcnt(6)
    ds_read_b128 v[144:147], v132 offset:15104
    v_add_f32_dpp v204, v200, v204 row_ror:8 row_mask:0xf bank_mask:0xf
    v_mfma_f32_16x16x32_bf16 v[24:27], v[148:151], v[100:103], v[24:27]
    s_waitcnt lgkmcnt(6)
    ds_read_b128 v[148:151], v132 offset:15168
    v_mul_f32 v204, 0x3b124925, v204
    v_mfma_f32_16x16x32_bf16 v[24:27], v[152:155], v[104:107], v[24:27]
    s_waitcnt lgkmcnt(6)
    v_mov_b32 v200, v204
    v_mfma_f32_16x16x32_bf16 v[24:27], v[156:159], v[108:111], v[24:27]
    s_waitcnt lgkmcnt(5)
    ds_read_b128 v[152:155], v132 offset:15232
    v_permlane32_swap_b32 v204, v200
    v_mfma_f32_16x16x32_bf16 v[28:31], v[160:163], v[56:59], 0
    s_waitcnt lgkmcnt(5)
    ds_read_b128 v[156:159], v132 offset:15296
    v_fma_f32 v200, -v204, v204, v200
    v_mfma_f32_16x16x32_bf16 v[28:31], v[164:167], v[60:63], v[28:31]
    s_waitcnt lgkmcnt(5)
    ds_read_b128 v[160:163], v132 offset:15360
    v_max_f32 v200, 0, v200
    v_mfma_f32_16x16x32_bf16 v[28:31], v[136:139], v[64:67], v[28:31]
    s_waitcnt lgkmcnt(5)
    ds_read_b128 v[164:167], v132 offset:15424
    v_add_f32 v200, 0x3727c5ac, v200
    v_mfma_f32_16x16x32_bf16 v[28:31], v[140:143], v[68:71], v[28:31]
    s_waitcnt lgkmcnt(5)
    ds_read_b128 v[136:139], v132 offset:15488
    v_rsq_f32 v200, v200
    v_mfma_f32_16x16x32_bf16 v[28:31], v[144:147], v[72:75], v[28:31]
    s_waitcnt vmcnt(0) lgkmcnt(5)
    ds_read_b128 v[140:143], v132 offset:15552
    ds_read_b128 v[168:171], v133 offset:29696
    v_mul_f32 v201, v200, v204
    v_mfma_f32_16x16x32_bf16 v[28:31], v[148:151], v[76:79], v[28:31]
    s_waitcnt lgkmcnt(6)
    ds_read_b128 v[144:147], v132 offset:15616
    ds_read_b128 v[172:175], v133 offset:29760
    s_mov_b64 exec, 0x00f0000f
    ds_write2st64_b32 v215, v200, v201 offset1:1
    ds_write_b32 v215, v204 offset:512
    s_mov_b64 exec, -1
    v_mfma_f32_16x16x32_bf16 v[28:31], v[152:155], v[80:83], v[28:31]
    s_waitcnt lgkmcnt(9)
    ds_read_b128 v[148:151], v132 offset:15680
    ds_read_b128 v[176:179], v133 offset:29824
    v_mfma_f32_16x16x32_bf16 v[28:31], v[156:159], v[84:87], v[28:31]
    s_waitcnt lgkmcnt(10)
    ds_read_b128 v[180:183], v133 offset:29888
    v_mfma_f32_16x16x32_bf16 v[28:31], v[160:163], v[88:91], v[28:31]
    s_waitcnt lgkmcnt(7)
    ds_read_b128 v[184:187], v133 offset:29952
    v_max_u32 v22, v168, v169
    v_mfma_f32_16x16x32_bf16 v[28:31], v[164:167], v[92:95], v[28:31]
    ds_read_b128 v[188:191], v133 offset:30016
    v_max3_u32 v22, v22, v170, v171
    v_mfma_f32_16x16x32_bf16 v[28:31], v[136:139], v[96:99], v[28:31]
    s_waitcnt lgkmcnt(7)
    ds_read_b128 v[192:195], v196 offset:30464
    v_max3_u32 v22, v22, v172, v173
    v_mfma_f32_16x16x32_bf16 v[28:31], v[140:143], v[100:103], v[28:31]
    s_waitcnt lgkmcnt(4)
    v_max3_u32 v22, v22, v174, v175
    v_max3_u32 v22, v22, v176, v177
    v_mfma_f32_16x16x32_bf16 v[28:31], v[144:147], v[104:107], v[28:31]
    s_waitcnt lgkmcnt(3)
    v_max3_u32 v22, v22, v178, v179
    v_max3_u32 v22, v22, v180, v181
    v_mfma_f32_16x16x32_bf16 v[28:31], v[148:151], v[108:111], v[28:31]
    v_max3_u32 v22, v22, v182, v183
    s_waitcnt lgkmcnt(2)
    v_max3_u32 v22, v22, v184, v185
    v_max3_u32 v22, v22, v186, v187
    s_waitcnt lgkmcnt(1)
    v_max3_u32 v22, v22, v188, v189
    v_max3_u32 v22, v22, v190, v191
    s_waitcnt lgkmcnt(0)
    v_max3_u32 v22, v22, v192, v193
    v_max3_u32 v22, v22, v194, v195
    v_cmp_eq_u32 vcc, -1, v22
    s_cbranch_vccnz L_slowx1
L_backx1:
    v_mfma_f32_16x16x32_bf16 v[200:203], v[168:171], v[168:171], 0
    s_barrier
    ds_read_b128 v[232:235], v135 offset:0
    v_mfma_f32_16x16x32_bf16 v[204:207], v[168:171], v[208:211], 0
    ds_read_b128 v[236:239], v135 offset:256
    v_mfma_f32_16x16x32_bf16 v[200:203], v[172:175], v[172:175], v[200:203]
    ds_read_b128 v[240:243], v135 offset:64
    v_mfma_f32_16x16x32_bf16 v[204:207], v[172:175], v[208:211], v[204:207]
    ds_read_b128 v[244:247], v135 offset:320
    v_mfma_f32_16x16x32_bf16 v[200:203], v[176:179], v[176:179], v[200:203]
    ds_read_b128 v[152:155], v132 offset:29696
    v_mfma_f32_16x16x32_bf16 v[204:207], v[176:179], v[208:211], v[204:207]
    s_waitcnt lgkmcnt(4)
    ds_read_b128 v[156:159], v132 offset:29760
    v_mul_f32 v24, v24, v232
    v_mfma_f32_16x16x32_bf16 v[200:203], v[180:183], v[180:183], v[200:203]
    ds_read_b128 v[160:163], v132 offset:29824
    v_mul_f32 v25, v25, v233
    v_mfma_f32_16x16x32_bf16 v[204:207], v[180:183], v[208:211], v[204:207]
    ds_read_b128 v[164:167], v132 offset:29888
    v_mul_f32 v26, v26, v234
    v_mfma_f32_16x16x32_bf16 v[200:203], v[184:187], v[184:187], v[200:203]
    ds_read_b128 v[136:139], v132 offset:29952
    v_mul_f32 v27, v27, v235
    v_mfma_f32_16x16x32_bf16 v[204:207], v[184:187], v[208:211], v[204:207]
    s_waitcnt lgkmcnt(7)
    ds_read_b128 v[140:143], v132 offset:30016
    v_fma_f32 v24, -v236, v216, v24
    v_mfma_f32_16x16x32_bf16 v[200:203], v[188:191], v[188:191], v[200:203]
    ds_read_b128 v[144:147], v132 offset:30080
    v_fma_f32 v25, -v237, v216, v25
    v_mfma_f32_16x16x32_bf16 v[204:207], v[188:191], v[208:211], v[204:207]
    ds_read_b128 v[148:151], v132 offset:30144
    v_fma_f32 v26, -v238, v216, v26
    v_mfma_f32_16x16x32_bf16 v[200:203], v[192:195], v[192:195], v[200:203]
    s_waitcnt lgkmcnt(9)
    v_fma_f32 v27, -v239, v216, v27
    v_mul_f32 v28, v28, v240
    v_mfma_f32_16x16x32_bf16 v[204:207], v[192:195], v[208:211], v[204:207]
    s_waitcnt lgkmcnt(7)
    v_mul_f32 v29, v29, v241
    v_mul_f32 v30, v30, v242
    v_mfma_f32_16x16x32_bf16 v[32:35], v[152:155], v[56:59], 0
    s_waitcnt lgkmcnt(6)
    ds_read_b128 v[152:155], v132 offset:30208
    v_mul_f32 v31, v31, v243
    v_mfma_f32_16x16x32_bf16 v[32:35], v[156:159], v[60:63], v[32:35]
    s_waitcnt lgkmcnt(6)
    ds_read_b128 v[156:159], v132 offset:30272
    v_cndmask_b32 v200, v200, v201, s[42:43]
    v_mfma_f32_16x16x32_bf16 v[32:35], v[160:163], v[64:67], v[32:35]
    s_waitcnt lgkmcnt(6)
    ds_read_b128 v[160:163], v132 offset:30336
    v_cndmask_b32 v204, v204, v205, s[42:43]
    v_mfma_f32_16x16x32_bf16 v[32:35], v[164:167], v[68:71], v[32:35]
    s_waitcnt lgkmcnt(6)
    ds_read_b128 v[164:167], v132 offset:30400
    v_cndmask_b32 v200, v200, v202, s[44:45]
    v_mfma_f32_16x16x32_bf16 v[32:35], v[136:139], v[72:75], v[32:35]
    s_waitcnt lgkmcnt(6)
    ds_read_b128 v[136:139], v132 offset:30464
    v_cndmask_b32 v204, v204, v206, s[44:45]
    v_mfma_f32_16x16x32_bf16 v[32:35], v[140:143], v[76:79], v[32:35]
    s_waitcnt lgkmcnt(6)
    ds_read_b128 v[140:143], v132 offset:30528
    v_cndmask_b32 v200, v200, v203, s[46:47]
    v_mfma_f32_16x16x32_bf16 v[32:35], v[144:147], v[80:83], v[32:35]
    s_waitcnt lgkmcnt(6)
    ds_read_b128 v[144:147], v132 offset:44544
    v_cndmask_b32 v204, v204, v207, s[46:47]
    v_mfma_f32_16x16x32_bf16 v[32:35], v[148:151], v[84:87], v[32:35]
    s_waitcnt lgkmcnt(6)
    ds_read_b128 v[148:151], v132 offset:44608
    v_permlane32_swap_b32 v204, v200
    v_mfma_f32_16x16x32_bf16 v[32:35], v[152:155], v[88:91], v[32:35]
    s_waitcnt lgkmcnt(6)
    ds_read_b128 v[152:155], v132 offset:44672
    v_add_f32_dpp v204, v200, v204 row_ror:8 row_mask:0xf bank_mask:0xf
    v_mfma_f32_16x16x32_bf16 v[32:35], v[156:159], v[92:95], v[32:35]
    s_waitcnt lgkmcnt(6)
    ds_read_b128 v[156:159], v132 offset:44736
    v_mul_f32 v204, 0x3b124925, v204
    v_mfma_f32_16x16x32_bf16 v[32:35], v[160:163], v[96:99], v[32:35]
    s_waitcnt lgkmcnt(6)
    ds_read_b128 v[160:163], v132 offset:44800
    v_mov_b32 v200, v204
    v_mfma_f32_16x16x32_bf16 v[32:35], v[164:167], v[100:103], v[32:35]
    s_waitcnt lgkmcnt(6)
    ds_read_b128 v[164:167], v132 offset:44864
    v_permlane32_swap_b32 v204, v200
    v_mfma_f32_16x16x32_bf16 v[32:35], v[136:139], v[104:107], v[32:35]
    s_waitcnt lgkmcnt(6)
    ds_read_b128 v[136:139], v132 offset:44928
    v_fma_f32 v200, -v204, v204, v200
    v_mfma_f32_16x16x32_bf16 v[32:35], v[140:143], v[108:111], v[32:35]
    s_waitcnt lgkmcnt(6)
    ds_read_b128 v[140:143], v132 offset:44992
    v_max_f32 v200, 0, v200
    v_mfma_f32_16x16x32_bf16 v[36:39], v[144:147], v[56:59], 0
    s_waitcnt lgkmcnt(6)
    ds_read_b128 v[144:147], v132 offset:45056
    v_add_f32 v200, 0x3727c5ac, v200
    v_mfma_f32_16x16x32_bf16 v[36:39], v[148:151], v[60:63], v[36:39]
    s_waitcnt lgkmcnt(6)
    ds_read_b128 v[148:151], v132 offset:45120
    v_fma_f32 v28, -v244, v216, v28
    v_mfma_f32_16x16x32_bf16 v[36:39], v[152:155], v[64:67], v[36:39]
    s_waitcnt lgkmcnt(6)
    v_rsq_f32 v200, v200
    v_mfma_f32_16x16x32_bf16 v[36:39], v[156:159], v[68:71], v[36:39]
    s_waitcnt lgkmcnt(5)
    ds_read_b128 v[152:155], v132 offset:45184
    v_mul_f32 v201, v200, v204
    v_mfma_f32_16x16x32_bf16 v[36:39], v[160:163], v[72:75], v[36:39]
    s_waitcnt lgkmcnt(5)
    ds_read_b128 v[156:159], v132 offset:45248
    v_add_u32 v215, 128, v215
    v_mfma_f32_16x16x32_bf16 v[36:39], v[164:167], v[76:79], v[36:39]
    s_waitcnt lgkmcnt(5)
    ds_read_b128 v[160:163], v132 offset:45312
    s_mov_b64 exec, 0x00f0000f
    ds_write2st64_b32 v215, v200, v201 offset1:1
    ds_write_b32 v215, v204 offset:512
    s_mov_b64 exec, -1
    v_mfma_f32_16x16x32_bf16 v[36:39], v[136:139], v[80:83], v[36:39]
    s_waitcnt lgkmcnt(7)
    ds_read_b128 v[164:167], v132 offset:45376
    v_fma_f32 v29, -v245, v216, v29
    v_mfma_f32_16x16x32_bf16 v[36:39], v[140:143], v[84:87], v[36:39]
    s_waitcnt lgkmcnt(7)
    v_fma_f32 v30, -v246, v216, v30
    v_fma_f32 v31, -v247, v216, v31
    v_mfma_f32_16x16x32_bf16 v[36:39], v[144:147], v[88:91], v[36:39]
    s_waitcnt lgkmcnt(1)
    s_barrier
    ds_read_b128 v[168:171], v135 offset:128
    v_mfma_f32_16x16x32_bf16 v[36:39], v[148:151], v[92:95], v[36:39]
    ds_read_b128 v[172:175], v135 offset:384
    v_mul_f32 v240, s38, v24
    v_mfma_f32_16x16x32_bf16 v[36:39], v[152:155], v[96:99], v[36:39]
    ds_read_b128 v[176:179], v135 offset:192
    v_mul_f32 v241, s38, v25
    v_mfma_f32_16x16x32_bf16 v[36:39], v[156:159], v[100:103], v[36:39]
    ds_read_b128 v[180:183], v135 offset:448
    v_mul_f32 v242, s38, v26
    v_mfma_f32_16x16x32_bf16 v[36:39], v[160:163], v[104:107], v[36:39]
    s_waitcnt lgkmcnt(4)
    v_mul_f32 v243, s38, v27
    v_mul_f32 v244, s38, v28
    v_mfma_f32_16x16x32_bf16 v[36:39], v[164:167], v[108:111], v[36:39]
    v_mul_f32 v245, s38, v29
    v_mul_f32 v246, s38, v30
    v_mul_f32 v247, s38, v31
    s_waitcnt lgkmcnt(3)
    v_pk_mul_f32 v[32:33], v[32:33], v[168:169]
    v_pk_mul_f32 v[34:35], v[34:35], v[170:171]
    s_waitcnt lgkmcnt(2)
    v_pk_fma_f32 v[32:33], v[172:173], v[216:217], v[32:33] neg_lo:[1,0,0] neg_hi:[1,0,0]
    v_pk_fma_f32 v[34:35], v[174:175], v[216:217], v[34:35] neg_lo:[1,0,0] neg_hi:[1,0,0]
    v_pk_fma_f32 v[232:233], v[32:33], v[212:213], v[24:25] op_sel_hi:[1,0,1]
    v_pk_fma_f32 v[240:241], v[32:33], v[212:213], v[240:241] op_sel:[0,1,0] op_sel_hi:[1,1,1]
    v_pk_fma_f32 v[234:235], v[34:35], v[212:213], v[26:27] op_sel_hi:[1,0,1]
    v_pk_fma_f32 v[242:243], v[34:35], v[212:213], v[242:243] op_sel:[0,1,0] op_sel_hi:[1,1,1]
    s_waitcnt lgkmcnt(1)
    v_pk_mul_f32 v[36:37], v[36:37], v[176:177]
    v_pk_mul_f32 v[38:39], v[38:39], v[178:179]
    s_waitcnt lgkmcnt(0)
    v_pk_fma_f32 v[36:37], v[180:181], v[216:217], v[36:37] neg_lo:[1,0,0] neg_hi:[1,0,0]
    v_pk_fma_f32 v[38:39], v[182:183], v[216:217], v[38:39] neg_lo:[1,0,0] neg_hi:[1,0,0]
    v_pk_fma_f32 v[236:237], v[36:37], v[212:213], v[28:29] op_sel_hi:[1,0,1]
    v_pk_fma_f32 v[244:245], v[36:37], v[212:213], v[244:245] op_sel:[0,1,0] op_sel_hi:[1,1,1]
    v_pk_fma_f32 v[238:239], v[38:39], v[212:213], v[30:31] op_sel_hi:[1,0,1]
    v_pk_fma_f32 v[246:247], v[38:39], v[212:213], v[246:247] op_sel:[0,1,0] op_sel_hi:[1,1,1]
    v_cvt_pk_f16_f32 v48, v232, v233
    v_cvt_pk_f16_f32 v49, v234, v235
    v_cvt_pk_f16_f32 v50, v236, v237
    v_cvt_pk_f16_f32 v51, v238, v239
    v_cvt_pk_f16_f32 v52, v240, v241
    v_cvt_pk_f16_f32 v53, v242, v243
    v_cvt_pk_f16_f32 v54, v244, v245
    v_cvt_pk_f16_f32 v55, v246, v247
    s_mov_b64 exec, s[40:41]
    v_xor_b32 v40, 0x80008000, v48
    v_xor_b32 v41, 0x80008000, v49
    v_xor_b32 v42, 0x80008000, v50
    v_xor_b32 v43, 0x80008000, v51
    v_xor_b32 v44, 0x80008000, v52
    v_xor_b32 v45, 0x80008000, v53
    v_xor_b32 v46, 0x80008000, v54
    v_xor_b32 v47, 0x80008000, v55
    v_mov_b32_dpp v40, v48 row_ror:8 row_mask:0xf bank_mask:0x3
    v_mov_b32_dpp v41, v49 row_ror:8 row_mask:0xf bank_mask:0x3
    v_mov_b32_dpp v42, v50 row_ror:8 row_mask:0xf bank_mask:0x3
    v_mov_b32_dpp v43, v51 row_ror:8 row_mask:0xf bank_mask:0x3
    v_mov_b32_dpp v44, v52 row_ror:8 row_mask:0xf bank_mask:0x3
    v_mov_b32_dpp v45, v53 row_ror:8 row_mask:0xf bank_mask:0x3
    v_mov_b32_dpp v46, v54 row_ror:8 row_mask:0xf bank_mask:0x3
    v_mov_b32_dpp v47, v55 row_ror:8 row_mask:0xf bank_mask:0x3
    v_mov_b32_dpp v48, v48 row_ror:8 row_mask:0xf bank_mask:0xc
    v_mov_b32_dpp v49, v49 row_ror:8 row_mask:0xf bank_mask:0xc
    v_mov_b32_dpp v50, v50 row_ror:8 row_mask:0xf bank_mask:0xc
    v_mov_b32_dpp v51, v51 row_ror:8 row_mask:0xf bank_mask:0xc
    v_mov_b32_dpp v52, v52 row_ror:8 row_mask:0xf bank_mask:0xc
    v_mov_b32_dpp v53, v53 row_ror:8 row_mask:0xf bank_mask:0xc
    v_mov_b32_dpp v54, v54 row_ror:8 row_mask:0xf bank_mask:0xc
    v_mov_b32_dpp v55, v55 row_ror:8 row_mask:0xf bank_mask:0xc
    s_mov_b64 exec, -1
    v_mfma_f32_16x16x32_f16 v[24:27], v[40:43], v[116:119], 0
    v_mfma_f32_16x16x32_f16 v[28:31], v[44:47], v[124:127], 0
    v_mfma_f32_16x16x32_f16 v[24:27], v[48:51], v[112:115], v[24:27]
    v_mfma_f32_16x16x32_f16 v[28:31], v[52:55], v[120:123], v[28:31]
    v_mfma_f32_16x16x32_f16 v[32:35], v[48:51], v[128:131], 0
    v_mfma_f32_16x16x32_f16 v[36:39], v[44:47], v[128:131], 0
    s_cmp_lg_u32 s26, 0
    s_cbranch_scc1 L_w0_90
    s_lshr_b32 s34, s2, 3
    s_lshl_b32 s34, s34, 7
    s_add_u32 s34, s34, 98304
    v_lshl_add_u32 v22, v0, 12, s34
    v_mov_b32 v20, 1
    s_mov_b64 exec, 0xff
    buffer_atomic_add v20, v22, s[8:11], 0 offen sc1
    s_mov_b64 exec, -1
L_w0_90:
    s_mov_b32 s32, 12017664
    s_mov_b32 s33, 12935168
    s_nop 0
    v_cvt_pk_f16_f32 v184, v24, v25
    v_cvt_pk_f16_f32 v185, v26, v27
    v_cvt_pk_f16_f32 v186, v28, v29
    v_cvt_pk_f16_f32 v187, v30, v31
    buffer_store_dwordx4 v[184:187], v134, s[8:11], s32 offen sc1
    v_cvt_pk_f16_f32 v188, v32, v33
    v_cvt_pk_f16_f32 v189, v34, v35
    v_cvt_pk_f16_f32 v190, v36, v37
    v_cvt_pk_f16_f32 v191, v38, v39
    s_mov_b32 exec_lo, 0x00010001
    s_mov_b32 exec_hi, 0x00010001
    buffer_store_dwordx4 v[188:191], v134, s[8:11], s33 offen sc1
    s_mov_b64 exec, -1
L_tagain:
    s_getpc_b64 s[36:37]
L_pf_89:
    s_lshr_b32 s34, s2, 3
    s_lshl_b32 s34, s34, 10
    v_lshrrev_b32 v22, 3, v0
    v_lshl_add_u32 v22, v22, 7, s34
    v_min_u32 v22, L_code_end - L_pf_89 - 64, v22
    global_load_dword v13, v22, s[36:37]
    v_lshlrev_b32 v22, 2, v2
    v_add_u32 v22, 158208, v22
    ds_read_b32 v228, v22 offset:0
    ds_read_b32 v229, v22 offset:64
    ds_read_b32 v230, v22 offset:128
    ds_read_b32 v231, v22 offset:192
    s_mul_i32 s34, s26, 96
    v_cmp_gt_u32 vcc, 2, v3
    v_and_b32 v22, 1, v3
    v_lshl_add_u32 v22, v22, 4, s34
    v_sub_u32 v23, 880, v22
    v_cndmask_b32 v226, v23, v22, vcc
    v_cndmask_b32 v227, v22, v23, vcc
    v_mul_u32_u24 v22, 928, v2
    v_add_u32 v226, v226, v22
    v_add_u32 v227, v227, v22
    v_mov_b32 v22, 0x01000c0c
    v_mov_b32 v23, 0x05040c0c
    v_cndmask_b32 v222, v23, v22, vcc
    v_cndmask_b32 v224, v22, v23, vcc
    v_add_u32 v223, 0x02020000, v222
    v_add_u32 v225, 0x02020000, v224
    v_mov_b32 v22, -32
    v_cndmask_b32 v200, v22, 32, vcc
    s_cmp_eq_u32 s26, 0
    s_cselect_b32 s34, 0xffff, 0
    s_mov_b32 s35, 0
    s_mov_b32 vcc_lo, 0
    s_mov_b32 vcc_hi, s34
    v_subrev_u32 v22, 448, v226
    v_subrev_u32 v23, 448, v227
    v_cndmask_b32 v201, v226, v22, vcc
    v_cndmask_b32 v202, v227, v23, s[34:35]
    ds_read_b128 v[136:139], v226 offset:0
    ds_read_b32 v140, v201 offset:16
    ds_read_b128 v[142:145], v226 offset:14848
    ds_read_b32 v146, v201 offset:14864
    ds_read_b128 v[148:151], v227 offset:29696
    ds_read_b32 v152, v202 offset:29712
    ds_read_b128 v[154:157], v227 offset:44544
    ds_read_b32 v158, v202 offset:44560
    v_add_u32 v226, v226, v200
    v_sub_u32 v227, v227, v200
    ds_read_b128 v[160:163], v226 offset:0
    ds_read_b32 v164, v226 offset:16
    s_waitcnt lgkmcnt(9)
    v_perm_b32 v25, v139, v136, v223
    v_perm_b32 v26, v139, v137, v222
    v_perm_b32 v27, v138, v137, v223
    v_perm_b32 v40, v138, v138, v222
    v_perm_b32 v41, v137, v138, v223
    v_perm_b32 v42, v137, v139, v222
    v_perm_b32 v43, v136, v139, v223
    s_waitcnt lgkmcnt(8)
    v_perm_b32 v24, v140, v136, v222
    v_mov_b32 v192, v24
    s_waitcnt lgkmcnt(7)
    v_perm_b32 v29, v145, v142, v223
    v_perm_b32 v30, v145, v143, v222
    v_perm_b32 v31, v144, v143, v223
    v_perm_b32 v44, v144, v144, v222
    v_perm_b32 v45, v143, v144, v223
    v_perm_b32 v46, v143, v145, v222
    v_perm_b32 v47, v142, v145, v223
    s_waitcnt lgkmcnt(6)
    v_perm_b32 v28, v146, v142, v222
    v_mov_b32 v193, v28
    ds_read_b128 v[136:139], v226 offset:14848
    ds_read_b32 v140, v226 offset:14864
    ds_read_b128 v[142:145], v227 offset:29696
    ds_read_b32 v146, v227 offset:29712
    s_waitcnt lgkmcnt(9)
    v_perm_b32 v33, v151, v148, v225
    v_perm_b32 v34, v151, v149, v224
    v_perm_b32 v35, v150, v149, v225
    v_perm_b32 v48, v150, v150, v224
    v_perm_b32 v49, v149, v150, v225
    v_perm_b32 v50, v149, v151, v224
    v_perm_b32 v51, v148, v151, v225
    s_waitcnt lgkmcnt(8)
    v_perm_b32 v32, v152, v148, v224
    v_mov_b32 v194, v32
    s_waitcnt lgkmcnt(7)
    v_perm_b32 v37, v157, v154, v225
    v_perm_b32 v38, v157, v155, v224
    v_perm_b32 v39, v156, v155, v225
    v_perm_b32 v52, v156, v156, v224
    v_perm_b32 v53, v155, v156, v225
    v_perm_b32 v54, v155, v157, v224
    v_perm_b32 v55, v154, v157, v225
    s_waitcnt lgkmcnt(6)
    v_perm_b32 v36, v158, v154, v224
    v_mov_b32 v195, v36
    ds_read_b128 v[148:151], v227 offset:44544
    ds_read_b32 v152, v227 offset:44560
    v_add_u32 v226, v226, v200
    v_sub_u32 v227, v227, v200
    ds_read_b128 v[154:157], v226 offset:0
    ds_read_b32 v158, v226 offset:16
    s_waitcnt lgkmcnt(9)
    v_perm_b32 v57, v163, v160, v223
    v_perm_b32 v58, v163, v161, v222
    v_perm_b32 v59, v162, v161, v223
    v_perm_b32 v72, v162, v162, v222
    v_perm_b32 v73, v161, v162, v223
    v_perm_b32 v74, v161, v163, v222
    v_perm_b32 v75, v160, v163, v223
    s_waitcnt lgkmcnt(8)
    v_perm_b32 v56, v164, v160, v222
    s_waitcnt lgkmcnt(7)
    v_perm_b32 v61, v139, v136, v223
    v_perm_b32 v62, v139, v137, v222
    v_perm_b32 v63, v138, v137, v223
    v_perm_b32 v76, v138, v138, v222
    v_perm_b32 v77, v137, v138, v223
    v_perm_b32 v78, v137, v139, v222
    v_perm_b32 v79, v136, v139, v223
    s_waitcnt lgkmcnt(6)
    v_perm_b32 v60, v140, v136, v222
    ds_read_b128 v[160:163], v226 offset:14848
    ds_read_b32 v164, v226 offset:14864
    ds_read_b128 v[136:139], v227 offset:29696
    ds_read_b32 v140, v227 offset:29712
    s_waitcnt lgkmcnt(9)
    v_perm_b32 v65, v145, v142, v225
    v_perm_b32 v66, v145, v143, v224
    v_perm_b32 v67, v144, v143, v225
    v_perm_b32 v80, v144, v144, v224
    v_perm_b32 v81, v143, v144, v225
    v_perm_b32 v82, v143, v145, v224
    v_perm_b32 v83, v142, v145, v225
    s_waitcnt lgkmcnt(8)
    v_perm_b32 v64, v146, v142, v224
    s_waitcnt lgkmcnt(7)
    v_perm_b32 v69, v151, v148, v225
    v_perm_b32 v70, v151, v149, v224
    v_perm_b32 v71, v150, v149, v225
    v_perm_b32 v84, v150, v150, v224
    v_perm_b32 v85, v149, v150, v225
    v_perm_b32 v86, v149, v151, v224
    v_perm_b32 v87, v148, v151, v225
    s_waitcnt lgkmcnt(6)
    v_perm_b32 v68, v152, v148, v224
    ds_read_b128 v[142:145], v227 offset:44544
    ds_read_b32 v146, v227 offset:44560
    s_lshr_b32 s34, s26, 1
    s_lshl_b32 s34, s34, 5
    s_and_b32 s35, s26, 1
    s_lshl3_add_u32 s34, s35, s34
    s_add_u32 s34, s34, 384
    v_cmp_gt_u32 vcc, 2, v3
    v_and_b32 v22, 1, v3
    v_lshl_add_u32 v22, v22, 4, s34
    v_sub_u32 v23, 888, v22
    v_cndmask_b32 v226, v23, v22, vcc
    v_cndmask_b32 v227, v22, v23, vcc
    v_mul_u32_u24 v22, 928, v2
    v_add_u32 v226, v226, v22
    v_add_u32 v227, v227, v22
    ds_read_b64 v[148:149], v226 offset:0
    ds_read_b32 v152, v226 offset:8
    s_waitcnt lgkmcnt(9)
    v_perm_b32 v89, v157, v154, v223
    v_perm_b32 v90, v157, v155, v222
    v_perm_b32 v91, v156, v155, v223
    v_perm_b32 v104, v156, v156, v222
    v_perm_b32 v105, v155, v156, v223
    v_perm_b32 v106, v155, v157, v222
    v_perm_b32 v107, v154, v157, v223
    s_waitcnt lgkmcnt(8)
    v_perm_b32 v88, v158, v154, v222
    s_waitcnt lgkmcnt(7)
    v_perm_b32 v93, v163, v160, v223
    v_perm_b32 v94, v163, v161, v222
    v_perm_b32 v95, v162, v161, v223
    v_perm_b32 v108, v162, v162, v222
    v_perm_b32 v109, v161, v162, v223
    v_perm_b32 v110, v161, v163, v222
    v_perm_b32 v111, v160, v163, v223
    s_waitcnt lgkmcnt(6)
    v_perm_b32 v92, v164, v160, v222
    ds_read_b64 v[154:155], v226 offset:14848
    ds_read_b32 v158, v226 offset:14856
    ds_read_b64 v[160:161], v227 offset:29696
    ds_read_b32 v164, v227 offset:29704
    s_waitcnt lgkmcnt(9)
    v_perm_b32 v97, v139, v136, v225
    v_perm_b32 v98, v139, v137, v224
    v_perm_b32 v99, v138, v137, v225
    v_perm_b32 v112, v138, v138, v224
    v_perm_b32 v113, v137, v138, v225
    v_perm_b32 v114, v137, v139, v224
    v_perm_b32 v115, v136, v139, v225
    s_waitcnt lgkmcnt(8)
    v_perm_b32 v96, v140, v136, v224
    s_waitcnt lgkmcnt(7)
    v_perm_b32 v101, v145, v142, v225
    v_perm_b32 v102, v145, v143, v224
    v_perm_b32 v103, v144, v143, v225
    v_perm_b32 v116, v144, v144, v224
    v_perm_b32 v117, v143, v144, v225
    v_perm_b32 v118, v143, v145, v224
    v_perm_b32 v119, v142, v145, v225
    s_waitcnt lgkmcnt(6)
    v_perm_b32 v100, v146, v142, v224
    ds_read_b64 v[136:137], v227 offset:44544
    ds_read_b32 v140, v227 offset:44552
    s_waitcnt lgkmcnt(7)
    v_perm_b32 v121, v149, v148, v223
    v_perm_b32 v122, v149, v149, v222
    v_perm_b32 v123, v148, v149, v223
    s_waitcnt lgkmcnt(6)
    v_perm_b32 v120, v152, v148, v222
    s_waitcnt lgkmcnt(5)
    v_perm_b32 v125, v155, v154, v223
    v_perm_b32 v126, v155, v155, v222
    v_perm_b32 v127, v154, v155, v223
    s_waitcnt lgkmcnt(4)
    v_perm_b32 v124, v158, v154, v222
    s_waitcnt lgkmcnt(3)
    v_perm_b32 v129, v161, v160, v225
    v_perm_b32 v130, v161, v161, v224
    v_perm_b32 v131, v160, v161, v225
    s_waitcnt lgkmcnt(2)
    v_perm_b32 v128, v164, v160, v224
    s_waitcnt lgkmcnt(1)
    v_perm_b32 v133, v137, v136, v225
    v_perm_b32 v134, v137, v137, v224
    v_perm_b32 v135, v136, v137, v225
    s_waitcnt lgkmcnt(0)
    v_perm_b32 v132, v140, v136, v224
    s_mul_i32 s3, s29, 57344
    s_add_u32 s3, s3, 12017664
    s_mul_i32 s101, s26, 12288
    s_mul_i32 s100, s26, -10240
    s_add_u32 s100, s100, 40960
    s_add_u32 s3, s3, s101
    s_cmp_lg_u32 s26, 0
    s_cbranch_scc1 L_w0_91
    s_lshl_b32 s34, s30, 12
    s_add_u32 s34, s34, 98304
    v_min_u32 v22, 27, v0
    v_lshl_add_u32 v22, v22, 7, s34
L_sp_93:
    buffer_load_dword v21, v22, s[8:11], 0 offen sc1
    s_waitcnt vmcnt(0)
    v_cmp_ne_u32 vcc, 8, v21
    s_sub_i32 s39, s39, 1
    s_max_i32 s39, s39, 0
    s_cbranch_scc0 L_ok_92
    s_cbranch_vccnz L_sp_93
L_ok_92:
L_w0_91:
    s_barrier
    s_mov_b32 m0, s101
    s_nop 0
    buffer_load_dwordx4 v1, s[8:11], s3 offen offset:0 sc1 lds
    buffer_load_dwordx4 v1, s[8:11], s3 offen offset:1024 sc1 lds
    buffer_load_dwordx4 v1, s[8:11], s3 offen offset:2048 sc1 lds
    v_and_b32 v22, 3, v0
    v_lshlrev_b32 v216, 4, v22
    v_lshl_add_u32 v216, v3, 7, v216
    v_bfe_u32 v22, v0, 3, 1
    v_lshl_add_u32 v216, v22, 6, v216
    v_bfe_u32 v22, v0, 2, 1
    v_lshl_add_u32 v216, v22, 3, v216
    s_mul_i32 s34, s26, 12288
    s_lshl_b32 s35, s26, 11
    s_add_u32 s35, s35, 49152
    v_add_u32 v217, s35, v216
    buffer_load_dwordx4 v1, s[8:11], s3 offen offset:3072 sc1 lds
    v_add_u32 v216, s34, v216
    v_lshlrev_b32 v22, 3, v0
    v_xor_b32 v23, 256, v22
    v_add_u32 v218, s34, v22
    v_add_u32 v219, s34, v23
    v_add_u32 v220, s35, v22
    v_add_u32 v221, s35, v23
    v_accvgpr_read_b32 v232, a224
    v_accvgpr_read_b32 v233, a225
    v_accvgpr_read_b32 v234, a226
    v_accvgpr_read_b32 v235, a227
    s_add_u32 m0, m0, 4096
    s_add_u32 s3, s3, 4096
    buffer_load_dwordx4 v1, s[8:11], s3 offen offset:0 sc1 lds
    v_accvgpr_read_b32 v236, a228
    v_accvgpr_read_b32 v237, a229
    v_accvgpr_read_b32 v238, a230
    v_accvgpr_read_b32 v239, a231
    v_accvgpr_read_b32 v240, a232
    v_accvgpr_read_b32 v241, a233
    v_accvgpr_read_b32 v242, a234
    v_accvgpr_read_b32 v243, a235
    v_accvgpr_read_b32 v244, a236
    v_accvgpr_read_b32 v245, a237
    v_accvgpr_read_b32 v246, a238
    buffer_load_dwordx4 v1, s[8:11], s3 offen offset:1024 sc1 lds
    v_accvgpr_read_b32 v247, a239
    v_and_b32 v169, 1, v3
    v_sub_u32 v169, 0, v169
    v_and_b32 v169, 0x80008000, v169
    v_xor_b32 v232, v232, v169
    v_xor_b32 v233, v233, v169
    v_xor_b32 v234, v234, v169
    v_xor_b32 v235, v235, v169
    v_xor_b32 v236, v236, v169
    v_xor_b32 v237, v237, v169
    buffer_load_dwordx4 v1, s[8:11], s3 offen offset:2048 sc1 lds
    v_xor_b32 v238, v238, v169
    v_xor_b32 v239, v239, v169
    v_xor_b32 v240, v240, v169
    v_xor_b32 v241, v241, v169
    v_xor_b32 v242, v242, v169
    v_xor_b32 v243, v243, v169
    v_xor_b32 v244, v244, v169
    v_xor_b32 v245, v245, v169
    v_xor_b32 v246, v246, v169
    v_xor_b32 v247, v247, v169
    v_accvgpr_write_b32 a240, v232
    buffer_load_dwordx4 v1, s[8:11], s3 offen offset:3072 sc1 lds
    v_accvgpr_write_b32 a241, v233
    v_accvgpr_write_b32 a242, v234
    v_accvgpr_write_b32 a243, v235
    v_accvgpr_write_b32 a244, v236
    v_accvgpr_write_b32 a245, v237
    v_accvgpr_write_b32 a246, v238
    v_accvgpr_write_b32 a247, v239
    v_accvgpr_write_b32 a248, v240
    v_accvgpr_write_b32 a249, v241
    v_accvgpr_write_b32 a250, v242
    v_accvgpr_write_b32 a251, v243
    s_add_u32 m0, m0, 4096
    s_add_u32 s3, s3, 4096
    buffer_load_dwordx4 v1, s[8:11], s3 offen offset:0 sc1 lds
    v_accvgpr_write_b32 a252, v244
    v_accvgpr_write_b32 a253, v245
    v_accvgpr_write_b32 a254, v246
    v_accvgpr_write_b32 a255, v247
    v_pk_add_f32 v[24:25], v[24:25], v[228:229] op_sel_hi:[1,0] neg_lo:[0,1] neg_hi:[0,1]
    v_pk_add_f32 v[26:27], v[26:27], v[228:229] op_sel_hi:[1,0] neg_lo:[0,1] neg_hi:[0,1]
    v_pk_add_f32 v[40:41], v[40:41], v[228:229] op_sel_hi:[1,0] neg_lo:[0,1] neg_hi:[0,1]
    v_pk_add_f32 v[42:43], v[42:43], v[228:229] op_sel_hi:[1,0] neg_lo:[0,1] neg_hi:[0,1]
    v_pk_add_f32 v[28:29], v[28:29], v[228:229] op_sel:[0,1] op_sel_hi:[1,1] neg_lo:[0,1] neg_hi:[0,1]
    v_pk_add_f32 v[30:31], v[30:31], v[228:229] op_sel:[0,1] op_sel_hi:[1,1] neg_lo:[0,1] neg_hi:[0,1]
    v_pk_add_f32 v[44:45], v[44:45], v[228:229] op_sel:[0,1] op_sel_hi:[1,1] neg_lo:[0,1] neg_hi:[0,1]
    buffer_load_dwordx4 v1, s[8:11], s3 offen offset:1024 sc1 lds
    v_pk_add_f32 v[46:47], v[46:47], v[228:229] op_sel:[0,1] op_sel_hi:[1,1] neg_lo:[0,1] neg_hi:[0,1]
    v_pk_add_f32 v[32:33], v[32:33], v[230:231] op_sel_hi:[1,0] neg_lo:[0,1] neg_hi:[0,1]
    v_pk_add_f32 v[34:35], v[34:35], v[230:231] op_sel_hi:[1,0] neg_lo:[0,1] neg_hi:[0,1]
    v_pk_add_f32 v[48:49], v[48:49], v[230:231] op_sel_hi:[1,0] neg_lo:[0,1] neg_hi:[0,1]
    v_pk_add_f32 v[50:51], v[50:51], v[230:231] op_sel_hi:[1,0] neg_lo:[0,1] neg_hi:[0,1]
    v_pk_add_f32 v[36:37], v[36:37], v[230:231] op_sel:[0,1] op_sel_hi:[1,1] neg_lo:[0,1] neg_hi:[0,1]
    v_pk_add_f32 v[38:39], v[38:39], v[230:231] op_sel:[0,1] op_sel_hi:[1,1] neg_lo:[0,1] neg_hi:[0,1]
    v_pk_add_f32 v[52:53], v[52:53], v[230:231] op_sel:[0,1] op_sel_hi:[1,1] neg_lo:[0,1] neg_hi:[0,1]
    v_pk_add_f32 v[54:55], v[54:55], v[230:231] op_sel:[0,1] op_sel_hi:[1,1] neg_lo:[0,1] neg_hi:[0,1]
    v_pk_add_f32 v[56:57], v[56:57], v[228:229] op_sel_hi:[1,0] neg_lo:[0,1] neg_hi:[0,1]
    buffer_load_dwordx4 v1, s[8:11], s3 offen offset:2048 sc1 lds
    v_pk_add_f32 v[58:59], v[58:59], v[228:229] op_sel_hi:[1,0] neg_lo:[0,1] neg_hi:[0,1]
    v_pk_add_f32 v[72:73], v[72:73], v[228:229] op_sel_hi:[1,0] neg_lo:[0,1] neg_hi:[0,1]
    v_pk_add_f32 v[74:75], v[74:75], v[228:229] op_sel_hi:[1,0] neg_lo:[0,1] neg_hi:[0,1]
    v_pk_add_f32 v[60:61], v[60:61], v[228:229] op_sel:[0,1] op_sel_hi:[1,1] neg_lo:[0,1] neg_hi:[0,1]
    v_pk_add_f32 v[62:63], v[62:63], v[228:229] op_sel:[0,1] op_sel_hi:[1,1] neg_lo:[0,1] neg_hi:[0,1]
    v_pk_add_f32 v[76:77], v[76:77], v[228:229] op_sel:[0,1] op_sel_hi:[1,1] neg_lo:[0,1] neg_hi:[0,1]
    v_pk_add_f32 v[78:79], v[78:79], v[228:229] op_sel:[0,1] op_sel_hi:[1,1] neg_lo:[0,1] neg_hi:[0,1]
    v_pk_add_f32 v[64:65], v[64:65], v[230:231] op_sel_hi:[1,0] neg_lo:[0,1] neg_hi:[0,1]
    v_pk_add_f32 v[66:67], v[66:67], v[230:231] op_sel_hi:[1,0] neg_lo:[0,1] neg_hi:[0,1]
    v_pk_add_f32 v[80:81], v[80:81], v[230:231] op_sel_hi:[1,0] neg_lo:[0,1] neg_hi:[0,1]
    v_pk_add_f32 v[82:83], v[82:83], v[230:231] op_sel_hi:[1,0] neg_lo:[0,1] neg_hi:[0,1]
    buffer_load_dwordx4 v1, s[8:11], s3 offen offset:3072 sc1 lds
    v_pk_add_f32 v[68:69], v[68:69], v[230:231] op_sel:[0,1] op_sel_hi:[1,1] neg_lo:[0,1] neg_hi:[0,1]
    v_pk_add_f32 v[70:71], v[70:71], v[230:231] op_sel:[0,1] op_sel_hi:[1,1] neg_lo:[0,1] neg_hi:[0,1]
    v_pk_add_f32 v[84:85], v[84:85], v[230:231] op_sel:[0,1] op_sel_hi:[1,1] neg_lo:[0,1] neg_hi:[0,1]
    v_pk_add_f32 v[86:87], v[86:87], v[230:231] op_sel:[0,1] op_sel_hi:[1,1] neg_lo:[0,1] neg_hi:[0,1]
    v_pk_add_f32 v[88:89], v[88:89], v[228:229] op_sel_hi:[1,0] neg_lo:[0,1] neg_hi:[0,1]
    v_pk_add_f32 v[90:91], v[90:91], v[228:229] op_sel_hi:[1,0] neg_lo:[0,1] neg_hi:[0,1]
    v_pk_add_f32 v[104:105], v[104:105], v[228:229] op_sel_hi:[1,0] neg_lo:[0,1] neg_hi:[0,1]
    v_pk_add_f32 v[106:107], v[106:107], v[228:229] op_sel_hi:[1,0] neg_lo:[0,1] neg_hi:[0,1]
    v_pk_add_f32 v[92:93], v[92:93], v[228:229] op_sel:[0,1] op_sel_hi:[1,1] neg_lo:[0,1] neg_hi:[0,1]
    v_pk_add_f32 v[94:95], v[94:95], v[228:229] op_sel:[0,1] op_sel_hi:[1,1] neg_lo:[0,1] neg_hi:[0,1]
    v_pk_add_f32 v[108:109], v[108:109], v[228:229] op_sel:[0,1] op_sel_hi:[1,1] neg_lo:[0,1] neg_hi:[0,1]
    s_add_u32 m0, m0, s100
    s_add_u32 s3, s3, s100
    buffer_load_dwordx4 v1, s[8:11], s3 offen offset:0 sc1 lds
    v_pk_add_f32 v[110:111], v[110:111], v[228:229] op_sel:[0,1] op_sel_hi:[1,1] neg_lo:[0,1] neg_hi:[0,1]
    v_pk_add_f32 v[96:97], v[96:97], v[230:231] op_sel_hi:[1,0] neg_lo:[0,1] neg_hi:[0,1]
    v_pk_add_f32 v[98:99], v[98:99], v[230:231] op_sel_hi:[1,0] neg_lo:[0,1] neg_hi:[0,1]
    v_pk_add_f32 v[112:113], v[112:113], v[230:231] op_sel_hi:[1,0] neg_lo:[0,1] neg_hi:[0,1]
    v_pk_add_f32 v[114:115], v[114:115], v[230:231] op_sel_hi:[1,0] neg_lo:[0,1] neg_hi:[0,1]
    v_pk_add_f32 v[100:101], v[100:101], v[230:231] op_sel:[0,1] op_sel_hi:[1,1] neg_lo:[0,1] neg_hi:[0,1]
    v_pk_add_f32 v[102:103], v[102:103], v[230:231] op_sel:[0,1] op_sel_hi:[1,1] neg_lo:[0,1] neg_hi:[0,1]
    v_pk_add_f32 v[116:117], v[116:117], v[230:231] op_sel:[0,1] op_sel_hi:[1,1] neg_lo:[0,1] neg_hi:[0,1]
    v_pk_add_f32 v[118:119], v[118:119], v[230:231] op_sel:[0,1] op_sel_hi:[1,1] neg_lo:[0,1] neg_hi:[0,1]
    v_pk_add_f32 v[120:121], v[120:121], v[228:229] op_sel_hi:[1,0] neg_lo:[0,1] neg_hi:[0,1]
    v_pk_add_f32 v[122:123], v[122:123], v[228:229] op_sel_hi:[1,0] neg_lo:[0,1] neg_hi:[0,1]
    buffer_load_dwordx4 v1, s[8:11], s3 offen offset:1024 sc1 lds
    v_pk_add_f32 v[124:125], v[124:125], v[228:229] op_sel:[0,1] op_sel_hi:[1,1] neg_lo:[0,1] neg_hi:[0,1]
    v_pk_add_f32 v[126:127], v[126:127], v[228:229] op_sel:[0,1] op_sel_hi:[1,1] neg_lo:[0,1] neg_hi:[0,1]
    v_pk_add_f32 v[128:129], v[128:129], v[230:231] op_sel_hi:[1,0] neg_lo:[0,1] neg_hi:[0,1]
    v_pk_add_f32 v[130:131], v[130:131], v[230:231] op_sel_hi:[1,0] neg_lo:[0,1] neg_hi:[0,1]
    v_pk_add_f32 v[132:133], v[132:133], v[230:231] op_sel:[0,1] op_sel_hi:[1,1] neg_lo:[0,1] neg_hi:[0,1]
    v_pk_add_f32 v[134:135], v[134:135], v[230:231] op_sel:[0,1] op_sel_hi:[1,1] neg_lo:[0,1] neg_hi:[0,1]
    s_mov_b32 s34, s55
    s_add_u32 s35, s34, 114688
    s_add_u32 s32, s34, s48
    s_add_u32 s33, s35, s48
    s_waitcnt vmcnt(13)
    ds_read_b64_tr_b16 v[136:137], v216 offset:0
    ds_read_b64_tr_b16 v[138:139], v216 offset:512
    s_waitcnt vmcnt(12)
    ds_read_b64_tr_b16 v[140:141], v216 offset:1024
    ds_read_b64_tr_b16 v[142:143], v216 offset:1536
    s_waitcnt lgkmcnt(2)
    v_mfma_f32_16x16x32_f16 v[24:27], v[136:139], a[224:227], v[24:27]
    s_waitcnt vmcnt(11)
    ds_read_b64_tr_b16 v[144:145], v216 offset:2048
    v_mfma_f32_16x16x32_f16 v[28:31], v[136:139], a[240:243], v[28:31]
    s_waitcnt lgkmcnt(1)
    ds_read_b64_tr_b16 v[146:147], v216 offset:2560
    v_mfma_f32_16x16x32_f16 v[24:27], v[140:143], a[228:231], v[24:27]
    s_waitcnt vmcnt(10)
    ds_read_b64_tr_b16 v[148:149], v216 offset:3072
    v_mfma_f32_16x16x32_f16 v[28:31], v[140:143], a[244:247], v[28:31]
    ds_read_b64_tr_b16 v[150:151], v216 offset:3584
    s_cmp_lg_u32 s26, 0
    s_cbranch_scc1 L_w0_94
    s_mov_b32 exec_lo, 0x01010101
    s_mov_b32 exec_hi, 0x01010101
    v_mov_b32_dpp v136, v136 row_ror:8 row_mask:0xf bank_mask:0xf
    v_mov_b32_dpp v137, v137 row_ror:8 row_mask:0xf bank_mask:0xf
    v_mov_b32_dpp v138, v138 row_ror:8 row_mask:0xf bank_mask:0xf
    v_mov_b32_dpp v139, v139 row_ror:8 row_mask:0xf bank_mask:0xf
    v_mov_b32_dpp v140, v140 row_ror:8 row_mask:0xf bank_mask:0xf
    v_mov_b32_dpp v141, v141 row_ror:8 row_mask:0xf bank_mask:0xf
    v_mov_b32_dpp v142, v142 row_ror:8 row_mask:0xf bank_mask:0xf
    v_mov_b32_dpp v143, v143 row_ror:8 row_mask:0xf bank_mask:0xf
    s_mov_b64 exec, -1
L_w0_94:
    v_mfma_f32_16x16x32_f16 v[32:35], v[136:139], a[232:235], v[32:35]
    v_mfma_f32_16x16x32_f16 v[36:39], v[136:139], a[248:251], v[36:39]
    v_cvt_pk_bf16_f32 v168, v24, v25
    v_cvt_pk_bf16_f32 v169, v26, v27
    v_mfma_f32_16x16x32_f16 v[32:35], v[140:143], a[236:239], v[32:35]
    v_cvt_pk_bf16_f32 v170, v28, v29
    v_cvt_pk_bf16_f32 v171, v30, v31
    v_mfma_f32_16x16x32_f16 v[36:39], v[140:143], a[252:255], v[36:39]
    s_waitcnt lgkmcnt(2)
    ds_write2st64_b64 v218, v[168:169], v[170:171] offset0:0 offset1:1
    v_mfma_f32_16x16x32_f16 v[40:43], v[144:147], a[224:227], v[40:43]
    s_waitcnt vmcnt(9)
    ds_read_b64_tr_b16 v[152:153], v216 offset:4096
    v_mfma_f32_16x16x32_f16 v[44:47], v[144:147], a[240:243], v[44:47]
    s_waitcnt lgkmcnt(2)
    ds_read_b64_tr_b16 v[154:155], v216 offset:4608
    v_cvt_pk_bf16_f32 v176, v32, v33
    v_mfma_f32_16x16x32_f16 v[40:43], v[148:151], a[228:231], v[40:43]
    s_waitcnt vmcnt(8)
    ds_read_b64_tr_b16 v[156:157], v216 offset:5120
    v_cvt_pk_bf16_f32 v177, v34, v35
    v_mfma_f32_16x16x32_f16 v[44:47], v[148:151], a[244:247], v[44:47]
    ds_read_b64_tr_b16 v[158:159], v216 offset:5632
    v_cvt_pk_bf16_f32 v178, v36, v37
    v_mfma_f32_16x16x32_f16 v[48:51], v[144:147], a[232:235], v[48:51]
    v_cvt_pk_bf16_f32 v179, v38, v39
    v_mfma_f32_16x16x32_f16 v[52:55], v[144:147], a[248:251], v[52:55]
    ds_write2st64_b64 v219, v[176:177], v[178:179] offset0:2 offset1:3
    v_mfma_f32_16x16x32_f16 v[48:51], v[148:151], a[236:239], v[48:51]
    v_cvt_pk_bf16_f32 v172, v40, v41
    v_cvt_pk_bf16_f32 v173, v42, v43
    v_mfma_f32_16x16x32_f16 v[52:55], v[148:151], a[252:255], v[52:55]
    s_waitcnt lgkmcnt(3)
    v_cvt_pk_bf16_f32 v174, v44, v45
    v_cvt_pk_bf16_f32 v175, v46, v47
    v_mfma_f32_16x16x32_f16 v[56:59], v[152:155], a[224:227], v[56:59]
    s_waitcnt vmcnt(7)
    ds_read_b64_tr_b16 v[160:161], v216 offset:6144
    v_sub_f32 v192, v192, v24
    v_mfma_f32_16x16x32_f16 v[60:63], v[152:155], a[240:243], v[60:63]
    s_waitcnt lgkmcnt(2)
    ds_read_b64_tr_b16 v[162:163], v216 offset:6656
    v_cvt_pk_bf16_f32 v180, v48, v49
    v_mfma_f32_16x16x32_f16 v[56:59], v[156:159], a[228:231], v[56:59]
    s_waitcnt vmcnt(6)
    ds_read_b64_tr_b16 v[164:165], v216 offset:7168
    v_cvt_pk_bf16_f32 v181, v50, v51
    v_mfma_f32_16x16x32_f16 v[60:63], v[156:159], a[244:247], v[60:63]
    ds_read_b64_tr_b16 v[166:167], v216 offset:7680
    v_cvt_pk_bf16_f32 v182, v52, v53
    v_mfma_f32_16x16x32_f16 v[64:67], v[152:155], a[232:235], v[64:67]
    ds_write2st64_b64 v218, v[172:173], v[174:175] offset0:4 offset1:5
    v_mfma_f32_16x16x32_f16 v[68:71], v[152:155], a[248:251], v[68:71]
    v_cvt_pk_bf16_f32 v168, v56, v57
    v_cvt_pk_bf16_f32 v169, v58, v59
    v_mfma_f32_16x16x32_f16 v[64:67], v[156:159], a[236:239], v[64:67]
    v_cvt_pk_bf16_f32 v170, v60, v61
    v_cvt_pk_bf16_f32 v171, v62, v63
    v_mfma_f32_16x16x32_f16 v[68:71], v[156:159], a[252:255], v[68:71]
    s_waitcnt lgkmcnt(3)
    ds_write2st64_b64 v218, v[168:169], v[170:171] offset0:8 offset1:9
    v_mfma_f32_16x16x32_f16 v[72:75], v[160:163], a[224:227], v[72:75]
    s_waitcnt vmcnt(5)
    ds_read_b64_tr_b16 v[136:137], v216 offset:8192
    v_cvt_pk_bf16_f32 v183, v54, v55
    v_mfma_f32_16x16x32_f16 v[76:79], v[160:163], a[240:243], v[76:79]
    s_waitcnt lgkmcnt(3)
    ds_read_b64_tr_b16 v[138:139], v216 offset:8704
    v_sub_f32 v193, v193, v28
    v_mfma_f32_16x16x32_f16 v[72:75], v[164:167], a[228:231], v[72:75]
    s_waitcnt vmcnt(4)
    ds_read_b64_tr_b16 v[140:141], v216 offset:9216
    v_sub_f32 v194, v194, v32
    v_mfma_f32_16x16x32_f16 v[76:79], v[164:167], a[244:247], v[76:79]
    ds_read_b64_tr_b16 v[142:143], v216 offset:9728
    v_sub_f32 v195, v195, v36
    v_mfma_f32_16x16x32_f16 v[80:83], v[160:163], a[232:235], v[80:83]
    ds_write2st64_b64 v219, v[180:181], v[182:183] offset0:6 offset1:7
    v_mfma_f32_16x16x32_f16 v[84:87], v[160:163], a[248:251], v[84:87]
    v_cvt_pk_bf16_f32 v172, v72, v73
    v_cvt_pk_bf16_f32 v173, v74, v75
    v_mfma_f32_16x16x32_f16 v[80:83], v[164:167], a[236:239], v[80:83]
    v_cvt_pk_bf16_f32 v174, v76, v77
    v_cvt_pk_bf16_f32 v175, v78, v79
    v_mfma_f32_16x16x32_f16 v[84:87], v[164:167], a[252:255], v[84:87]
    s_waitcnt lgkmcnt(3)
    ds_write2st64_b64 v218, v[172:173], v[174:175] offset0:12 offset1:13
    v_mfma_f32_16x16x32_f16 v[88:91], v[136:139], a[224:227], v[88:91]
    s_waitcnt vmcnt(3)
    ds_read_b64_tr_b16 v[144:145], v216 offset:10240
    v_cvt_pk_bf16_f32 v176, v64, v65
    v_mfma_f32_16x16x32_f16 v[92:95], v[136:139], a[240:243], v[92:95]
    s_waitcnt lgkmcnt(3)
    ds_read_b64_tr_b16 v[146:147], v216 offset:10752
    v_cvt_pk_bf16_f32 v177, v66, v67
    v_mfma_f32_16x16x32_f16 v[88:91], v[140:143], a[228:231], v[88:91]
    s_waitcnt vmcnt(2)
    ds_read_b64_tr_b16 v[148:149], v216 offset:11264
    v_cvt_pk_bf16_f32 v178, v68, v69
    v_mfma_f32_16x16x32_f16 v[92:95], v[140:143], a[244:247], v[92:95]
    ds_read_b64_tr_b16 v[150:151], v216 offset:11776
    v_cvt_pk_bf16_f32 v179, v70, v71
    v_mfma_f32_16x16x32_f16 v[96:99], v[136:139], a[232:235], v[96:99]
    ds_write2st64_b64 v219, v[176:177], v[178:179] offset0:10 offset1:11
    v_mfma_f32_16x16x32_f16 v[100:103], v[136:139], a[248:251], v[100:103]
    v_cvt_pk_bf16_f32 v168, v88, v89
    v_cvt_pk_bf16_f32 v169, v90, v91
    v_mfma_f32_16x16x32_f16 v[96:99], v[140:143], a[236:239], v[96:99]
    v_cvt_pk_bf16_f32 v170, v92, v93
    v_cvt_pk_bf16_f32 v171, v94, v95
    v_mfma_f32_16x16x32_f16 v[100:103], v[140:143], a[252:255], v[100:103]
    s_waitcnt lgkmcnt(3)
    ds_write2st64_b64 v218, v[168:169], v[170:171] offset0:16 offset1:17
    v_mfma_f32_16x16x32_f16 v[104:107], v[144:147], a[224:227], v[104:107]
    s_waitcnt vmcnt(1)
    ds_read_b64_tr_b16 v[152:153], v217 offset:0
    v_cvt_pk_bf16_f32 v180, v80, v81
    v_mfma_f32_16x16x32_f16 v[108:111], v[144:147], a[240:243], v[108:111]
    s_waitcnt lgkmcnt(3)
    ds_read_b64_tr_b16 v[154:155], v217 offset:512
    v_cvt_pk_bf16_f32 v181, v82, v83
    v_mfma_f32_16x16x32_f16 v[104:107], v[148:151], a[228:231], v[104:107]
    s_waitcnt vmcnt(0)
    ds_read_b64_tr_b16 v[156:157], v217 offset:1024
    v_cvt_pk_bf16_f32 v182, v84, v85
    v_mfma_f32_16x16x32_f16 v[108:111], v[148:151], a[244:247], v[108:111]
    ds_read_b64_tr_b16 v[158:159], v217 offset:1536
    v_cvt_pk_bf16_f32 v183, v86, v87
    v_mfma_f32_16x16x32_f16 v[112:115], v[144:147], a[232:235], v[112:115]
    ds_write2st64_b64 v219, v[180:181], v[182:183] offset0:14 offset1:15
    v_mfma_f32_16x16x32_f16 v[116:119], v[144:147], a[248:251], v[116:119]
    s_barrier
    ds_read2st64_b64 v[232:235], v4 offset0:0 offset1:4
    v_mfma_f32_16x16x32_f16 v[112:115], v[148:151], a[236:239], v[112:115]
    v_cvt_pk_bf16_f32 v176, v96, v97
    v_cvt_pk_bf16_f32 v177, v98, v99
    v_mfma_f32_16x16x32_f16 v[116:119], v[148:151], a[252:255], v[116:119]
    s_waitcnt lgkmcnt(4)
    ds_read2st64_b64 v[236:239], v4 offset0:24 offset1:28
    v_cvt_pk_bf16_f32 v178, v100, v101
    v_mfma_f32_16x16x32_f16 v[120:123], v[152:155], a[224:227], v[120:123]
    v_cvt_pk_bf16_f32 v179, v102, v103
    v_cvt_pk_bf16_f32 v172, v104, v105
    v_mfma_f32_16x16x32_f16 v[124:127], v[152:155], a[240:243], v[124:127]
    s_waitcnt lgkmcnt(3)
    ds_write2st64_b64 v219, v[176:177], v[178:179] offset0:18 offset1:19
    v_mfma_f32_16x16x32_f16 v[120:123], v[156:159], a[228:231], v[120:123]
    v_cvt_pk_bf16_f32 v173, v106, v107
    v_cvt_pk_bf16_f32 v174, v108, v109
    v_mfma_f32_16x16x32_f16 v[124:127], v[156:159], a[244:247], v[124:127]
    ds_read2st64_b64 v[240:243], v4 offset0:48 offset1:52
    v_cvt_pk_bf16_f32 v175, v110, v111
    v_mfma_f32_16x16x32_f16 v[128:131], v[152:155], a[232:235], v[128:131]
    ds_write2st64_b64 v218, v[172:173], v[174:175] offset0:20 offset1:21
    v_mfma_f32_16x16x32_f16 v[132:135], v[152:155], a[248:251], v[132:135]
    v_cvt_pk_bf16_f32 v180, v112, v113
    v_cvt_pk_bf16_f32 v181, v114, v115
    v_mfma_f32_16x16x32_f16 v[128:131], v[156:159], a[236:239], v[128:131]
    v_cvt_pk_bf16_f32 v182, v116, v117
    v_cvt_pk_bf16_f32 v183, v118, v119
    v_mfma_f32_16x16x32_f16 v[132:135], v[156:159], a[252:255], v[132:135]
    s_waitcnt lgkmcnt(4)
    ds_write2st64_b64 v219, v[180:181], v[182:183] offset0:22 offset1:23
    v_mfma_f32_16x16x32_bf16 v[200:203], a[0:3], v[232:235], 0
    ds_read2st64_b64 v[244:247], v4 offset0:72 offset1:76
    v_cvt_pk_bf16_f32 v168, v120, v121
    v_mfma_f32_16x16x32_bf16 v[204:207], a[4:7], v[232:235], 0
    v_cvt_pk_bf16_f32 v169, v122, v123
    v_cvt_pk_bf16_f32 v170, v124, v125
    v_mfma_f32_16x16x32_bf16 v[208:211], a[8:11], v[232:235], 0
    v_cvt_pk_bf16_f32 v171, v126, v127
    v_cvt_pk_bf16_f32 v176, v128, v129
    v_mfma_f32_16x16x32_bf16 v[212:215], a[12:15], v[232:235], 0
    s_waitcnt lgkmcnt(5)
    ds_write2st64_b64 v220, v[168:169], v[170:171] offset0:0 offset1:1
    v_mfma_f32_16x16x32_bf16 v[200:203], a[48:51], v[236:239], v[200:203]
    ds_read2st64_b64 v[232:235], v4 offset0:8 offset1:12
    v_cvt_pk_bf16_f32 v177, v130, v131
    v_mfma_f32_16x16x32_bf16 v[204:207], a[52:55], v[236:239], v[204:207]
    v_cvt_pk_bf16_f32 v178, v132, v133
    v_cvt_pk_bf16_f32 v179, v134, v135
    v_mfma_f32_16x16x32_bf16 v[208:211], a[56:59], v[236:239], v[208:211]
    v_mul_f32 v184, v24, v24
    v_mul_f32 v185, v28, v28
    v_mfma_f32_16x16x32_bf16 v[212:215], a[60:63], v[236:239], v[212:215]
    s_waitcnt lgkmcnt(5)
    ds_read2st64_b64 v[236:239], v4 offset0:32 offset1:36
    v_mul_f32 v186, v32, v32
    v_mfma_f32_16x16x32_bf16 v[200:203], a[96:99], v[240:243], v[200:203]
    ds_write2st64_b64 v221, v[176:177], v[178:179] offset0:2 offset1:3
    v_mfma_f32_16x16x32_bf16 v[204:207], a[100:103], v[240:243], v[204:207]
    v_mul_f32 v187, v36, v36
    v_fmac_f32 v184, v25, v25
    v_mfma_f32_16x16x32_bf16 v[208:211], a[104:107], v[240:243], v[208:211]
    s_add_u32 s63, s56, 28672
    buffer_load_dwordx4 a[240:243], v1, s[8:11], s63 offen offset:0 sc1
    v_mfma_f32_16x16x32_bf16 v[212:215], a[108:111], v[240:243], v[212:215]
    s_waitcnt lgkmcnt(4)
    ds_read2st64_b64 v[240:243], v4 offset0:56 offset1:60
    v_fmac_f32 v185, v29, v29
    v_mfma_f32_16x16x32_bf16 v[200:203], a[144:147], v[244:247], v[200:203]
    v_fmac_f32 v186, v33, v33
    v_fmac_f32 v187, v37, v37
    v_mfma_f32_16x16x32_bf16 v[204:207], a[148:151], v[244:247], v[204:207]
    s_waitcnt lgkmcnt(1)
    s_barrier
    v_fmac_f32 v184, v26, v26
    v_mfma_f32_16x16x32_bf16 v[208:211], a[152:155], v[244:247], v[208:211]
    v_fmac_f32 v185, v30, v30
    v_fmac_f32 v186, v34, v34
    v_mfma_f32_16x16x32_bf16 v[212:215], a[156:159], v[244:247], v[212:215]
    ds_read2st64_b64 v[244:247], v4 offset0:80 offset1:84
    buffer_load_dwordx4 a[244:247], v1, s[8:11], s63 offen offset:1024 sc1
    v_mfma_f32_16x16x32_bf16 v[200:203], a[16:19], v[232:235], v[200:203]
    v_fmac_f32 v187, v38, v38
    v_fmac_f32 v184, v27, v27
    v_mfma_f32_16x16x32_bf16 v[204:207], a[20:23], v[232:235], v[204:207]
    v_fmac_f32 v185, v31, v31
    v_fmac_f32 v186, v35, v35
    v_mfma_f32_16x16x32_bf16 v[208:211], a[24:27], v[232:235], v[208:211]
    v_fmac_f32 v187, v39, v39
    v_fmac_f32 v184, v40, v40
    v_mfma_f32_16x16x32_bf16 v[212:215], a[28:31], v[232:235], v[212:215]
    ds_read2st64_b64 v[232:235], v4 offset0:16 offset1:20
    v_fmac_f32 v185, v44, v44
    v_mfma_f32_16x16x32_bf16 v[200:203], a[64:67], v[236:239], v[200:203]
    buffer_load_dwordx4 a[248:251], v1, s[8:11], s63 offen offset:2048 sc1
    v_fmac_f32 v186, v48, v48
    v_mfma_f32_16x16x32_bf16 v[204:207], a[68:71], v[236:239], v[204:207]
    v_fmac_f32 v187, v52, v52
    v_fmac_f32 v184, v41, v41
    v_mfma_f32_16x16x32_bf16 v[208:211], a[72:75], v[236:239], v[208:211]
    v_fmac_f32 v185, v45, v45
    v_fmac_f32 v186, v49, v49
    v_mfma_f32_16x16x32_bf16 v[212:215], a[76:79], v[236:239], v[212:215]
    s_waitcnt lgkmcnt(2)
    ds_read2st64_b64 v[236:239], v4 offset0:40 offset1:44
    v_fmac_f32 v187, v53, v53
    v_mfma_f32_16x16x32_bf16 v[200:203], a[112:115], v[240:243], v[200:203]
    v_fmac_f32 v184, v42, v42
    v_fmac_f32 v185, v46, v46
    v_mfma_f32_16x16x32_bf16 v[204:207], a[116:119], v[240:243], v[204:207]
    buffer_load_dwordx4 a[252:255], v1, s[8:11], s63 offen offset:3072 sc1
    v_fmac_f32 v186, v50, v50
    v_mfma_f32_16x16x32_bf16 v[208:211], a[120:123], v[240:243], v[208:211]
    v_fmac_f32 v187, v54, v54
    v_fmac_f32 v184, v43, v43
    v_mfma_f32_16x16x32_bf16 v[212:215], a[124:127], v[240:243], v[212:215]
    s_waitcnt lgkmcnt(2)
    ds_read2st64_b64 v[240:243], v4 offset0:64 offset1:68
    v_fmac_f32 v185, v47, v47
    v_mfma_f32_16x16x32_bf16 v[200:203], a[160:163], v[244:247], v[200:203]
    v_fmac_f32 v186, v51, v51
    v_fmac_f32 v187, v55, v55
    v_mfma_f32_16x16x32_bf16 v[204:207], a[164:167], v[244:247], v[204:207]
    v_fmac_f32 v184, v56, v56
    v_fmac_f32 v185, v60, v60
    v_mfma_f32_16x16x32_bf16 v[208:211], a[168:171], v[244:247], v[208:211]
    s_add_u32 s63, s56, 0
    buffer_load_dwordx4 v[24:27], v1, s[8:11], s63 offen offset:0 sc1
    v_mfma_f32_16x16x32_bf16 v[212:215], a[172:175], v[244:247], v[212:215]
    s_waitcnt lgkmcnt(2)
    ds_read2st64_b64 v[244:247], v4 offset0:88 offset1:92
    v_fmac_f32 v186, v64, v64
    v_mfma_f32_16x16x32_bf16 v[200:203], a[32:35], v[232:235], v[200:203]
    v_fmac_f32 v187, v68, v68
    v_fmac_f32 v184, v57, v57
    v_mfma_f32_16x16x32_bf16 v[204:207], a[36:39], v[232:235], v[204:207]
    v_fmac_f32 v185, v61, v61
    v_fmac_f32 v186, v65, v65
    v_mfma_f32_16x16x32_bf16 v[208:211], a[40:43], v[232:235], v[208:211]
    v_fmac_f32 v187, v69, v69
    v_fmac_f32 v184, v58, v58
    v_mfma_f32_16x16x32_bf16 v[212:215], a[44:47], v[232:235], v[212:215]
    s_waitcnt lgkmcnt(2)
    ds_read2st64_b64 v[232:235], v4 offset0:96 offset1:100
    buffer_load_dwordx4 v[28:31], v1, s[8:11], s63 offen offset:1024 sc1
    v_mfma_f32_16x16x32_bf16 v[200:203], a[80:83], v[236:239], v[200:203]
    v_fmac_f32 v185, v62, v62
    v_fmac_f32 v186, v66, v66
    v_mfma_f32_16x16x32_bf16 v[204:207], a[84:87], v[236:239], v[204:207]
    v_fmac_f32 v187, v70, v70
    v_fmac_f32 v184, v59, v59
    v_mfma_f32_16x16x32_bf16 v[208:211], a[88:91], v[236:239], v[208:211]
    v_fmac_f32 v185, v63, v63
    v_fmac_f32 v186, v67, v67
    v_mfma_f32_16x16x32_bf16 v[212:215], a[92:95], v[236:239], v[212:215]
    s_waitcnt lgkmcnt(2)
    ds_read2st64_b64 v[236:239], v4 offset0:104 offset1:108
    v_fmac_f32 v187, v71, v71
    v_mfma_f32_16x16x32_bf16 v[200:203], a[128:131], v[240:243], v[200:203]
    buffer_load_dwordx4 v[32:35], v1, s[8:11], s63 offen offset:2048 sc1
    v_fmac_f32 v184, v72, v72
    v_mfma_f32_16x16x32_bf16 v[204:207], a[132:135], v[240:243], v[204:207]
    v_fmac_f32 v185, v76, v76
    v_fmac_f32 v186, v80, v80
    v_mfma_f32_16x16x32_bf16 v[208:211], a[136:139], v[240:243], v[208:211]
    v_fmac_f32 v187, v84, v84
    v_fmac_f32 v184, v73, v73
    v_mfma_f32_16x16x32_bf16 v[212:215], a[140:143], v[240:243], v[212:215]
    s_waitcnt lgkmcnt(2)
    ds_read2st64_b64 v[240:243], v5 offset0:0 offset1:4
    v_fmac_f32 v185, v77, v77
    v_mfma_f32_16x16x32_bf16 v[200:203], a[176:179], v[244:247], v[200:203]
    v_fmac_f32 v186, v81, v81
    v_fmac_f32 v187, v85, v85
    v_mfma_f32_16x16x32_bf16 v[204:207], a[180:183], v[244:247], v[204:207]
    buffer_load_dwordx4 v[36:39], v1, s[8:11], s63 offen offset:3072 sc1
    v_fmac_f32 v184, v74, v74
    v_mfma_f32_16x16x32_bf16 v[208:211], a[184:187], v[244:247], v[208:211]
    v_fmac_f32 v185, v78, v78
    v_fmac_f32 v186, v82, v82
    v_mfma_f32_16x16x32_bf16 v[212:215], a[188:191], v[244:247], v[212:215]
    s_waitcnt lgkmcnt(2)
    ds_read2st64_b64 v[244:247], v5 offset0:24 offset1:28
    v_fmac_f32 v187, v86, v86
    v_mfma_f32_16x16x32_bf16 v[200:203], a[192:195], v[232:235], v[200:203]
    v_fmac_f32 v184, v75, v75
    v_fmac_f32 v185, v79, v79
    v_mfma_f32_16x16x32_bf16 v[204:207], a[196:199], v[232:235], v[204:207]
    v_fmac_f32 v186, v83, v83
    v_fmac_f32 v187, v87, v87
    v_mfma_f32_16x16x32_bf16 v[208:211], a[200:203], v[232:235], v[208:211]
    s_add_u32 s63, s56, 4096
    buffer_load_dwordx4 v[40:43], v1, s[8:11], s63 offen offset:0 sc1
    v_mfma_f32_16x16x32_bf16 v[212:215], a[204:207], v[232:235], v[212:215]
    s_waitcnt lgkmcnt(2)
    ds_read2st64_b64 v[232:235], v5 offset0:48 offset1:52
    v_fmac_f32 v184, v88, v88
    v_mfma_f32_16x16x32_bf16 v[200:203], a[208:211], v[236:239], v[200:203]
    v_fmac_f32 v185, v92, v92
    v_fmac_f32 v186, v96, v96
    v_mfma_f32_16x16x32_bf16 v[204:207], a[212:215], v[236:239], v[204:207]
    v_fmac_f32 v187, v100, v100
    v_permlane32_swap_b32 v194, v196
    v_mfma_f32_16x16x32_bf16 v[208:211], a[216:219], v[236:239], v[208:211]
    v_permlane32_swap_b32 v195, v197
    v_lshlrev_b32 v198, 2, v2
    v_mfma_f32_16x16x32_bf16 v[212:215], a[220:223], v[236:239], v[212:215]
    s_waitcnt lgkmcnt(2)
    ds_read2st64_b64 v[236:239], v5 offset0:72 offset1:76
    buffer_load_dwordx4 v[44:47], v1, s[8:11], s63 offen offset:1024 sc1
    v_mfma_f32_16x16x32_bf16 v[216:219], a[0:3], v[240:243], 0
    v_cmp_u_f32 vcc, v200, v200
    v_cvt_pk_bf16_f32 v152, -v200, -v201
    v_mfma_f32_16x16x32_bf16 v[220:223], a[4:7], v[240:243], 0
    v_cvt_pk_bf16_f32 v153, -v202, -v203
    v_cvt_pk_bf16_f32 v154, -v204, -v205
    v_mfma_f32_16x16x32_bf16 v[224:227], a[8:11], v[240:243], 0
    s_cbranch_vccnz L_slowt
L_backt:
    v_cvt_pk_bf16_f32 v155, -v206, -v207
    v_mfma_f32_16x16x32_bf16 v[228:231], a[12:15], v[240:243], 0
    s_waitcnt lgkmcnt(2)
    ds_read2st64_b64 v[240:243], v5 offset0:8 offset1:12
    v_pk_max_u16 v152, v152, s62
    v_mfma_f32_16x16x32_bf16 v[216:219], a[48:51], v[244:247], v[216:219]
    buffer_load_dwordx4 v[48:51], v1, s[8:11], s63 offen offset:2048 sc1
    v_pk_max_u16 v153, v153, s62
    v_mfma_f32_16x16x32_bf16 v[220:223], a[52:55], v[244:247], v[220:223]
    v_pk_max_u16 v154, v154, s62
    v_pk_max_u16 v155, v155, s62
    v_mfma_f32_16x16x32_bf16 v[224:227], a[56:59], v[244:247], v[224:227]
    buffer_store_dwordx4 v[152:155], v1, s[8:11], s32 offen offset:0 sc1
    v_mfma_f32_16x16x32_bf16 v[228:231], a[60:63], v[244:247], v[228:231]
    s_waitcnt lgkmcnt(2)
    ds_read2st64_b64 v[244:247], v5 offset0:32 offset1:36
    v_cvt_pk_bf16_f32 v156, -v208, -v209
    v_mfma_f32_16x16x32_bf16 v[216:219], a[96:99], v[232:235], v[216:219]
    v_cvt_pk_bf16_f32 v157, -v210, -v211
    v_cvt_pk_bf16_f32 v158, -v212, -v213
    v_mfma_f32_16x16x32_bf16 v[220:223], a[100:103], v[232:235], v[220:223]
    buffer_load_dwordx4 v[52:55], v1, s[8:11], s63 offen offset:3072 sc1
    v_cvt_pk_bf16_f32 v159, -v214, -v215
    v_mfma_f32_16x16x32_bf16 v[224:227], a[104:107], v[232:235], v[224:227]
    v_pk_max_u16 v156, v156, s62
    v_pk_max_u16 v157, v157, s62
    v_mfma_f32_16x16x32_bf16 v[228:231], a[108:111], v[232:235], v[228:231]
    s_waitcnt lgkmcnt(2)
    ds_read2st64_b64 v[232:235], v5 offset0:56 offset1:60
    v_pk_max_u16 v158, v158, s62
    v_mfma_f32_16x16x32_bf16 v[216:219], a[144:147], v[236:239], v[216:219]
    v_pk_max_u16 v159, v159, s62
    v_add_u32 v198, 158464, v198
    v_mfma_f32_16x16x32_bf16 v[220:223], a[148:151], v[236:239], v[220:223]
    buffer_store_dwordx4 v[156:159], v1, s[8:11], s32 offen offset:2048 sc1
    v_mfma_f32_16x16x32_bf16 v[224:227], a[152:155], v[236:239], v[224:227]
    s_add_u32 s63, s56, 8192
    buffer_load_dwordx4 v[56:59], v1, s[8:11], s63 offen offset:0 sc1
    v_mfma_f32_16x16x32_bf16 v[228:231], a[156:159], v[236:239], v[228:231]
    s_waitcnt lgkmcnt(2)
    ds_read2st64_b64 v[236:239], v5 offset0:80 offset1:84
    v_fmac_f32 v184, v89, v89
    v_mfma_f32_16x16x32_bf16 v[216:219], a[16:19], v[240:243], v[216:219]
    s_mov_b32 exec_lo, s96
    s_mov_b32 exec_hi, 0
    ds_write2_b32 v198, v192, v193 offset0:0 offset1:16
    s_mov_b64 exec, -1
    v_mfma_f32_16x16x32_bf16 v[220:223], a[20:23], v[240:243], v[220:223]
    s_mov_b32 exec_lo, s96
    s_mov_b32 exec_hi, 0
    ds_write2_b32 v198, v196, v197 offset0:32 offset1:48
    s_mov_b64 exec, -1
    v_mfma_f32_16x16x32_bf16 v[224:227], a[24:27], v[240:243], v[224:227]
    v_fmac_f32 v185, v93, v93
    v_fmac_f32 v186, v97, v97
    v_mfma_f32_16x16x32_bf16 v[228:231], a[28:31], v[240:243], v[228:231]
    s_waitcnt lgkmcnt(4)
    ds_read2st64_b64 v[240:243], v5 offset0:16 offset1:20
    buffer_load_dwordx4 v[60:63], v1, s[8:11], s63 offen offset:1024 sc1
    v_mfma_f32_16x16x32_bf16 v[216:219], a[64:67], v[244:247], v[216:219]
    v_fmac_f32 v187, v101, v101
    v_fmac_f32 v184, v90, v90
    v_mfma_f32_16x16x32_bf16 v[220:223], a[68:71], v[244:247], v[220:223]
    v_fmac_f32 v185, v94, v94
    v_fmac_f32 v186, v98, v98
    v_mfma_f32_16x16x32_bf16 v[224:227], a[72:75], v[244:247], v[224:227]
    v_fmac_f32 v187, v102, v102
    v_fmac_f32 v184, v91, v91
    v_mfma_f32_16x16x32_bf16 v[228:231], a[76:79], v[244:247], v[228:231]
    s_waitcnt lgkmcnt(4)
    ds_read2st64_b64 v[244:247], v5 offset0:40 offset1:44
    v_fmac_f32 v185, v95, v95
    v_mfma_f32_16x16x32_bf16 v[216:219], a[112:115], v[232:235], v[216:219]
    buffer_load_dwordx4 v[64:67], v1, s[8:11], s63 offen offset:2048 sc1
    v_fmac_f32 v186, v99, v99
    v_mfma_f32_16x16x32_bf16 v[220:223], a[116:119], v[232:235], v[220:223]
    v_fmac_f32 v187, v103, v103
    v_fmac_f32 v184, v104, v104
    v_mfma_f32_16x16x32_bf16 v[224:227], a[120:123], v[232:235], v[224:227]
    v_fmac_f32 v185, v108, v108
    v_fmac_f32 v186, v112, v112
    v_mfma_f32_16x16x32_bf16 v[228:231], a[124:127], v[232:235], v[228:231]
    s_waitcnt lgkmcnt(4)
    ds_read2st64_b64 v[232:235], v5 offset0:64 offset1:68
    v_fmac_f32 v187, v116, v116
    v_mfma_f32_16x16x32_bf16 v[216:219], a[160:163], v[236:239], v[216:219]
    v_fmac_f32 v184, v105, v105
    v_fmac_f32 v185, v109, v109
    v_mfma_f32_16x16x32_bf16 v[220:223], a[164:167], v[236:239], v[220:223]
    buffer_load_dwordx4 v[68:71], v1, s[8:11], s63 offen offset:3072 sc1
    v_fmac_f32 v186, v113, v113
    v_mfma_f32_16x16x32_bf16 v[224:227], a[168:171], v[236:239], v[224:227]
    v_fmac_f32 v187, v117, v117
    v_fmac_f32 v184, v106, v106
    v_mfma_f32_16x16x32_bf16 v[228:231], a[172:175], v[236:239], v[228:231]
    s_waitcnt lgkmcnt(2)
    ds_read2st64_b64 v[236:239], v5 offset0:88 offset1:92
    v_fmac_f32 v185, v110, v110
    v_mfma_f32_16x16x32_bf16 v[216:219], a[32:35], v[240:243], v[216:219]
    v_fmac_f32 v186, v114, v114
    v_fmac_f32 v187, v118, v118
    v_mfma_f32_16x16x32_bf16 v[220:223], a[36:39], v[240:243], v[220:223]
    v_fmac_f32 v184, v107, v107
    v_fmac_f32 v185, v111, v111
    v_mfma_f32_16x16x32_bf16 v[224:227], a[40:43], v[240:243], v[224:227]
    s_add_u32 s63, s56, 12288
    buffer_load_dwordx4 v[72:75], v1, s[8:11], s63 offen offset:0 sc1
    v_mfma_f32_16x16x32_bf16 v[228:231], a[44:47], v[240:243], v[228:231]
    s_waitcnt lgkmcnt(2)
    ds_read2st64_b64 v[240:243], v5 offset0:96 offset1:100
    v_fmac_f32 v186, v115, v115
    v_mfma_f32_16x16x32_bf16 v[216:219], a[80:83], v[244:247], v[216:219]
    v_fmac_f32 v187, v119, v119
    v_fmac_f32 v184, v120, v120
    v_mfma_f32_16x16x32_bf16 v[220:223], a[84:87], v[244:247], v[220:223]
    v_fmac_f32 v185, v124, v124
    v_fmac_f32 v186, v128, v128
    v_mfma_f32_16x16x32_bf16 v[224:227], a[88:91], v[244:247], v[224:227]
    v_fmac_f32 v187, v132, v132
    v_fmac_f32 v184, v121, v121
    v_mfma_f32_16x16x32_bf16 v[228:231], a[92:95], v[244:247], v[228:231]
    s_waitcnt lgkmcnt(2)
    ds_read2st64_b64 v[244:247], v5 offset0:104 offset1:108
    buffer_load_dwordx4 v[76:79], v1, s[8:11], s63 offen offset:1024 sc1
    v_mfma_f32_16x16x32_bf16 v[216:219], a[128:131], v[232:235], v[216:219]
    v_fmac_f32 v185, v125, v125
    v_fmac_f32 v186, v129, v129
    v_mfma_f32_16x16x32_bf16 v[220:223], a[132:135], v[232:235], v[220:223]
    v_fmac_f32 v187, v133, v133
    v_fmac_f32 v184, v122, v122
    v_mfma_f32_16x16x32_bf16 v[224:227], a[136:139], v[232:235], v[224:227]
    v_fmac_f32 v185, v126, v126
    v_fmac_f32 v186, v130, v130
    v_mfma_f32_16x16x32_bf16 v[228:231], a[140:143], v[232:235], v[228:231]
    s_waitcnt lgkmcnt(2)
    ds_read2st64_b64 v[232:235], v4 offset0:2 offset1:6
    v_fmac_f32 v187, v134, v134
    v_mfma_f32_16x16x32_bf16 v[216:219], a[176:179], v[236:239], v[216:219]
    buffer_load_dwordx4 v[80:83], v1, s[8:11], s63 offen offset:2048 sc1
    v_fmac_f32 v184, v123, v123
    v_mfma_f32_16x16x32_bf16 v[220:223], a[180:183], v[236:239], v[220:223]
    v_fmac_f32 v185, v127, v127
    v_fmac_f32 v186, v131, v131
    v_mfma_f32_16x16x32_bf16 v[224:227], a[184:187], v[236:239], v[224:227]
    v_fmac_f32 v187, v135, v135
    v_permlane32_swap_b32 v184, v185
    v_mfma_f32_16x16x32_bf16 v[228:231], a[188:191], v[236:239], v[228:231]
    s_waitcnt lgkmcnt(2)
    ds_read2st64_b64 v[236:239], v4 offset0:26 offset1:30
    v_permlane32_swap_b32 v186, v187
    v_mfma_f32_16x16x32_bf16 v[216:219], a[192:195], v[240:243], v[216:219]
    v_add_f32 v184, v184, v185
    v_add_f32 v186, v186, v187
    v_mfma_f32_16x16x32_bf16 v[220:223], a[196:199], v[240:243], v[220:223]
    buffer_load_dwordx4 v[84:87], v1, s[8:11], s63 offen offset:3072 sc1
    v_and_b32 v185, 1, v3
    v_mfma_f32_16x16x32_bf16 v[224:227], a[200:203], v[240:243], v[224:227]
    v_lshlrev_b32 v185, 9, v185
    v_lshrrev_b32 v187, 1, v3
    v_mfma_f32_16x16x32_bf16 v[228:231], a[204:207], v[240:243], v[228:231]
    s_waitcnt lgkmcnt(2)
    ds_read2st64_b64 v[240:243], v4 offset0:50 offset1:54
    v_lshl_add_u32 v185, v187, 8, v185
    v_mfma_f32_16x16x32_bf16 v[216:219], a[208:211], v[244:247], v[216:219]
    v_permlane16_swap_b32 v184, v186
    v_lshl_add_u32 v185, v2, 4, v185
    v_mfma_f32_16x16x32_bf16 v[220:223], a[212:215], v[244:247], v[220:223]
    s_lshl_b32 s36, s26, 2
    s_add_u32 s36, s36, 158720
    v_add_u32 v185, s36, v185
    v_mfma_f32_16x16x32_bf16 v[224:227], a[216:219], v[244:247], v[224:227]
    s_add_u32 s63, s56, 16384
    buffer_load_dwordx4 v[88:91], v1, s[8:11], s63 offen offset:0 sc1
    v_mfma_f32_16x16x32_bf16 v[228:231], a[220:223], v[244:247], v[228:231]
    s_waitcnt lgkmcnt(2)
    ds_read2st64_b64 v[244:247], v4 offset0:74 offset1:78
    v_add_f32 v184, v184, v186
    v_mfma_f32_16x16x32_bf16 v[200:203], a[0:3], v[232:235], 0
    ds_write_b32 v185, v184
    v_mfma_f32_16x16x32_bf16 v[204:207], a[4:7], v[232:235], 0
    v_cvt_pk_bf16_f32 v192, -v216, -v217
    v_cvt_pk_bf16_f32 v193, -v218, -v219
    v_mfma_f32_16x16x32_bf16 v[208:211], a[8:11], v[232:235], 0
    v_cvt_pk_bf16_f32 v194, -v220, -v221
    v_cvt_pk_bf16_f32 v195, -v222, -v223
    v_mfma_f32_16x16x32_bf16 v[212:215], a[12:15], v[232:235], 0
    s_waitcnt lgkmcnt(3)
    ds_read2st64_b64 v[232:235], v4 offset0:10 offset1:14
    buffer_load_dwordx4 v[92:95], v1, s[8:11], s63 offen offset:1024 sc1
    v_mfma_f32_16x16x32_bf16 v[200:203], a[48:51], v[236:239], v[200:203]
    v_pk_max_u16 v192, v192, s62
    v_pk_max_u16 v193, v193, s62
    v_mfma_f32_16x16x32_bf16 v[204:207], a[52:55], v[236:239], v[204:207]
    v_pk_max_u16 v194, v194, s62
    v_pk_max_u16 v195, v195, s62
    v_mfma_f32_16x16x32_bf16 v[208:211], a[56:59], v[236:239], v[208:211]
    buffer_store_dwordx4 v[192:195], v1, s[8:11], s32 offen offset:1024 sc1
    v_mfma_f32_16x16x32_bf16 v[212:215], a[60:63], v[236:239], v[212:215]
    s_waitcnt lgkmcnt(3)
    ds_read2st64_b64 v[236:239], v4 offset0:34 offset1:38
    v_cvt_pk_bf16_f32 v196, -v224, -v225
    v_mfma_f32_16x16x32_bf16 v[200:203], a[96:99], v[240:243], v[200:203]
    buffer_load_dwordx4 v[96:99], v1, s[8:11], s63 offen offset:2048 sc1
    v_cvt_pk_bf16_f32 v197, -v226, -v227
    v_mfma_f32_16x16x32_bf16 v[204:207], a[100:103], v[240:243], v[204:207]
    v_cvt_pk_bf16_f32 v198, -v228, -v229
    v_cvt_pk_bf16_f32 v199, -v230, -v231
    v_mfma_f32_16x16x32_bf16 v[208:211], a[104:107], v[240:243], v[208:211]
    v_pk_max_u16 v196, v196, s62
    v_pk_max_u16 v197, v197, s62
    v_mfma_f32_16x16x32_bf16 v[212:215], a[108:111], v[240:243], v[212:215]
    s_waitcnt lgkmcnt(3)
    ds_read2st64_b64 v[240:243], v4 offset0:58 offset1:62
    v_pk_max_u16 v198, v198, s62
    v_mfma_f32_16x16x32_bf16 v[200:203], a[144:147], v[244:247], v[200:203]
    v_pk_max_u16 v199, v199, s62
    v_mfma_f32_16x16x32_bf16 v[204:207], a[148:151], v[244:247], v[204:207]
    buffer_store_dwordx4 v[196:199], v1, s[8:11], s32 offen offset:3072 sc1
    v_mfma_f32_16x16x32_bf16 v[208:211], a[152:155], v[244:247], v[208:211]
    buffer_load_dwordx4 v[100:103], v1, s[8:11], s63 offen offset:3072 sc1
    v_mfma_f32_16x16x32_bf16 v[212:215], a[156:159], v[244:247], v[212:215]
    s_waitcnt lgkmcnt(2)
    ds_read2st64_b64 v[244:247], v4 offset0:82 offset1:86
    v_mfma_f32_16x16x32_bf16 v[200:203], a[16:19], v[232:235], v[200:203]
    s_barrier
    v_mfma_f32_16x16x32_bf16 v[204:207], a[20:23], v[232:235], v[204:207]
    s_lshr_b32 s36, s26, 1
    s_lshl_b32 s36, s36, 6
    v_lshl_add_u32 v22, v2, 2, s36
    v_mfma_f32_16x16x32_bf16 v[208:211], a[24:27], v[232:235], v[208:211]
    s_add_u32 s63, s56, 20480
    buffer_load_dwordx4 v[104:107], v1, s[8:11], s63 offen offset:0 sc1
    v_mfma_f32_16x16x32_bf16 v[212:215], a[28:31], v[232:235], v[212:215]
    s_waitcnt lgkmcnt(2)
    ds_read2st64_b64 v[232:235], v4 offset0:18 offset1:22
    v_lshlrev_b32 v23, 2, v22
    v_mfma_f32_16x16x32_bf16 v[200:203], a[64:67], v[236:239], v[200:203]
    v_add_u32 v23, 158720, v23
    v_add_u32 v22, 158464, v22
    v_mfma_f32_16x16x32_bf16 v[204:207], a[68:71], v[236:239], v[204:207]
    ds_read_b128 v[140:143], v23
    v_mfma_f32_16x16x32_bf16 v[208:211], a[72:75], v[236:239], v[208:211]
    ds_read_b32 v150, v22
    v_mfma_f32_16x16x32_bf16 v[212:215], a[76:79], v[236:239], v[212:215]
    s_waitcnt lgkmcnt(4)
    ds_read2st64_b64 v[236:239], v4 offset0:42 offset1:46
    buffer_load_dwordx4 v[108:111], v1, s[8:11], s63 offen offset:1024 sc1
    v_mfma_f32_16x16x32_bf16 v[200:203], a[112:115], v[240:243], v[200:203]
    ds_read_b64 v[144:145], v9 offset:0
    v_mfma_f32_16x16x32_bf16 v[204:207], a[116:119], v[240:243], v[204:207]
    ds_read_b32 v148, v10 offset:0
    v_mfma_f32_16x16x32_bf16 v[208:211], a[120:123], v[240:243], v[208:211]
    ds_read_b64 v[146:147], v11 offset:0
    v_mfma_f32_16x16x32_bf16 v[212:215], a[124:127], v[240:243], v[212:215]
    s_waitcnt lgkmcnt(7)
    ds_read2st64_b64 v[240:243], v4 offset0:66 offset1:70
    v_mfma_f32_16x16x32_bf16 v[200:203], a[160:163], v[244:247], v[200:203]
    buffer_load_dwordx4 v[112:115], v1, s[8:11], s63 offen offset:2048 sc1
    ds_read_b32 v149, v12 offset:0
    v_mfma_f32_16x16x32_bf16 v[204:207], a[164:167], v[244:247], v[204:207]
    s_waitcnt lgkmcnt(7)
    v_mov_b32 v151, 0x3727c5ac
    v_add_f32 v140, v140, v141
    v_mfma_f32_16x16x32_bf16 v[208:211], a[168:171], v[244:247], v[208:211]
    v_add_f32 v142, v142, v143
    v_add_f32 v140, v140, v142
    v_mfma_f32_16x16x32_bf16 v[212:215], a[172:175], v[244:247], v[212:215]
    ds_read2st64_b64 v[244:247], v4 offset0:90 offset1:94
    v_fmac_f32 v151, 0x3b124925, v140
    v_mfma_f32_16x16x32_bf16 v[200:203], a[32:35], v[232:235], v[200:203]
    v_rsq_f32 v18, v151
    v_mfma_f32_16x16x32_bf16 v[204:207], a[36:39], v[232:235], v[204:207]
    s_waitcnt lgkmcnt(4)
    buffer_load_dwordx4 v[116:119], v1, s[8:11], s63 offen offset:3072 sc1
    v_perm_b32 v136, v148, v144, s58
    v_mfma_f32_16x16x32_bf16 v[208:211], a[40:43], v[232:235], v[208:211]
    v_perm_b32 v137, v145, v144, s59
    v_perm_b32 v138, v145, v145, s58
    v_mfma_f32_16x16x32_bf16 v[212:215], a[44:47], v[232:235], v[212:215]
    ds_read2st64_b64 v[232:235], v4 offset0:98 offset1:102
    v_perm_b32 v139, v144, v145, s59
    v_mfma_f32_16x16x32_bf16 v[200:203], a[80:83], v[236:239], v[200:203]
    s_waitcnt lgkmcnt(2)
    v_perm_b32 v140, v149, v146, s58
    v_perm_b32 v141, v147, v146, s59
    v_mfma_f32_16x16x32_bf16 v[204:207], a[84:87], v[236:239], v[204:207]
    v_perm_b32 v142, v147, v147, s58
    v_perm_b32 v143, v146, v147, s59
    v_mfma_f32_16x16x32_bf16 v[208:211], a[88:91], v[236:239], v[208:211]
    s_add_u32 s63, s56, 24576
    buffer_load_dwordx4 v[120:123], v1, s[8:11], s63 offen offset:0 sc1
    v_mfma_f32_16x16x32_bf16 v[212:215], a[92:95], v[236:239], v[212:215]
    ds_read2st64_b64 v[236:239], v4 offset0:106 offset1:110
    v_xor_b32 v18, 0x80000000, v18
    v_mfma_f32_16x16x32_bf16 v[200:203], a[128:131], v[240:243], v[200:203]
    v_mul_f32 v151, v151, v18
    v_mul_f32 v150, v150, v151
    v_mfma_f32_16x16x32_bf16 v[204:207], a[132:135], v[240:243], v[204:207]
    v_fma_f32 v136, v136, v151, v150
    v_fma_f32 v137, v137, v151, v150
    v_mfma_f32_16x16x32_bf16 v[208:211], a[136:139], v[240:243], v[208:211]
    v_fma_f32 v138, v138, v151, v150
    v_fma_f32 v139, v139, v151, v150
    v_mfma_f32_16x16x32_bf16 v[212:215], a[140:143], v[240:243], v[212:215]
    s_waitcnt lgkmcnt(2)
    ds_read2st64_b64 v[240:243], v5 offset0:2 offset1:6
    buffer_load_dwordx4 v[124:127], v1, s[8:11], s63 offen offset:1024 sc1
    v_mfma_f32_16x16x32_bf16 v[200:203], a[176:179], v[244:247], v[200:203]
    v_fma_f32 v140, v140, v151, v150
    v_fma_f32 v141, v141, v151, v150
    v_mfma_f32_16x16x32_bf16 v[204:207], a[180:183], v[244:247], v[204:207]
    v_fma_f32 v142, v142, v151, v150
    v_fma_f32 v143, v143, v151, v150
    v_mfma_f32_16x16x32_bf16 v[208:211], a[184:187], v[244:247], v[208:211]
    s_lshr_b32 s36, s26, 1
    s_lshl_b32 s36, s36, 6
    v_lshl_add_u32 v22, v2, 2, s36
    v_mfma_f32_16x16x32_bf16 v[212:215], a[188:191], v[244:247], v[212:215]
    s_waitcnt lgkmcnt(2)
    ds_read2st64_b64 v[244:247], v5 offset0:26 offset1:30
    v_lshlrev_b32 v23, 2, v22
    v_mfma_f32_16x16x32_bf16 v[200:203], a[192:195], v[232:235], v[200:203]
    buffer_load_dwordx4 v[128:131], v1, s[8:11], s63 offen offset:2048 sc1
    v_add_u32 v23, 159232, v23
    v_mfma_f32_16x16x32_bf16 v[204:207], a[196:199], v[232:235], v[204:207]
    v_add_u32 v22, 158592, v22
    v_mfma_f32_16x16x32_bf16 v[208:211], a[200:203], v[232:235], v[208:211]
    ds_read_b128 v[172:175], v23
    v_mfma_f32_16x16x32_bf16 v[212:215], a[204:207], v[232:235], v[212:215]
    s_waitcnt lgkmcnt(3)
    ds_read2st64_b64 v[232:235], v5 offset0:50 offset1:54
    v_mfma_f32_16x16x32_bf16 v[200:203], a[208:211], v[236:239], v[200:203]
    ds_read_b32 v150, v22
    v_mfma_f32_16x16x32_bf16 v[204:207], a[212:215], v[236:239], v[204:207]
    buffer_load_dwordx4 v[132:135], v1, s[8:11], s63 offen offset:3072 sc1
    ds_read_b64 v[144:145], v9 offset:1024
    v_mfma_f32_16x16x32_bf16 v[208:211], a[216:219], v[236:239], v[208:211]
    ds_read_b32 v148, v10 offset:1024
    v_mfma_f32_16x16x32_bf16 v[212:215], a[220:223], v[236:239], v[212:215]
    s_waitcnt lgkmcnt(6)
    ds_read2st64_b64 v[236:239], v5 offset0:74 offset1:78
    v_mfma_f32_16x16x32_bf16 v[160:163], a[0:3], v[240:243], 0
    ds_read_b64 v[146:147], v11 offset:1024
    v_cvt_pk_bf16_f32 v184, -v200, -v201
    v_mfma_f32_16x16x32_bf16 v[164:167], a[4:7], v[240:243], 0
    ds_read_b32 v149, v12 offset:1024
    v_cvt_pk_bf16_f32 v185, -v202, -v203
    v_mfma_f32_16x16x32_bf16 v[176:179], a[8:11], v[240:243], 0
    v_cvt_pk_bf16_f32 v186, -v204, -v205
    v_cvt_pk_bf16_f32 v187, -v206, -v207
    v_mfma_f32_16x16x32_bf16 v[180:183], a[12:15], v[240:243], 0
    s_waitcnt lgkmcnt(8)
    ds_read2st64_b64 v[240:243], v5 offset0:10 offset1:14
    v_pk_max_u16 v184, v184, s62
    v_mfma_f32_16x16x32_bf16 v[160:163], a[48:51], v[244:247], v[160:163]
    v_pk_max_u16 v185, v185, s62
    v_pk_max_u16 v186, v186, s62
    v_mfma_f32_16x16x32_bf16 v[164:167], a[52:55], v[244:247], v[164:167]
    v_pk_max_u16 v187, v187, s62
    v_mov_b32 v151, 0x3727c5ac
    v_mfma_f32_16x16x32_bf16 v[176:179], a[56:59], v[244:247], v[176:179]
    buffer_store_dwordx4 v[184:187], v1, s[8:11], s33 offen offset:0 sc1
    v_mfma_f32_16x16x32_bf16 v[180:183], a[60:63], v[244:247], v[180:183]
    s_waitcnt lgkmcnt(7)
    ds_read2st64_b64 v[244:247], v5 offset0:34 offset1:38
    v_cvt_pk_bf16_f32 v188, -v208, -v209
    v_mfma_f32_16x16x32_bf16 v[160:163], a[96:99], v[232:235], v[160:163]
    v_cvt_pk_bf16_f32 v189, -v210, -v211
    v_cvt_pk_bf16_f32 v190, -v212, -v213
    v_mfma_f32_16x16x32_bf16 v[164:167], a[100:103], v[232:235], v[164:167]
    v_cvt_pk_bf16_f32 v191, -v214, -v215
    v_pk_max_u16 v188, v188, s62
    v_mfma_f32_16x16x32_bf16 v[176:179], a[104:107], v[232:235], v[176:179]
    v_pk_max_u16 v189, v189, s62
    v_pk_max_u16 v190, v190, s62
    v_mfma_f32_16x16x32_bf16 v[180:183], a[108:111], v[232:235], v[180:183]
    s_waitcnt lgkmcnt(4)
    ds_read2st64_b64 v[232:235], v5 offset0:58 offset1:62
    v_pk_max_u16 v191, v191, s62
    v_mfma_f32_16x16x32_bf16 v[160:163], a[144:147], v[236:239], v[160:163]
    buffer_store_dwordx4 v[188:191], v1, s[8:11], s33 offen offset:2048 sc1
    v_mfma_f32_16x16x32_bf16 v[164:167], a[148:151], v[236:239], v[164:167]
    s_add_u32 s63, s34, s49
    buffer_load_dwordx4 v[216:219], v1, s[8:11], s63 offen offset:0 sc1
    v_mfma_f32_16x16x32_bf16 v[176:179], a[152:155], v[236:239], v[176:179]
    v_add_f32 v172, v172, v173
    v_add_f32 v174, v174, v175
    v_mfma_f32_16x16x32_bf16 v[180:183], a[156:159], v[236:239], v[180:183]
    s_waitcnt lgkmcnt(2)
    ds_read2st64_b64 v[236:239], v5 offset0:82 offset1:86
    v_add_f32 v172, v172, v174
    v_mfma_f32_16x16x32_bf16 v[160:163], a[16:19], v[240:243], v[160:163]
    buffer_load_dwordx4 v[220:223], v1, s[8:11], s63 offen offset:2048 sc1
    v_fmac_f32 v151, 0x3b124925, v172
    v_mfma_f32_16x16x32_bf16 v[164:167], a[20:23], v[240:243], v[164:167]
    v_rsq_f32 v19, v151
    v_mfma_f32_16x16x32_bf16 v[176:179], a[24:27], v[240:243], v[176:179]
    v_perm_b32 v168, v148, v144, s58
    v_perm_b32 v169, v145, v144, s59
    v_mfma_f32_16x16x32_bf16 v[180:183], a[28:31], v[240:243], v[180:183]
    s_waitcnt lgkmcnt(2)
    ds_read2st64_b64 v[240:243], v5 offset0:18 offset1:22
    v_perm_b32 v170, v145, v145, s58
    v_mfma_f32_16x16x32_bf16 v[160:163], a[64:67], v[244:247], v[160:163]
    s_add_u32 s63, s34, s50
    buffer_load_dwordx4 v[224:227], v1, s[8:11], s63 offen offset:0 sc1
    v_mfma_f32_16x16x32_bf16 v[164:167], a[68:71], v[244:247], v[164:167]
    v_perm_b32 v171, v144, v145, s59
    v_perm_b32 v172, v149, v146, s58
    v_mfma_f32_16x16x32_bf16 v[176:179], a[72:75], v[244:247], v[176:179]
    v_perm_b32 v173, v147, v146, s59
    v_perm_b32 v174, v147, v147, s58
    v_mfma_f32_16x16x32_bf16 v[180:183], a[76:79], v[244:247], v[180:183]
    s_waitcnt lgkmcnt(2)
    ds_read2st64_b64 v[244:247], v5 offset0:42 offset1:46
    v_perm_b32 v175, v146, v147, s59
    v_mfma_f32_16x16x32_bf16 v[160:163], a[112:115], v[232:235], v[160:163]
    buffer_load_dwordx4 v[228:231], v1, s[8:11], s63 offen offset:2048 sc1
    v_xor_b32 v19, 0x80000000, v19
    v_mfma_f32_16x16x32_bf16 v[164:167], a[116:119], v[232:235], v[164:167]
    v_mul_f32 v151, v151, v19
    v_mul_f32 v150, v150, v151
    v_mfma_f32_16x16x32_bf16 v[176:179], a[120:123], v[232:235], v[176:179]
    v_fma_f32 v168, v168, v151, v150
    v_fma_f32 v169, v169, v151, v150
    v_mfma_f32_16x16x32_bf16 v[180:183], a[124:127], v[232:235], v[180:183]
    s_waitcnt lgkmcnt(2)
    ds_read2st64_b64 v[232:235], v5 offset0:66 offset1:70
    v_fma_f32 v170, v170, v151, v150
    v_mfma_f32_16x16x32_bf16 v[160:163], a[160:163], v[236:239], v[160:163]
    s_add_u32 s63, s34, s49
    buffer_load_dwordx4 v[200:203], v1, s[8:11], s63 offen offset:1024 sc1
    v_mfma_f32_16x16x32_bf16 v[164:167], a[164:167], v[236:239], v[164:167]
    v_fma_f32 v171, v171, v151, v150
    v_fma_f32 v172, v172, v151, v150
    v_mfma_f32_16x16x32_bf16 v[176:179], a[168:171], v[236:239], v[176:179]
    v_fma_f32 v173, v173, v151, v150
    v_fma_f32 v174, v174, v151, v150
    v_mfma_f32_16x16x32_bf16 v[180:183], a[172:175], v[236:239], v[180:183]
    s_waitcnt lgkmcnt(2)
    ds_read2st64_b64 v[236:239], v5 offset0:90 offset1:94
    v_fma_f32 v175, v175, v151, v150
    v_mfma_f32_16x16x32_bf16 v[160:163], a[32:35], v[240:243], v[160:163]
    buffer_load_dwordx4 v[204:207], v1, s[8:11], s63 offen offset:3072 sc1
    v_mfma_f32_16x16x32_bf16 v[164:167], a[36:39], v[240:243], v[164:167]
    v_mfma_f32_16x16x32_bf16 v[176:179], a[40:43], v[240:243], v[176:179]
    v_mfma_f32_16x16x32_bf16 v[180:183], a[44:47], v[240:243], v[180:183]
    s_waitcnt lgkmcnt(2)
    ds_read2st64_b64 v[240:243], v5 offset0:98 offset1:102
    v_mfma_f32_16x16x32_bf16 v[160:163], a[80:83], v[244:247], v[160:163]
    s_add_u32 s63, s34, s50
    buffer_load_dwordx4 v[208:211], v1, s[8:11], s63 offen offset:1024 sc1
    v_mfma_f32_16x16x32_bf16 v[164:167], a[84:87], v[244:247], v[164:167]
    v_mfma_f32_16x16x32_bf16 v[176:179], a[88:91], v[244:247], v[176:179]
    v_mfma_f32_16x16x32_bf16 v[180:183], a[92:95], v[244:247], v[180:183]
    s_waitcnt lgkmcnt(2)
    ds_read2st64_b64 v[244:247], v5 offset0:106 offset1:110
    v_mfma_f32_16x16x32_bf16 v[160:163], a[128:131], v[232:235], v[160:163]
    buffer_load_dwordx4 v[212:215], v1, s[8:11], s63 offen offset:3072 sc1
    v_mfma_f32_16x16x32_bf16 v[164:167], a[132:135], v[232:235], v[164:167]
    v_mfma_f32_16x16x32_bf16 v[176:179], a[136:139], v[232:235], v[176:179]
    v_mfma_f32_16x16x32_bf16 v[180:183], a[140:143], v[232:235], v[180:183]
    s_waitcnt lgkmcnt(2)
    v_mfma_f32_16x16x32_bf16 v[160:163], a[176:179], v[236:239], v[160:163]
    v_mfma_f32_16x16x32_bf16 v[164:167], a[180:183], v[236:239], v[164:167]
    v_mfma_f32_16x16x32_bf16 v[176:179], a[184:187], v[236:239], v[176:179]
    v_mfma_f32_16x16x32_bf16 v[180:183], a[188:191], v[236:239], v[180:183]
    s_waitcnt lgkmcnt(1)
    v_mfma_f32_16x16x32_bf16 v[160:163], a[192:195], v[240:243], v[160:163]
    v_mfma_f32_16x16x32_bf16 v[164:167], a[196:199], v[240:243], v[164:167]
    v_mfma_f32_16x16x32_bf16 v[176:179], a[200:203], v[240:243], v[176:179]
    v_mfma_f32_16x16x32_bf16 v[180:183], a[204:207], v[240:243], v[180:183]
    s_waitcnt lgkmcnt(0)
    v_mfma_f32_16x16x32_bf16 v[160:163], a[208:211], v[244:247], v[160:163]
    v_mfma_f32_16x16x32_bf16 v[164:167], a[212:215], v[244:247], v[164:167]
    v_mfma_f32_16x16x32_bf16 v[176:179], a[216:219], v[244:247], v[176:179]
    v_mfma_f32_16x16x32_bf16 v[180:183], a[220:223], v[244:247], v[180:183]
    s_waitcnt vmcnt(41)
    v_mfma_f32_16x16x32_bf16 v[136:139], v[24:27], v[152:155], v[136:139]
    s_waitcnt vmcnt(40)
    v_mfma_f32_16x16x32_bf16 v[140:143], v[28:31], v[152:155], v[140:143]
    s_waitcnt vmcnt(39)
    v_mfma_f32_16x16x32_bf16 v[144:147], v[32:35], v[152:155], 0
    s_waitcnt vmcnt(38)
    v_mfma_f32_16x16x32_bf16 v[148:151], v[36:39], v[152:155], 0
    s_waitcnt vmcnt(37)
    v_mfma_f32_16x16x32_bf16 v[136:139], v[40:43], v[156:159], v[136:139]
    s_waitcnt vmcnt(36)
    v_cvt_pk_bf16_f32 v248, -v160, -v161
    v_cvt_pk_bf16_f32 v249, -v162, -v163
    v_mfma_f32_16x16x32_bf16 v[140:143], v[44:47], v[156:159], v[140:143]
    s_waitcnt vmcnt(35)
    v_cvt_pk_bf16_f32 v250, -v164, -v165
    v_cvt_pk_bf16_f32 v251, -v166, -v167
    v_mfma_f32_16x16x32_bf16 v[144:147], v[48:51], v[156:159], v[144:147]
    s_waitcnt vmcnt(33)
    v_pk_max_u16 v248, v248, s62
    v_pk_max_u16 v249, v249, s62
    v_mfma_f32_16x16x32_bf16 v[148:151], v[52:55], v[156:159], v[148:151]
    v_pk_max_u16 v250, v250, s62
    v_pk_max_u16 v251, v251, s62
    v_mfma_f32_16x16x32_bf16 v[152:155], v[24:27], v[192:195], 0
    buffer_store_dwordx4 v[248:251], v1, s[8:11], s33 offen offset:1024 sc1
    v_mfma_f32_16x16x32_bf16 v[156:159], v[28:31], v[192:195], 0
    v_cvt_pk_bf16_f32 v252, -v176, -v177
    v_cvt_pk_bf16_f32 v253, -v178, -v179
    v_mfma_f32_16x16x32_bf16 v[160:163], v[32:35], v[192:195], 0
    ds_read_b128 v[232:235], v14 offset:0
    v_cvt_pk_bf16_f32 v254, -v180, -v181
    v_mfma_f32_16x16x32_bf16 v[164:167], v[36:39], v[192:195], 0
    v_cvt_pk_bf16_f32 v255, -v182, -v183
    v_pk_max_u16 v252, v252, s62
    v_mfma_f32_16x16x32_bf16 v[152:155], v[40:43], v[196:199], v[152:155]
    v_pk_max_u16 v253, v253, s62
    v_pk_max_u16 v254, v254, s62
    v_mfma_f32_16x16x32_bf16 v[156:159], v[44:47], v[196:199], v[156:159]
    v_pk_max_u16 v255, v255, s62
    v_mfma_f32_16x16x32_bf16 v[160:163], v[48:51], v[196:199], v[160:163]
    ds_read_b128 v[236:239], v14 offset:1024
    v_mfma_f32_16x16x32_bf16 v[164:167], v[52:55], v[196:199], v[164:167]
    buffer_store_dwordx4 v[252:255], v1, s[8:11], s33 offen offset:3072 sc1
    v_mfma_f32_16x16x32_bf16 v[168:171], v[24:27], v[184:187], v[168:171]
    ds_read_b128 v[240:243], v14 offset:2048
    v_mfma_f32_16x16x32_bf16 v[172:175], v[28:31], v[184:187], v[172:175]
    v_mfma_f32_16x16x32_bf16 v[176:179], v[32:35], v[184:187], 0
    v_mfma_f32_16x16x32_bf16 v[180:183], v[36:39], v[184:187], 0
    ds_read_b128 v[244:247], v14 offset:3072
    v_mfma_f32_16x16x32_bf16 v[168:171], v[40:43], v[188:191], v[168:171]
    s_barrier
    v_mfma_f32_16x16x32_bf16 v[172:175], v[44:47], v[188:191], v[172:175]
    v_mfma_f32_16x16x32_bf16 v[176:179], v[48:51], v[188:191], v[176:179]
    v_mfma_f32_16x16x32_bf16 v[180:183], v[52:55], v[188:191], v[180:183]
    s_waitcnt vmcnt(9)
    v_and_b32 v21, v216, v217
    v_mfma_f32_16x16x32_bf16 v[184:187], v[24:27], v[248:251], 0
    v_bitop3_b32 v21, v21, v218, v219 bitop3:0x80
    v_mfma_f32_16x16x32_bf16 v[188:191], v[28:31], v[248:251], 0
    s_waitcnt vmcnt(5)
    v_bitop3_b32 v21, v21, v200, v201 bitop3:0x80
    v_mfma_f32_16x16x32_bf16 v[192:195], v[32:35], v[248:251], 0
    v_bitop3_b32 v21, v21, v202, v203 bitop3:0x80
    v_mfma_f32_16x16x32_bf16 v[196:199], v[36:39], v[248:251], 0
    v_cmp_le_i32 vcc, 0, v21
    v_mfma_f32_16x16x32_bf16 v[184:187], v[40:43], v[252:255], v[184:187]
    v_mfma_f32_16x16x32_bf16 v[188:191], v[44:47], v[252:255], v[188:191]
    s_cbranch_vccnz L_slow_95
L_back_96:
    v_mfma_f32_16x16x32_bf16 v[192:195], v[48:51], v[252:255], v[192:195]
    v_mfma_f32_16x16x32_bf16 v[196:199], v[52:55], v[252:255], v[196:199]
    s_waitcnt lgkmcnt(3)
    s_add_u32 s63, s34, s51
    buffer_load_dwordx4 v[24:27], v1, s[8:11], s63 offen offset:0 sc1
    v_mfma_f32_16x16x32_bf16 v[136:139], v[232:235], v[216:219], v[136:139]
    s_waitcnt lgkmcnt(2)
    v_and_b32 v21, v220, v221
    v_bitop3_b32 v21, v21, v222, v223 bitop3:0x80
    v_mfma_f32_16x16x32_bf16 v[140:143], v[236:239], v[216:219], v[140:143]
    s_waitcnt vmcnt(5) lgkmcnt(1)
    buffer_load_dwordx4 v[28:31], v1, s[8:11], s63 offen offset:1024 sc1
    v_bitop3_b32 v21, v21, v204, v205 bitop3:0x80
    v_mfma_f32_16x16x32_bf16 v[144:147], v[240:243], v[216:219], v[144:147]
    s_waitcnt lgkmcnt(0)
    v_bitop3_b32 v21, v21, v206, v207 bitop3:0x80
    v_mfma_f32_16x16x32_bf16 v[148:151], v[244:247], v[216:219], v[148:151]
    v_cmp_le_i32 vcc, 0, v21
    v_mfma_f32_16x16x32_bf16 v[152:155], v[232:235], v[200:203], v[152:155]
    ds_read_b128 v[232:235], v14 offset:4096
    buffer_load_dwordx4 v[32:35], v1, s[8:11], s63 offen offset:2048 sc1
    v_mfma_f32_16x16x32_bf16 v[156:159], v[236:239], v[200:203], v[156:159]
    ds_read_b128 v[236:239], v14 offset:5120
    v_mfma_f32_16x16x32_bf16 v[160:163], v[240:243], v[200:203], v[160:163]
    ds_read_b128 v[240:243], v14 offset:6144
    v_mfma_f32_16x16x32_bf16 v[164:167], v[244:247], v[200:203], v[164:167]
    s_cbranch_vccnz L_slow_98
L_back_99:
    ds_read_b128 v[244:247], v14 offset:7168
    v_mfma_f32_16x16x32_bf16 v[136:139], v[56:59], v[220:223], v[136:139]
    buffer_load_dwordx4 v[36:39], v1, s[8:11], s63 offen offset:3072 sc1
    v_and_b32 v21, v224, v225
    v_mfma_f32_16x16x32_bf16 v[140:143], v[60:63], v[220:223], v[140:143]
    s_waitcnt vmcnt(7)
    v_bitop3_b32 v21, v21, v226, v227 bitop3:0x80
    v_bitop3_b32 v21, v21, v208, v209 bitop3:0x80
    v_mfma_f32_16x16x32_bf16 v[144:147], v[64:67], v[220:223], v[144:147]
    s_add_u32 s63, s34, s52
    buffer_load_dwordx4 v[40:43], v1, s[8:11], s63 offen offset:0 sc1
    v_mfma_f32_16x16x32_bf16 v[148:151], v[68:71], v[220:223], v[148:151]
    v_bitop3_b32 v21, v21, v210, v211 bitop3:0x80
    v_cmp_le_i32 vcc, 0, v21
    v_mfma_f32_16x16x32_bf16 v[152:155], v[56:59], v[204:207], v[152:155]
    v_mfma_f32_16x16x32_bf16 v[156:159], v[60:63], v[204:207], v[156:159]
    buffer_load_dwordx4 v[44:47], v1, s[8:11], s63 offen offset:1024 sc1
    v_mfma_f32_16x16x32_bf16 v[160:163], v[64:67], v[204:207], v[160:163]
    s_cbranch_vccnz L_slow_101
L_back_102:
    v_mfma_f32_16x16x32_bf16 v[164:167], v[68:71], v[204:207], v[164:167]
    s_waitcnt lgkmcnt(3)
    v_and_b32 v21, v228, v229
    v_mfma_f32_16x16x32_bf16 v[136:139], v[232:235], v[224:227], v[136:139]
    s_waitcnt lgkmcnt(2)
    buffer_load_dwordx4 v[48:51], v1, s[8:11], s63 offen offset:2048 sc1
    v_bitop3_b32 v21, v21, v230, v231 bitop3:0x80
    v_mfma_f32_16x16x32_bf16 v[140:143], v[236:239], v[224:227], v[140:143]
    s_waitcnt vmcnt(9) lgkmcnt(1)
    v_bitop3_b32 v21, v21, v212, v213 bitop3:0x80
    v_mfma_f32_16x16x32_bf16 v[144:147], v[240:243], v[224:227], v[144:147]
    s_waitcnt lgkmcnt(0)
    v_bitop3_b32 v21, v21, v214, v215 bitop3:0x80
    v_mfma_f32_16x16x32_bf16 v[148:151], v[244:247], v[224:227], v[148:151]
    buffer_load_dwordx4 v[52:55], v1, s[8:11], s63 offen offset:3072 sc1
    v_cmp_le_i32 vcc, 0, v21
    v_mfma_f32_16x16x32_bf16 v[152:155], v[232:235], v[208:211], v[152:155]
    ds_read_b128 v[232:235], v14 offset:8192
    v_mfma_f32_16x16x32_bf16 v[156:159], v[236:239], v[208:211], v[156:159]
    ds_read_b128 v[236:239], v14 offset:9216
    v_mfma_f32_16x16x32_bf16 v[160:163], v[240:243], v[208:211], v[160:163]
    ds_read_b128 v[240:243], v14 offset:10240
    v_mfma_f32_16x16x32_bf16 v[164:167], v[244:247], v[208:211], v[164:167]
    s_cbranch_vccnz L_slow_104
L_back_105:
    ds_read_b128 v[244:247], v14 offset:11264
    v_mfma_f32_16x16x32_bf16 v[136:139], v[72:75], v[228:231], v[136:139]
    s_add_u32 s63, s34, s53
    buffer_load_dwordx4 v[248:251], v1, s[8:11], s63 offen offset:0 sc1
    v_mfma_f32_16x16x32_bf16 v[140:143], v[76:79], v[228:231], v[140:143]
    s_waitcnt vmcnt(8)
    v_and_b32 v21, v24, v25
    v_bitop3_b32 v21, v21, v26, v27 bitop3:0x80
    v_mfma_f32_16x16x32_bf16 v[144:147], v[80:83], v[228:231], v[144:147]
    s_waitcnt vmcnt(7)
    buffer_load_dwordx4 v[252:255], v1, s[8:11], s63 offen offset:1024 sc1
    v_bitop3_b32 v21, v21, v28, v29 bitop3:0x80
    v_mfma_f32_16x16x32_bf16 v[148:151], v[84:87], v[228:231], v[148:151]
    v_bitop3_b32 v21, v21, v30, v31 bitop3:0x80
    v_cmp_le_i32 vcc, 0, v21
    v_mfma_f32_16x16x32_bf16 v[152:155], v[72:75], v[212:215], v[152:155]
    v_mfma_f32_16x16x32_bf16 v[156:159], v[76:79], v[212:215], v[156:159]
    buffer_load_dwordx4 v[216:219], v1, s[8:11], s63 offen offset:2048 sc1
    v_mfma_f32_16x16x32_bf16 v[160:163], v[80:83], v[212:215], v[160:163]
    s_cbranch_vccnz L_slow_107
L_back_108:
    v_mfma_f32_16x16x32_bf16 v[164:167], v[84:87], v[212:215], v[164:167]
    s_waitcnt vmcnt(8) lgkmcnt(3)
    v_and_b32 v21, v32, v33
    v_mfma_f32_16x16x32_bf16 v[136:139], v[232:235], v[24:27], v[136:139]
    s_waitcnt lgkmcnt(2)
    buffer_load_dwordx4 v[200:203], v1, s[8:11], s63 offen offset:3072 sc1
    v_bitop3_b32 v21, v21, v34, v35 bitop3:0x80
    v_mfma_f32_16x16x32_bf16 v[140:143], v[236:239], v[24:27], v[140:143]
    s_waitcnt vmcnt(8) lgkmcnt(1)
    v_bitop3_b32 v21, v21, v36, v37 bitop3:0x80
    v_mfma_f32_16x16x32_bf16 v[144:147], v[240:243], v[24:27], v[144:147]
    s_waitcnt lgkmcnt(0)
    v_bitop3_b32 v21, v21, v38, v39 bitop3:0x80
    v_mfma_f32_16x16x32_bf16 v[148:151], v[244:247], v[24:27], v[148:151]
    s_add_u32 s63, s34, s54
    buffer_load_dwordx4 v[220:223], v1, s[8:11], s63 offen offset:0 sc1
    v_mfma_f32_16x16x32_bf16 v[152:155], v[232:235], v[28:31], v[152:155]
    v_cmp_le_i32 vcc, 0, v21
    v_mfma_f32_16x16x32_bf16 v[156:159], v[236:239], v[28:31], v[156:159]
    ds_read_b128 v[232:235], v14 offset:12288
    v_mfma_f32_16x16x32_bf16 v[160:163], v[240:243], v[28:31], v[160:163]
    ds_read_b128 v[236:239], v14 offset:13312
    buffer_load_dwordx4 v[204:207], v1, s[8:11], s63 offen offset:1024 sc1
    v_mfma_f32_16x16x32_bf16 v[164:167], v[244:247], v[28:31], v[164:167]
    s_cbranch_vccnz L_slow_110
L_back_111:
    ds_read_b128 v[240:243], v14 offset:14336
    v_mfma_f32_16x16x32_bf16 v[136:139], v[88:91], v[32:35], v[136:139]
    s_waitcnt vmcnt(9)
    ds_read_b128 v[244:247], v14 offset:15360
    v_and_b32 v21, v40, v41
    v_mfma_f32_16x16x32_bf16 v[140:143], v[92:95], v[32:35], v[140:143]
    buffer_load_dwordx4 v[224:227], v1, s[8:11], s63 offen offset:2048 sc1
    v_bitop3_b32 v21, v21, v42, v43 bitop3:0x80
    v_mfma_f32_16x16x32_bf16 v[144:147], v[96:99], v[32:35], v[144:147]
    s_waitcnt vmcnt(9)
    v_bitop3_b32 v21, v21, v44, v45 bitop3:0x80
    v_bitop3_b32 v21, v21, v46, v47 bitop3:0x80
    v_mfma_f32_16x16x32_bf16 v[148:151], v[100:103], v[32:35], v[148:151]
    v_cmp_le_i32 vcc, 0, v21
    v_mfma_f32_16x16x32_bf16 v[152:155], v[88:91], v[36:39], v[152:155]
    buffer_load_dwordx4 v[208:211], v1, s[8:11], s63 offen offset:3072 sc1
    v_mfma_f32_16x16x32_bf16 v[156:159], v[92:95], v[36:39], v[156:159]
    s_cbranch_vccnz L_slow_113
L_back_114:
    v_mfma_f32_16x16x32_bf16 v[160:163], v[96:99], v[36:39], v[160:163]
    v_mfma_f32_16x16x32_bf16 v[164:167], v[100:103], v[36:39], v[164:167]
    s_waitcnt vmcnt(9) lgkmcnt(3)
    v_and_b32 v21, v48, v49
    v_mfma_f32_16x16x32_bf16 v[136:139], v[232:235], v[40:43], v[136:139]
    s_waitcnt lgkmcnt(2)
    v_bitop3_b32 v21, v21, v50, v51 bitop3:0x80
    v_mfma_f32_16x16x32_bf16 v[140:143], v[236:239], v[40:43], v[140:143]
    s_waitcnt vmcnt(8) lgkmcnt(1)
    v_bitop3_b32 v21, v21, v52, v53 bitop3:0x80
    v_mfma_f32_16x16x32_bf16 v[144:147], v[240:243], v[40:43], v[144:147]
    s_waitcnt lgkmcnt(0)
    v_bitop3_b32 v21, v21, v54, v55 bitop3:0x80
    v_mfma_f32_16x16x32_bf16 v[148:151], v[244:247], v[40:43], v[148:151]
    s_add_u32 s63, s35, s49
    buffer_load_dwordx4 v[228:231], v1, s[8:11], s63 offen offset:0 sc1
    v_mfma_f32_16x16x32_bf16 v[152:155], v[232:235], v[44:47], v[152:155]
    v_cmp_le_i32 vcc, 0, v21
    v_mfma_f32_16x16x32_bf16 v[156:159], v[236:239], v[44:47], v[156:159]
    ds_read_b128 v[232:235], v14 offset:16384
    buffer_load_dwordx4 v[212:215], v1, s[8:11], s63 offen offset:1024 sc1
    v_mfma_f32_16x16x32_bf16 v[160:163], v[240:243], v[44:47], v[160:163]
    ds_read_b128 v[236:239], v14 offset:17408
    v_mfma_f32_16x16x32_bf16 v[164:167], v[244:247], v[44:47], v[164:167]
    s_cbranch_vccnz L_slow_116
L_back_117:
    ds_read_b128 v[240:243], v14 offset:18432
    v_mfma_f32_16x16x32_bf16 v[136:139], v[104:107], v[48:51], v[136:139]
    ds_read_b128 v[244:247], v14 offset:19456
    buffer_load_dwordx4 v[24:27], v1, s[8:11], s63 offen offset:2048 sc1
    v_mfma_f32_16x16x32_bf16 v[140:143], v[108:111], v[48:51], v[140:143]
    s_waitcnt vmcnt(10)
    v_and_b32 v21, v248, v249
    v_bitop3_b32 v21, v21, v250, v251 bitop3:0x80
    v_mfma_f32_16x16x32_bf16 v[144:147], v[112:115], v[48:51], v[144:147]
    s_waitcnt vmcnt(9)
    v_bitop3_b32 v21, v21, v252, v253 bitop3:0x80
    v_bitop3_b32 v21, v21, v254, v255 bitop3:0x80
    v_mfma_f32_16x16x32_bf16 v[148:151], v[116:119], v[48:51], v[148:151]
    buffer_load_dwordx4 v[28:31], v1, s[8:11], s63 offen offset:3072 sc1
    v_cmp_le_i32 vcc, 0, v21
    v_mfma_f32_16x16x32_bf16 v[152:155], v[104:107], v[52:55], v[152:155]
    v_mfma_f32_16x16x32_bf16 v[156:159], v[108:111], v[52:55], v[156:159]
    s_cbranch_vccnz L_slow_119
L_back_120:
    v_mfma_f32_16x16x32_bf16 v[160:163], v[112:115], v[52:55], v[160:163]
    s_add_u32 s63, s35, s50
    buffer_load_dwordx4 v[32:35], v1, s[8:11], s63 offen offset:0 sc1
    v_mfma_f32_16x16x32_bf16 v[164:167], v[116:119], v[52:55], v[164:167]
    s_waitcnt vmcnt(10) lgkmcnt(3)
    v_and_b32 v21, v216, v217
    v_bitop3_b32 v21, v21, v218, v219 bitop3:0x80
    v_mfma_f32_16x16x32_bf16 v[136:139], v[232:235], v[248:251], v[136:139]
    s_waitcnt vmcnt(9) lgkmcnt(2)
    v_bitop3_b32 v21, v21, v200, v201 bitop3:0x80
    v_bitop3_b32 v21, v21, v202, v203 bitop3:0x80
    v_mfma_f32_16x16x32_bf16 v[140:143], v[236:239], v[248:251], v[140:143]
    s_waitcnt lgkmcnt(1)
    buffer_load_dwordx4 v[36:39], v1, s[8:11], s63 offen offset:1024 sc1
    v_cmp_le_i32 vcc, 0, v21
    v_mfma_f32_16x16x32_bf16 v[144:147], v[240:243], v[248:251], v[144:147]
    s_waitcnt lgkmcnt(0)
    v_mfma_f32_16x16x32_bf16 v[148:151], v[244:247], v[248:251], v[148:151]
    s_cbranch_vccnz L_slow_122
L_back_123:
    v_mfma_f32_16x16x32_bf16 v[152:155], v[232:235], v[252:255], v[152:155]
    ds_read_b128 v[232:235], v14 offset:20480
    buffer_load_dwordx4 v[40:43], v1, s[8:11], s63 offen offset:2048 sc1
    v_mfma_f32_16x16x32_bf16 v[156:159], v[236:239], v[252:255], v[156:159]
    s_waitcnt vmcnt(10)
    ds_read_b128 v[236:239], v14 offset:21504
    v_and_b32 v21, v220, v221
    v_mfma_f32_16x16x32_bf16 v[160:163], v[240:243], v[252:255], v[160:163]
    ds_read_b128 v[240:243], v14 offset:22528
    v_bitop3_b32 v21, v21, v222, v223 bitop3:0x80
    v_mfma_f32_16x16x32_bf16 v[164:167], v[244:247], v[252:255], v[164:167]
    ds_read_b128 v[244:247], v14 offset:23552
    buffer_load_dwordx4 v[44:47], v1, s[8:11], s63 offen offset:3072 sc1
    v_mfma_f32_16x16x32_bf16 v[152:155], v[120:123], v[200:203], v[152:155]
    s_waitcnt vmcnt(10)
    v_bitop3_b32 v21, v21, v204, v205 bitop3:0x80
    v_bitop3_b32 v21, v21, v206, v207 bitop3:0x80
    s_waitcnt vmcnt(9)
    v_bitop3_b32 v21, v21, v224, v225 bitop3:0x80
    v_bitop3_b32 v21, v21, v226, v227 bitop3:0x80
    s_waitcnt vmcnt(8)
    v_bitop3_b32 v21, v21, v208, v209 bitop3:0x80
    v_bitop3_b32 v21, v21, v210, v211 bitop3:0x80
    v_cmp_le_i32 vcc, 0, v21
    v_mfma_f32_16x16x32_bf16 v[156:159], v[124:127], v[200:203], v[156:159]
    s_add_u32 s63, s35, s51
    buffer_load_dwordx4 v[48:51], v1, s[8:11], s63 offen offset:0 sc1
    v_mfma_f32_16x16x32_bf16 v[160:163], v[128:131], v[200:203], v[160:163]
    s_cbranch_vccnz L_slow_125
L_back_126:
    v_mfma_f32_16x16x32_bf16 v[164:167], v[132:135], v[200:203], v[164:167]
    v_mfma_f32_16x16x32_bf16 v[152:155], a[240:243], v[208:211], v[152:155]
    buffer_load_dwordx4 v[52:55], v1, s[8:11], s63 offen offset:1024 sc1
    v_mfma_f32_16x16x32_bf16 v[156:159], a[244:247], v[208:211], v[156:159]
    v_mfma_f32_16x16x32_bf16 v[160:163], a[248:251], v[208:211], v[160:163]
    v_mfma_f32_16x16x32_bf16 v[164:167], a[252:255], v[208:211], v[164:167]
    s_waitcnt lgkmcnt(3)
    buffer_load_dwordx4 v[248:251], v1, s[8:11], s63 offen offset:2048 sc1
    v_mfma_f32_16x16x32_bf16 v[152:155], v[232:235], v[204:207], v[152:155]
    s_waitcnt lgkmcnt(2)
    v_mfma_f32_16x16x32_bf16 v[156:159], v[236:239], v[204:207], v[156:159]
    s_waitcnt lgkmcnt(1)
    v_mfma_f32_16x16x32_bf16 v[160:163], v[240:243], v[204:207], v[160:163]
    s_waitcnt lgkmcnt(0)
    buffer_load_dwordx4 v[252:255], v1, s[8:11], s63 offen offset:3072 sc1
    v_mfma_f32_16x16x32_bf16 v[164:167], v[244:247], v[204:207], v[164:167]
    v_mfma_f32_16x16x32_bf16 v[144:147], v[240:243], v[220:223], v[144:147]
    ds_read_b128 v[240:243], v14 offset:2048
    v_mfma_f32_16x16x32_bf16 v[148:151], v[244:247], v[220:223], v[148:151]
    ds_read_b128 v[244:247], v14 offset:3072
    v_mfma_f32_16x16x32_bf16 v[144:147], v[128:131], v[216:219], v[144:147]
    ds_write_b128 v16, v[152:155] offset:8192
    v_mfma_f32_16x16x32_bf16 v[148:151], v[132:135], v[216:219], v[148:151]
    ds_write_b128 v16, v[156:159] offset:9216
    v_mfma_f32_16x16x32_bf16 v[144:147], a[248:251], v[224:227], v[144:147]
    s_waitcnt vmcnt(11)
    v_and_b32 v21, v228, v229
    v_bitop3_b32 v21, v21, v230, v231 bitop3:0x80
    v_mfma_f32_16x16x32_bf16 v[148:151], a[252:255], v[224:227], v[148:151]
    s_waitcnt vmcnt(10)
    v_bitop3_b32 v21, v21, v212, v213 bitop3:0x80
    v_mfma_f32_16x16x32_bf16 v[136:139], v[232:235], v[220:223], v[136:139]
    ds_read_b128 v[232:235], v14 offset:0
    v_bitop3_b32 v21, v21, v214, v215 bitop3:0x80
    v_mfma_f32_16x16x32_bf16 v[140:143], v[236:239], v[220:223], v[140:143]
    ds_read_b128 v[236:239], v14 offset:1024
    v_cmp_le_i32 vcc, 0, v21
    v_mfma_f32_16x16x32_bf16 v[136:139], v[120:123], v[216:219], v[136:139]
    ds_write_b128 v17, v[160:163] offset:16384
    v_mfma_f32_16x16x32_bf16 v[140:143], v[124:127], v[216:219], v[140:143]
    s_add_u32 s63, s35, s52
    buffer_load_dwordx4 v[216:219], v1, s[8:11], s63 offen offset:0 sc1
    v_mfma_f32_16x16x32_bf16 v[136:139], a[240:243], v[224:227], v[136:139]
    ds_write_b128 v17, v[164:167] offset:17408
    v_mfma_f32_16x16x32_bf16 v[140:143], a[244:247], v[224:227], v[140:143]
    s_waitcnt lgkmcnt(3)
    s_cbranch_vccnz L_slow_128
L_back_129:
    buffer_load_dwordx4 v[200:203], v1, s[8:11], s63 offen offset:1024 sc1
    v_mfma_f32_16x16x32_bf16 v[168:171], v[232:235], v[228:231], v[168:171]
    s_waitcnt vmcnt(11) lgkmcnt(2)
    v_and_b32 v21, v24, v25
    v_bitop3_b32 v21, v21, v26, v27 bitop3:0x80
    v_mfma_f32_16x16x32_bf16 v[172:175], v[236:239], v[228:231], v[172:175]
    ds_write_b128 v15, v[144:147] offset:0
    v_mfma_f32_16x16x32_bf16 v[176:179], v[240:243], v[228:231], v[176:179]
    s_waitcnt vmcnt(10)
    buffer_load_dwordx4 v[220:223], v1, s[8:11], s63 offen offset:2048 sc1
    v_bitop3_b32 v21, v21, v28, v29 bitop3:0x80
    v_mfma_f32_16x16x32_bf16 v[180:183], v[244:247], v[228:231], v[180:183]
    ds_write_b128 v15, v[148:151] offset:1024
    v_mfma_f32_16x16x32_bf16 v[184:187], v[232:235], v[212:215], v[184:187]
    v_bitop3_b32 v21, v21, v30, v31 bitop3:0x80
    v_cmp_le_i32 vcc, 0, v21
    v_mfma_f32_16x16x32_bf16 v[188:191], v[236:239], v[212:215], v[188:191]
    ds_read_b128 v[232:235], v14 offset:4096
    buffer_load_dwordx4 v[204:207], v1, s[8:11], s63 offen offset:3072 sc1
    v_mfma_f32_16x16x32_bf16 v[192:195], v[240:243], v[212:215], v[192:195]
    ds_read_b128 v[236:239], v14 offset:5120
    v_mfma_f32_16x16x32_bf16 v[196:199], v[244:247], v[212:215], v[196:199]
    s_cbranch_vccnz L_slow_131
L_back_132:
    ds_read_b128 v[240:243], v14 offset:6144
    v_mfma_f32_16x16x32_bf16 v[168:171], v[56:59], v[24:27], v[168:171]
    s_waitcnt vmcnt(11)
    ds_read_b128 v[244:247], v14 offset:7168
    v_and_b32 v21, v32, v33
    v_mfma_f32_16x16x32_bf16 v[172:175], v[60:63], v[24:27], v[172:175]
    s_add_u32 s63, s35, s53
    buffer_load_dwordx4 v[224:227], v1, s[8:11], s63 offen offset:0 sc1
    v_mfma_f32_16x16x32_bf16 v[176:179], v[64:67], v[24:27], v[176:179]
    s_waitcnt vmcnt(11)
    v_bitop3_b32 v21, v21, v34, v35 bitop3:0x80
    v_bitop3_b32 v21, v21, v36, v37 bitop3:0x80
    v_mfma_f32_16x16x32_bf16 v[180:183], v[68:71], v[24:27], v[180:183]
    buffer_load_dwordx4 v[208:211], v1, s[8:11], s63 offen offset:1024 sc1
    v_bitop3_b32 v21, v21, v38, v39 bitop3:0x80
    v_mfma_f32_16x16x32_bf16 v[184:187], v[56:59], v[28:31], v[184:187]
    v_cmp_le_i32 vcc, 0, v21
    v_mfma_f32_16x16x32_bf16 v[188:191], v[60:63], v[28:31], v[188:191]
    s_waitcnt lgkmcnt(4)
    s_barrier
    ds_read_b128 v[144:147], v6 offset:0
    v_mfma_f32_16x16x32_bf16 v[192:195], v[64:67], v[28:31], v[192:195]
    ds_read_b128 v[148:151], v6 offset:1024
    buffer_load_dwordx4 v[228:231], v1, s[8:11], s63 offen offset:2048 sc1
    v_mfma_f32_16x16x32_bf16 v[196:199], v[68:71], v[28:31], v[196:199]
    s_waitcnt lgkmcnt(5)
    s_cbranch_vccnz L_slow_134
L_back_135:
    ds_read_b128 v[152:155], v6 offset:8192
    v_mfma_f32_16x16x32_bf16 v[168:171], v[232:235], v[32:35], v[168:171]
    s_waitcnt vmcnt(12) lgkmcnt(5)
    ds_read_b128 v[156:159], v6 offset:9216
    v_and_b32 v21, v40, v41
    v_mfma_f32_16x16x32_bf16 v[172:175], v[236:239], v[32:35], v[172:175]
    s_waitcnt lgkmcnt(5)
    ds_read_b128 v[160:163], v6 offset:16384
    buffer_load_dwordx4 v[212:215], v1, s[8:11], s63 offen offset:3072 sc1
    v_mfma_f32_16x16x32_bf16 v[176:179], v[240:243], v[32:35], v[176:179]
    s_waitcnt lgkmcnt(5)
    ds_read_b128 v[164:167], v6 offset:17408
    v_bitop3_b32 v21, v21, v42, v43 bitop3:0x80
    v_mfma_f32_16x16x32_bf16 v[180:183], v[244:247], v[32:35], v[180:183]
    s_waitcnt vmcnt(12)
    v_bitop3_b32 v21, v21, v44, v45 bitop3:0x80
    v_bitop3_b32 v21, v21, v46, v47 bitop3:0x80
    v_mfma_f32_16x16x32_bf16 v[184:187], v[232:235], v[36:39], v[184:187]
    s_waitcnt lgkmcnt(5)
    v_cmp_le_i32 vcc, 0, v21
    v_add_f32 v136, v136, v144
    v_mfma_f32_16x16x32_bf16 v[188:191], v[236:239], v[36:39], v[188:191]
    ds_read_b128 v[232:235], v14 offset:8192
    v_add_f32 v137, v137, v145
    v_mfma_f32_16x16x32_bf16 v[192:195], v[240:243], v[36:39], v[192:195]
    ds_read_b128 v[236:239], v14 offset:9216
    v_add_f32 v138, v138, v146
    v_mfma_f32_16x16x32_bf16 v[196:199], v[244:247], v[36:39], v[196:199]
    s_cbranch_vccnz L_slow_137
L_back_138:
    ds_read_b128 v[240:243], v14 offset:10240
    v_mfma_f32_16x16x32_bf16 v[168:171], v[72:75], v[40:43], v[168:171]
    s_waitcnt vmcnt(11)
    ds_read_b128 v[244:247], v14 offset:11264
    v_and_b32 v21, v48, v49
    v_mfma_f32_16x16x32_bf16 v[172:175], v[76:79], v[40:43], v[172:175]
    s_add_u32 s63, s35, s54
    buffer_load_dwordx4 v[24:27], v1, s[8:11], s63 offen offset:0 sc1
    v_mfma_f32_16x16x32_bf16 v[176:179], v[80:83], v[40:43], v[176:179]
    s_waitcnt vmcnt(11)
    v_bitop3_b32 v21, v21, v50, v51 bitop3:0x80
    v_bitop3_b32 v21, v21, v52, v53 bitop3:0x80
    v_mfma_f32_16x16x32_bf16 v[180:183], v[84:87], v[40:43], v[180:183]
    buffer_load_dwordx4 v[28:31], v1, s[8:11], s63 offen offset:1024 sc1
    v_bitop3_b32 v21, v21, v54, v55 bitop3:0x80
    v_mfma_f32_16x16x32_bf16 v[184:187], v[72:75], v[44:47], v[184:187]
    v_cmp_le_i32 vcc, 0, v21
    v_add_f32 v139, v139, v147
    v_mfma_f32_16x16x32_bf16 v[188:191], v[76:79], v[44:47], v[188:191]
    s_waitcnt lgkmcnt(8)
    v_add_f32 v140, v140, v148
    v_add_f32 v141, v141, v149
    v_mfma_f32_16x16x32_bf16 v[192:195], v[80:83], v[44:47], v[192:195]
    buffer_load_dwordx4 v[32:35], v1, s[8:11], s63 offen offset:2048 sc1
    v_add_f32 v142, v142, v150
    v_mfma_f32_16x16x32_bf16 v[196:199], v[84:87], v[44:47], v[196:199]
    s_waitcnt lgkmcnt(3)
    s_cbranch_vccnz L_slow_140
L_back_141:
    v_add_f32 v143, v143, v151
    v_mfma_f32_16x16x32_bf16 v[168:171], v[232:235], v[48:51], v[168:171]
    s_waitcnt vmcnt(12) lgkmcnt(2)
    v_and_b32 v21, v248, v249
    v_bitop3_b32 v21, v21, v250, v251 bitop3:0x80
    v_mfma_f32_16x16x32_bf16 v[172:175], v[236:239], v[48:51], v[172:175]
    s_waitcnt vmcnt(11) lgkmcnt(1)
    buffer_load_dwordx4 v[36:39], v1, s[8:11], s63 offen offset:3072 sc1
    v_bitop3_b32 v21, v21, v252, v253 bitop3:0x80
    v_mfma_f32_16x16x32_bf16 v[176:179], v[240:243], v[48:51], v[176:179]
    s_waitcnt lgkmcnt(0)
    v_bitop3_b32 v21, v21, v254, v255 bitop3:0x80
    v_add_f32 v136, v136, v152
    v_mfma_f32_16x16x32_bf16 v[180:183], v[244:247], v[48:51], v[180:183]
    v_cmp_le_i32 vcc, 0, v21
    v_add_f32 v137, v137, v153
    v_mfma_f32_16x16x32_bf16 v[184:187], v[232:235], v[52:55], v[184:187]
    ds_read_b128 v[232:235], v14 offset:12288
    v_add_f32 v138, v138, v154
    v_mfma_f32_16x16x32_bf16 v[188:191], v[236:239], v[52:55], v[188:191]
    ds_read_b128 v[236:239], v14 offset:13312
    v_add_f32 v139, v139, v155
    v_mfma_f32_16x16x32_bf16 v[192:195], v[240:243], v[52:55], v[192:195]
    ds_read_b128 v[240:243], v14 offset:14336
    v_add_f32 v140, v140, v156
    v_mfma_f32_16x16x32_bf16 v[196:199], v[244:247], v[52:55], v[196:199]
    s_cbranch_vccnz L_slow_143
L_back_144:
    ds_read_b128 v[244:247], v14 offset:15360
    v_mfma_f32_16x16x32_bf16 v[168:171], v[88:91], v[248:251], v[168:171]
    s_waitcnt vmcnt(11)
    v_add_f32 v141, v141, v157
    v_and_b32 v21, v216, v217
    v_mfma_f32_16x16x32_bf16 v[172:175], v[92:95], v[248:251], v[172:175]
    s_waitcnt vmcnt(10)
    v_bitop3_b32 v21, v21, v218, v219 bitop3:0x80
    v_bitop3_b32 v21, v21, v200, v201 bitop3:0x80
    v_mfma_f32_16x16x32_bf16 v[176:179], v[96:99], v[248:251], v[176:179]
    v_bitop3_b32 v21, v21, v202, v203 bitop3:0x80
    v_add_f32 v142, v142, v158
    v_mfma_f32_16x16x32_bf16 v[180:183], v[100:103], v[248:251], v[180:183]
    v_cmp_le_i32 vcc, 0, v21
    v_add_f32 v143, v143, v159
    v_mfma_f32_16x16x32_bf16 v[184:187], v[88:91], v[252:255], v[184:187]
    v_add_f32 v136, v136, v160
    v_add_f32 v137, v137, v161
    v_mfma_f32_16x16x32_bf16 v[188:191], v[92:95], v[252:255], v[188:191]
    s_cbranch_vccnz L_slow_146
L_back_147:
    v_add_f32 v138, v138, v162
    v_mfma_f32_16x16x32_bf16 v[192:195], v[96:99], v[252:255], v[192:195]
    v_add_f32 v139, v139, v163
    v_add_f32 v140, v140, v164
    v_mfma_f32_16x16x32_bf16 v[196:199], v[100:103], v[252:255], v[196:199]
    s_waitcnt vmcnt(9) lgkmcnt(3)
    v_and_b32 v21, v220, v221
    v_add_f32 v141, v141, v165
    v_mfma_f32_16x16x32_bf16 v[168:171], v[232:235], v[216:219], v[168:171]
    s_waitcnt lgkmcnt(2)
    v_bitop3_b32 v21, v21, v222, v223 bitop3:0x80
    v_add_f32 v142, v142, v166
    v_mfma_f32_16x16x32_bf16 v[172:175], v[236:239], v[216:219], v[172:175]
    s_waitcnt vmcnt(8) lgkmcnt(1)
    v_bitop3_b32 v21, v21, v204, v205 bitop3:0x80
    v_add_f32 v143, v143, v167
    v_mfma_f32_16x16x32_bf16 v[176:179], v[240:243], v[216:219], v[176:179]
    s_waitcnt lgkmcnt(0)
    v_bitop3_b32 v21, v21, v206, v207 bitop3:0x80
    v_mul_f32 v136, v136, v18
    v_mfma_f32_16x16x32_bf16 v[180:183], v[244:247], v[216:219], v[180:183]
    v_cmp_le_i32 vcc, 0, v21
    v_mul_f32 v137, v137, v18
    v_mfma_f32_16x16x32_bf16 v[184:187], v[232:235], v[200:203], v[184:187]
    ds_read_b128 v[232:235], v14 offset:16384
    v_mul_f32 v138, v138, v18
    v_mfma_f32_16x16x32_bf16 v[188:191], v[236:239], v[200:203], v[188:191]
    ds_read_b128 v[236:239], v14 offset:17408
    v_mul_f32 v139, v139, v18
    v_mfma_f32_16x16x32_bf16 v[192:195], v[240:243], v[200:203], v[192:195]
    ds_read_b128 v[240:243], v14 offset:18432
    v_mul_f32 v140, v140, v18
    v_mfma_f32_16x16x32_bf16 v[196:199], v[244:247], v[200:203], v[196:199]
    s_cbranch_vccnz L_slow_149
L_back_150:
    ds_read_b128 v[244:247], v14 offset:19456
    v_mfma_f32_16x16x32_bf16 v[168:171], v[104:107], v[220:223], v[168:171]
    s_waitcnt vmcnt(7)
    v_and_b32 v21, v224, v225
    v_bitop3_b32 v21, v21, v226, v227 bitop3:0x80
    v_mfma_f32_16x16x32_bf16 v[172:175], v[108:111], v[220:223], v[172:175]
    s_waitcnt vmcnt(6)
    v_bitop3_b32 v21, v21, v208, v209 bitop3:0x80
    v_mul_f32 v141, v141, v18
    v_mfma_f32_16x16x32_bf16 v[176:179], v[112:115], v[220:223], v[176:179]
    v_bitop3_b32 v21, v21, v210, v211 bitop3:0x80
    v_mul_f32 v142, v142, v18
    v_mfma_f32_16x16x32_bf16 v[180:183], v[116:119], v[220:223], v[180:183]
    v_cmp_le_i32 vcc, 0, v21
    v_mul_f32 v143, v143, v18
    v_mfma_f32_16x16x32_bf16 v[184:187], v[104:107], v[204:207], v[184:187]
    v_cvt_pk_bf16_f32 v144, v136, v137
    v_cvt_pk_bf16_f32 v146, v140, v141
    v_mfma_f32_16x16x32_bf16 v[188:191], v[108:111], v[204:207], v[188:191]
    s_waitcnt vmcnt(5)
    s_cbranch_vccnz L_slow_152
L_back_153:
    v_and_b32 v21, v228, v229
    v_mfma_f32_16x16x32_bf16 v[192:195], v[112:115], v[204:207], v[192:195]
    v_bitop3_b32 v21, v21, v230, v231 bitop3:0x80
    v_cvt_pk_bf16_f32 v145, v138, v139
    v_mfma_f32_16x16x32_bf16 v[196:199], v[116:119], v[204:207], v[196:199]
    s_waitcnt vmcnt(4) lgkmcnt(3)
    v_bitop3_b32 v21, v21, v212, v213 bitop3:0x80
    v_cvt_pk_bf16_f32 v147, v142, v143
    v_mfma_f32_16x16x32_bf16 v[168:171], v[232:235], v[224:227], v[168:171]
    s_waitcnt lgkmcnt(2)
    v_bitop3_b32 v21, v21, v214, v215 bitop3:0x80
    v_permlane16_swap_b32 v144, v146
    v_mfma_f32_16x16x32_bf16 v[172:175], v[236:239], v[224:227], v[172:175]
    s_waitcnt lgkmcnt(1)
    v_cmp_le_i32 vcc, 0, v21
    v_permlane16_swap_b32 v145, v147
    v_mfma_f32_16x16x32_bf16 v[176:179], v[240:243], v[224:227], v[176:179]
    s_waitcnt lgkmcnt(0)
    buffer_store_dwordx4 v[144:147], v7, s[12:15], 0 offen sc1
    v_mfma_f32_16x16x32_bf16 v[180:183], v[244:247], v[224:227], v[180:183]
    s_waitcnt vmcnt(4)
    s_cbranch_vccnz L_slow_155
L_back_156:
    v_and_b32 v21, v24, v25
    v_mfma_f32_16x16x32_bf16 v[184:187], v[232:235], v[208:211], v[184:187]
    ds_read_b128 v[232:235], v14 offset:20480
    v_bitop3_b32 v21, v21, v26, v27 bitop3:0x80
    v_mfma_f32_16x16x32_bf16 v[188:191], v[236:239], v[208:211], v[188:191]
    s_waitcnt vmcnt(3)
    ds_read_b128 v[236:239], v14 offset:21504
    v_bitop3_b32 v21, v21, v28, v29 bitop3:0x80
    v_mfma_f32_16x16x32_bf16 v[192:195], v[240:243], v[208:211], v[192:195]
    ds_read_b128 v[240:243], v14 offset:22528
    v_bitop3_b32 v21, v21, v30, v31 bitop3:0x80
    v_mfma_f32_16x16x32_bf16 v[196:199], v[244:247], v[208:211], v[196:199]
    s_waitcnt vmcnt(2)
    ds_read_b128 v[244:247], v14 offset:23552
    v_bitop3_b32 v21, v21, v32, v33 bitop3:0x80
    v_mfma_f32_16x16x32_bf16 v[184:187], v[120:123], v[212:215], v[184:187]
    s_waitcnt vmcnt(1)
    v_bitop3_b32 v21, v21, v34, v35 bitop3:0x80
    v_bitop3_b32 v21, v21, v36, v37 bitop3:0x80
    v_bitop3_b32 v21, v21, v38, v39 bitop3:0x80
    v_cmp_le_i32 vcc, 0, v21
    v_mfma_f32_16x16x32_bf16 v[188:191], v[124:127], v[212:215], v[188:191]
    v_mfma_f32_16x16x32_bf16 v[192:195], v[128:131], v[212:215], v[192:195]
    s_cbranch_vccnz L_slow_158
L_back_159:
    v_mfma_f32_16x16x32_bf16 v[196:199], v[132:135], v[212:215], v[196:199]
    v_mfma_f32_16x16x32_bf16 v[184:187], a[240:243], v[36:39], v[184:187]
    v_mfma_f32_16x16x32_bf16 v[188:191], a[244:247], v[36:39], v[188:191]
    v_mfma_f32_16x16x32_bf16 v[192:195], a[248:251], v[36:39], v[192:195]
    v_mfma_f32_16x16x32_bf16 v[196:199], a[252:255], v[36:39], v[196:199]
    s_waitcnt lgkmcnt(3)
    v_mfma_f32_16x16x32_bf16 v[184:187], v[232:235], v[28:31], v[184:187]
    s_waitcnt lgkmcnt(2)
    v_mfma_f32_16x16x32_bf16 v[188:191], v[236:239], v[28:31], v[188:191]
    s_waitcnt lgkmcnt(1)
    v_mfma_f32_16x16x32_bf16 v[192:195], v[240:243], v[28:31], v[192:195]
    s_waitcnt lgkmcnt(0)
    v_mfma_f32_16x16x32_bf16 v[196:199], v[244:247], v[28:31], v[196:199]
    v_mfma_f32_16x16x32_bf16 v[176:179], v[240:243], v[24:27], v[176:179]
    v_mfma_f32_16x16x32_bf16 v[180:183], v[244:247], v[24:27], v[180:183]
    v_mfma_f32_16x16x32_bf16 v[176:179], v[128:131], v[228:231], v[176:179]
    v_mfma_f32_16x16x32_bf16 v[180:183], v[132:135], v[228:231], v[180:183]
    v_mfma_f32_16x16x32_bf16 v[176:179], a[248:251], v[32:35], v[176:179]
    ds_write_b128 v16, v[184:187] offset:37888
    v_mfma_f32_16x16x32_bf16 v[180:183], a[252:255], v[32:35], v[180:183]
    ds_write_b128 v16, v[188:191] offset:38912
    v_mfma_f32_16x16x32_bf16 v[168:171], v[232:235], v[24:27], v[168:171]
    v_mfma_f32_16x16x32_bf16 v[172:175], v[236:239], v[24:27], v[172:175]
    v_mfma_f32_16x16x32_bf16 v[168:171], v[120:123], v[228:231], v[168:171]
    ds_write_b128 v17, v[192:195] offset:46080
    v_mfma_f32_16x16x32_bf16 v[172:175], v[124:127], v[228:231], v[172:175]
    v_mfma_f32_16x16x32_bf16 v[168:171], a[240:243], v[32:35], v[168:171]
    ds_write_b128 v17, v[196:199] offset:47104
    v_mfma_f32_16x16x32_bf16 v[172:175], a[244:247], v[32:35], v[172:175]
    ds_write_b128 v15, v[176:179] offset:29696
    ds_write_b128 v15, v[180:183] offset:30720
    s_waitcnt lgkmcnt(0)
    s_barrier
    ds_read_b128 v[176:179], v6 offset:29696
    ds_read_b128 v[180:183], v6 offset:30720
    ds_read_b128 v[184:187], v6 offset:37888
    ds_read_b128 v[188:191], v6 offset:38912
    ds_read_b128 v[192:195], v6 offset:46080
    ds_read_b128 v[196:199], v6 offset:47104
    s_waitcnt lgkmcnt(5)
    v_pk_add_f32 v[168:169], v[168:169], v[176:177]
    v_pk_add_f32 v[170:171], v[170:171], v[178:179]
    s_waitcnt lgkmcnt(4)
    v_pk_add_f32 v[172:173], v[172:173], v[180:181]
    v_pk_add_f32 v[174:175], v[174:175], v[182:183]
    s_waitcnt lgkmcnt(3)
    v_pk_add_f32 v[168:169], v[168:169], v[184:185]
    v_pk_add_f32 v[170:171], v[170:171], v[186:187]
    s_waitcnt lgkmcnt(2)
    v_pk_add_f32 v[172:173], v[172:173], v[188:189]
    v_pk_add_f32 v[174:175], v[174:175], v[190:191]
    s_waitcnt lgkmcnt(1)
    v_pk_add_f32 v[168:169], v[168:169], v[192:193]
    v_pk_add_f32 v[170:171], v[170:171], v[194:195]
    s_waitcnt lgkmcnt(0)
    v_pk_add_f32 v[172:173], v[172:173], v[196:197]
    v_pk_add_f32 v[174:175], v[174:175], v[198:199]
    v_pk_mul_f32 v[168:169], v[168:169], v[18:19] op_sel:[0,1] op_sel_hi:[1,1]
    v_pk_mul_f32 v[170:171], v[170:171], v[18:19] op_sel:[0,1] op_sel_hi:[1,1]
    v_pk_mul_f32 v[172:173], v[172:173], v[18:19] op_sel:[0,1] op_sel_hi:[1,1]
    v_pk_mul_f32 v[174:175], v[174:175], v[18:19] op_sel:[0,1] op_sel_hi:[1,1]
    v_cvt_pk_bf16_f32 v176, v168, v169
    v_cvt_pk_bf16_f32 v178, v172, v173
    v_cvt_pk_bf16_f32 v177, v170, v171
    v_cvt_pk_bf16_f32 v179, v174, v175
    v_permlane16_swap_b32 v176, v178
    s_nop 0
    v_permlane16_swap_b32 v177, v179
    buffer_store_dwordx4 v[176:179], v8, s[12:15], 0 offen sc1
L_main_end:
L_end:
    s_endpgm
L_slow_10:
L_sp_13:
    buffer_load_dword v21, off, s[8:11], s37 sc1
    s_waitcnt vmcnt(0)
    v_cmp_ne_u32 vcc, 32, v21
    s_sub_i32 s39, s39, 1
    s_max_i32 s39, s39, 0
    s_cbranch_scc0 L_ok_12
    s_cbranch_vccnz L_sp_13
L_ok_12:
    s_branch L_back_11
L_slow_14:
L_sp_17:
    buffer_load_dword v21, off, s[8:11], s100 offset:0 sc1
    s_waitcnt vmcnt(0)
    v_cmp_ne_u32 vcc, 1, v21
    s_sub_i32 s39, s39, 1
    s_max_i32 s39, s39, 0
    s_cbranch_scc0 L_ok_16
    s_cbranch_vccnz L_sp_17
L_ok_16:
    s_branch L_back_15
L_slow_18:
L_sp_21:
    buffer_load_dword v21, off, s[8:11], s100 offset:512 sc1
    s_waitcnt vmcnt(0)
    v_cmp_ne_u32 vcc, 1, v21
    s_sub_i32 s39, s39, 1
    s_max_i32 s39, s39, 0
    s_cbranch_scc0 L_ok_20
    s_cbranch_vccnz L_sp_21
L_ok_20:
    s_branch L_back_19
L_slowh:
L_slowh2:
    buffer_load_dword v23, off, s[8:11], s3 offset:1024 sc1
    s_waitcnt vmcnt(0)
    v_cmp_ne_u32 s[32:33], 32, v23
    s_sub_i32 s39, s39, 1
    s_max_i32 s39, s39, 0
    s_cbranch_scc0 L_backh
    s_cmp_lg_u64 s[32:33], 0
    s_cbranch_scc1 L_slowh2
    s_branch L_backh
L_slow_22:
    s_add_u32 s37, s34, s49
L_re_24:
    buffer_load_dwordx4 v[216:219], v1, s[8:11], s37 offen offset:0 sc1
    buffer_load_dwordx4 v[200:203], v1, s[8:11], s37 offen offset:1024 sc1
    s_waitcnt vmcnt(0)
    v_or_b32 v21, v216, v217
    v_or3_b32 v21, v21, v218, v219
    v_or3_b32 v21, v21, v200, v201
    v_or3_b32 v21, v21, v202, v203
    v_cmp_gt_i32 vcc, 0, v21
    s_sub_i32 s39, s39, 1
    s_max_i32 s39, s39, 0
    s_cbranch_scc0 L_back_23
    s_cbranch_vccnz L_re_24
    s_branch L_back_23
L_slow_25:
    s_add_u32 s37, s34, s49
L_re_27:
    buffer_load_dwordx4 v[220:223], v1, s[8:11], s37 offen offset:2048 sc1
    buffer_load_dwordx4 v[204:207], v1, s[8:11], s37 offen offset:3072 sc1
    s_waitcnt vmcnt(0)
    v_or_b32 v21, v220, v221
    v_or3_b32 v21, v21, v222, v223
    v_or3_b32 v21, v21, v204, v205
    v_or3_b32 v21, v21, v206, v207
    v_cmp_gt_i32 vcc, 0, v21
    s_sub_i32 s39, s39, 1
    s_max_i32 s39, s39, 0
    s_cbranch_scc0 L_back_26
    s_cbranch_vccnz L_re_27
    s_branch L_back_26
L_slow_28:
    s_add_u32 s37, s34, s50
L_re_30:
    buffer_load_dwordx4 v[224:227], v1, s[8:11], s37 offen offset:0 sc1
    buffer_load_dwordx4 v[208:211], v1, s[8:11], s37 offen offset:1024 sc1
    s_waitcnt vmcnt(0)
    v_or_b32 v21, v224, v225
    v_or3_b32 v21, v21, v226, v227
    v_or3_b32 v21, v21, v208, v209
    v_or3_b32 v21, v21, v210, v211
    v_cmp_gt_i32 vcc, 0, v21
    s_sub_i32 s39, s39, 1
    s_max_i32 s39, s39, 0
    s_cbranch_scc0 L_back_29
    s_cbranch_vccnz L_re_30
    s_branch L_back_29
L_slow_31:
    s_add_u32 s37, s34, s50
L_re_33:
    buffer_load_dwordx4 v[228:231], v1, s[8:11], s37 offen offset:2048 sc1
    buffer_load_dwordx4 v[212:215], v1, s[8:11], s37 offen offset:3072 sc1
    s_waitcnt vmcnt(0)
    v_or_b32 v21, v228, v229
    v_or3_b32 v21, v21, v230, v231
    v_or3_b32 v21, v21, v212, v213
    v_or3_b32 v21, v21, v214, v215
    v_cmp_gt_i32 vcc, 0, v21
    s_sub_i32 s39, s39, 1
    s_max_i32 s39, s39, 0
    s_cbranch_scc0 L_back_32
    s_cbranch_vccnz L_re_33
    s_branch L_back_32
L_slow_34:
    s_add_u32 s37, s34, s51
L_re_36:
    buffer_load_dwordx4 v[24:27], v1, s[8:11], s37 offen offset:0 sc1
    buffer_load_dwordx4 v[28:31], v1, s[8:11], s37 offen offset:1024 sc1
    s_waitcnt vmcnt(0)
    v_or_b32 v21, v24, v25
    v_or3_b32 v21, v21, v26, v27
    v_or3_b32 v21, v21, v28, v29
    v_or3_b32 v21, v21, v30, v31
    v_cmp_gt_i32 vcc, 0, v21
    s_sub_i32 s39, s39, 1
    s_max_i32 s39, s39, 0
    s_cbranch_scc0 L_back_35
    s_cbranch_vccnz L_re_36
    s_branch L_back_35
L_slow_37:
    s_add_u32 s37, s34, s51
L_re_39:
    buffer_load_dwordx4 v[32:35], v1, s[8:11], s37 offen offset:2048 sc1
    buffer_load_dwordx4 v[36:39], v1, s[8:11], s37 offen offset:3072 sc1
    s_waitcnt vmcnt(0)
    v_or_b32 v21, v32, v33
    v_or3_b32 v21, v21, v34, v35
    v_or3_b32 v21, v21, v36, v37
    v_or3_b32 v21, v21, v38, v39
    v_cmp_gt_i32 vcc, 0, v21
    s_sub_i32 s39, s39, 1
    s_max_i32 s39, s39, 0
    s_cbranch_scc0 L_back_38
    s_cbranch_vccnz L_re_39
    s_branch L_back_38
L_slow_40:
    s_add_u32 s37, s34, s52
L_re_42:
    buffer_load_dwordx4 v[40:43], v1, s[8:11], s37 offen offset:0 sc1
    buffer_load_dwordx4 v[44:47], v1, s[8:11], s37 offen offset:1024 sc1
    s_waitcnt vmcnt(0)
    v_or_b32 v21, v40, v41
    v_or3_b32 v21, v21, v42, v43
    v_or3_b32 v21, v21, v44, v45
    v_or3_b32 v21, v21, v46, v47
    v_cmp_gt_i32 vcc, 0, v21
    s_sub_i32 s39, s39, 1
    s_max_i32 s39, s39, 0
    s_cbranch_scc0 L_back_41
    s_cbranch_vccnz L_re_42
    s_branch L_back_41
L_slow_43:
    s_add_u32 s37, s34, s52
L_re_45:
    buffer_load_dwordx4 v[48:51], v1, s[8:11], s37 offen offset:2048 sc1
    buffer_load_dwordx4 v[52:55], v1, s[8:11], s37 offen offset:3072 sc1
    s_waitcnt vmcnt(0)
    v_or_b32 v21, v48, v49
    v_or3_b32 v21, v21, v50, v51
    v_or3_b32 v21, v21, v52, v53
    v_or3_b32 v21, v21, v54, v55
    v_cmp_gt_i32 vcc, 0, v21
    s_sub_i32 s39, s39, 1
    s_max_i32 s39, s39, 0
    s_cbranch_scc0 L_back_44
    s_cbranch_vccnz L_re_45
    s_branch L_back_44
L_slow_46:
    s_add_u32 s37, s34, s53
L_re_48:
    buffer_load_dwordx4 v[248:251], v1, s[8:11], s37 offen offset:0 sc1
    buffer_load_dwordx4 v[252:255], v1, s[8:11], s37 offen offset:1024 sc1
    s_waitcnt vmcnt(0)
    v_or_b32 v21, v248, v249
    v_or3_b32 v21, v21, v250, v251
    v_or3_b32 v21, v21, v252, v253
    v_or3_b32 v21, v21, v254, v255
    v_cmp_gt_i32 vcc, 0, v21
    s_sub_i32 s39, s39, 1
    s_max_i32 s39, s39, 0
    s_cbranch_scc0 L_back_47
    s_cbranch_vccnz L_re_48
    s_branch L_back_47
L_slow_49:
    s_add_u32 s37, s34, s53
L_re_51:
    buffer_load_dwordx4 v[216:219], v1, s[8:11], s37 offen offset:2048 sc1
    buffer_load_dwordx4 v[200:203], v1, s[8:11], s37 offen offset:3072 sc1
    s_waitcnt vmcnt(0)
    v_or_b32 v21, v216, v217
    v_or3_b32 v21, v21, v218, v219
    v_or3_b32 v21, v21, v200, v201
    v_or3_b32 v21, v21, v202, v203
    v_cmp_gt_i32 vcc, 0, v21
    s_sub_i32 s39, s39, 1
    s_max_i32 s39, s39, 0
    s_cbranch_scc0 L_back_50
    s_cbranch_vccnz L_re_51
    s_branch L_back_50
L_slow_52:
    s_add_u32 s37, s34, s54
L_re_54:
    buffer_load_dwordx4 v[220:223], v1, s[8:11], s37 offen offset:0 sc1
    buffer_load_dwordx4 v[204:207], v1, s[8:11], s37 offen offset:1024 sc1
    buffer_load_dwordx4 v[224:227], v1, s[8:11], s37 offen offset:2048 sc1
    buffer_load_dwordx4 v[208:211], v1, s[8:11], s37 offen offset:3072 sc1
    s_waitcnt vmcnt(0)
    v_or_b32 v21, v220, v221
    v_or3_b32 v21, v21, v222, v223
    v_or3_b32 v21, v21, v204, v205
    v_or3_b32 v21, v21, v206, v207
    v_or3_b32 v21, v21, v224, v225
    v_or3_b32 v21, v21, v226, v227
    v_or3_b32 v21, v21, v208, v209
    v_or3_b32 v21, v21, v210, v211
    v_cmp_gt_i32 vcc, 0, v21
    s_sub_i32 s39, s39, 1
    s_max_i32 s39, s39, 0
    s_cbranch_scc0 L_back_53
    s_cbranch_vccnz L_re_54
    s_branch L_back_53
L_slow_55:
    s_add_u32 s37, s35, s49
L_re_57:
    buffer_load_dwordx4 v[228:231], v1, s[8:11], s37 offen offset:0 sc1
    buffer_load_dwordx4 v[212:215], v1, s[8:11], s37 offen offset:1024 sc1
    s_waitcnt vmcnt(0)
    v_or_b32 v21, v228, v229
    v_or3_b32 v21, v21, v230, v231
    v_or3_b32 v21, v21, v212, v213
    v_or3_b32 v21, v21, v214, v215
    v_cmp_gt_i32 vcc, 0, v21
    s_sub_i32 s39, s39, 1
    s_max_i32 s39, s39, 0
    s_cbranch_scc0 L_back_56
    s_cbranch_vccnz L_re_57
    s_branch L_back_56
L_slow_58:
    s_add_u32 s37, s35, s49
L_re_60:
    buffer_load_dwordx4 v[24:27], v1, s[8:11], s37 offen offset:2048 sc1
    buffer_load_dwordx4 v[28:31], v1, s[8:11], s37 offen offset:3072 sc1
    s_waitcnt vmcnt(0)
    v_or_b32 v21, v24, v25
    v_or3_b32 v21, v21, v26, v27
    v_or3_b32 v21, v21, v28, v29
    v_or3_b32 v21, v21, v30, v31
    v_cmp_gt_i32 vcc, 0, v21
    s_sub_i32 s39, s39, 1
    s_max_i32 s39, s39, 0
    s_cbranch_scc0 L_back_59
    s_cbranch_vccnz L_re_60
    s_branch L_back_59
L_slow_61:
    s_add_u32 s37, s35, s50
L_re_63:
    buffer_load_dwordx4 v[32:35], v1, s[8:11], s37 offen offset:0 sc1
    buffer_load_dwordx4 v[36:39], v1, s[8:11], s37 offen offset:1024 sc1
    s_waitcnt vmcnt(0)
    v_or_b32 v21, v32, v33
    v_or3_b32 v21, v21, v34, v35
    v_or3_b32 v21, v21, v36, v37
    v_or3_b32 v21, v21, v38, v39
    v_cmp_gt_i32 vcc, 0, v21
    s_sub_i32 s39, s39, 1
    s_max_i32 s39, s39, 0
    s_cbranch_scc0 L_back_62
    s_cbranch_vccnz L_re_63
    s_branch L_back_62
L_slow_64:
    s_add_u32 s37, s35, s50
L_re_66:
    buffer_load_dwordx4 v[40:43], v1, s[8:11], s37 offen offset:2048 sc1
    buffer_load_dwordx4 v[44:47], v1, s[8:11], s37 offen offset:3072 sc1
    s_waitcnt vmcnt(0)
    v_or_b32 v21, v40, v41
    v_or3_b32 v21, v21, v42, v43
    v_or3_b32 v21, v21, v44, v45
    v_or3_b32 v21, v21, v46, v47
    v_cmp_gt_i32 vcc, 0, v21
    s_sub_i32 s39, s39, 1
    s_max_i32 s39, s39, 0
    s_cbranch_scc0 L_back_65
    s_cbranch_vccnz L_re_66
    s_branch L_back_65
L_slow_67:
    s_add_u32 s37, s35, s51
L_re_69:
    buffer_load_dwordx4 v[48:51], v1, s[8:11], s37 offen offset:0 sc1
    buffer_load_dwordx4 v[52:55], v1, s[8:11], s37 offen offset:1024 sc1
    s_waitcnt vmcnt(0)
    v_or_b32 v21, v48, v49
    v_or3_b32 v21, v21, v50, v51
    v_or3_b32 v21, v21, v52, v53
    v_or3_b32 v21, v21, v54, v55
    v_cmp_gt_i32 vcc, 0, v21
    s_sub_i32 s39, s39, 1
    s_max_i32 s39, s39, 0
    s_cbranch_scc0 L_back_68
    s_cbranch_vccnz L_re_69
    s_branch L_back_68
L_slow_70:
    s_add_u32 s37, s35, s51
L_re_72:
    buffer_load_dwordx4 v[248:251], v1, s[8:11], s37 offen offset:2048 sc1
    buffer_load_dwordx4 v[252:255], v1, s[8:11], s37 offen offset:3072 sc1
    s_waitcnt vmcnt(0)
    v_or_b32 v21, v248, v249
    v_or3_b32 v21, v21, v250, v251
    v_or3_b32 v21, v21, v252, v253
    v_or3_b32 v21, v21, v254, v255
    v_cmp_gt_i32 vcc, 0, v21
    s_sub_i32 s39, s39, 1
    s_max_i32 s39, s39, 0
    s_cbranch_scc0 L_back_71
    s_cbranch_vccnz L_re_72
    s_branch L_back_71
L_slow_73:
    s_add_u32 s37, s35, s52
L_re_75:
    buffer_load_dwordx4 v[216:219], v1, s[8:11], s37 offen offset:0 sc1
    buffer_load_dwordx4 v[200:203], v1, s[8:11], s37 offen offset:1024 sc1
    s_waitcnt vmcnt(0)
    v_or_b32 v21, v216, v217
    v_or3_b32 v21, v21, v218, v219
    v_or3_b32 v21, v21, v200, v201
    v_or3_b32 v21, v21, v202, v203
    v_cmp_gt_i32 vcc, 0, v21
    s_sub_i32 s39, s39, 1
    s_max_i32 s39, s39, 0
    s_cbranch_scc0 L_back_74
    s_cbranch_vccnz L_re_75
    s_branch L_back_74
L_slow_76:
    s_add_u32 s37, s35, s52
L_re_78:
    buffer_load_dwordx4 v[220:223], v1, s[8:11], s37 offen offset:2048 sc1
    buffer_load_dwordx4 v[204:207], v1, s[8:11], s37 offen offset:3072 sc1
    s_waitcnt vmcnt(0)
    v_or_b32 v21, v220, v221
    v_or3_b32 v21, v21, v222, v223
    v_or3_b32 v21, v21, v204, v205
    v_or3_b32 v21, v21, v206, v207
    v_cmp_gt_i32 vcc, 0, v21
    s_sub_i32 s39, s39, 1
    s_max_i32 s39, s39, 0
    s_cbranch_scc0 L_back_77
    s_cbranch_vccnz L_re_78
    s_branch L_back_77
L_slow_79:
    s_add_u32 s37, s35, s53
L_re_81:
    buffer_load_dwordx4 v[224:227], v1, s[8:11], s37 offen offset:0 sc1
    buffer_load_dwordx4 v[208:211], v1, s[8:11], s37 offen offset:1024 sc1
    s_waitcnt vmcnt(0)
    v_or_b32 v21, v224, v225
    v_or3_b32 v21, v21, v226, v227
    v_or3_b32 v21, v21, v208, v209
    v_or3_b32 v21, v21, v210, v211
    v_cmp_gt_i32 vcc, 0, v21
    s_sub_i32 s39, s39, 1
    s_max_i32 s39, s39, 0
    s_cbranch_scc0 L_back_80
    s_cbranch_vccnz L_re_81
    s_branch L_back_80
L_slow_82:
    s_add_u32 s37, s35, s53
L_re_84:
    buffer_load_dwordx4 v[228:231], v1, s[8:11], s37 offen offset:2048 sc1
    buffer_load_dwordx4 v[212:215], v1, s[8:11], s37 offen offset:3072 sc1
    s_waitcnt vmcnt(0)
    v_or_b32 v21, v228, v229
    v_or3_b32 v21, v21, v230, v231
    v_or3_b32 v21, v21, v212, v213
    v_or3_b32 v21, v21, v214, v215
    v_cmp_gt_i32 vcc, 0, v21
    s_sub_i32 s39, s39, 1
    s_max_i32 s39, s39, 0
    s_cbranch_scc0 L_back_83
    s_cbranch_vccnz L_re_84
    s_branch L_back_83
L_slow_85:
    s_add_u32 s37, s35, s54
L_re_87:
    buffer_load_dwordx4 v[24:27], v1, s[8:11], s37 offen offset:0 sc1
    buffer_load_dwordx4 v[28:31], v1, s[8:11], s37 offen offset:1024 sc1
    buffer_load_dwordx4 v[32:35], v1, s[8:11], s37 offen offset:2048 sc1
    buffer_load_dwordx4 v[36:39], v1, s[8:11], s37 offen offset:3072 sc1
    s_waitcnt vmcnt(0)
    v_or_b32 v21, v24, v25
    v_or3_b32 v21, v21, v26, v27
    v_or3_b32 v21, v21, v28, v29
    v_or3_b32 v21, v21, v30, v31
    v_or3_b32 v21, v21, v32, v33
    v_or3_b32 v21, v21, v34, v35
    v_or3_b32 v21, v21, v36, v37
    v_or3_b32 v21, v21, v38, v39
    v_cmp_gt_i32 vcc, 0, v21
    s_sub_i32 s39, s39, 1
    s_max_i32 s39, s39, 0
    s_cbranch_scc0 L_back_86
    s_cbranch_vccnz L_re_87
    s_branch L_back_86
L_slowx0:
    s_sub_i32 s39, s39, 1
    s_max_i32 s39, s39, 0
    s_cbranch_scc0 L_backx0
    s_mov_b32 exec_hi, 0x00ffffff
    s_add_u32 m0, s101, 0
    s_add_u32 s57, s3, 0
    buffer_load_dwordx4 v1, s[8:11], s57 offen sc1 lds
    s_add_u32 m0, s101, 928
    s_add_u32 s57, s3, 57344
    buffer_load_dwordx4 v1, s[8:11], s57 offen sc1 lds
    s_add_u32 m0, s101, 1856
    s_add_u32 s57, s3, 114688
    buffer_load_dwordx4 v1, s[8:11], s57 offen sc1 lds
    s_add_u32 m0, s101, 2784
    s_add_u32 s57, s3, 172032
    buffer_load_dwordx4 v1, s[8:11], s57 offen sc1 lds
    s_add_u32 m0, s101, 14848
    s_add_u32 s57, s3, 917504
    buffer_load_dwordx4 v1, s[8:11], s57 offen sc1 lds
    s_add_u32 m0, s101, 15776
    s_add_u32 s57, s3, 974848
    buffer_load_dwordx4 v1, s[8:11], s57 offen sc1 lds
    s_add_u32 m0, s101, 16704
    s_add_u32 s57, s3, 1032192
    buffer_load_dwordx4 v1, s[8:11], s57 offen sc1 lds
    s_add_u32 m0, s101, 17632
    s_add_u32 s57, s3, 1089536
    buffer_load_dwordx4 v1, s[8:11], s57 offen sc1 lds
    s_mov_b64 exec, -1
    s_waitcnt vmcnt(0)
    ds_read_b128 v[168:171], v133 offset:0
    ds_read_b128 v[172:175], v133 offset:64
    ds_read_b128 v[176:179], v133 offset:128
    ds_read_b128 v[180:183], v133 offset:192
    ds_read_b128 v[184:187], v133 offset:256
    ds_read_b128 v[188:191], v133 offset:320
    ds_read_b128 v[192:195], v196 offset:768
    s_waitcnt lgkmcnt(0)
    v_max_u32 v22, v168, v169
    v_max3_u32 v22, v22, v170, v171
    v_max3_u32 v22, v22, v172, v173
    v_max3_u32 v22, v22, v174, v175
    v_max3_u32 v22, v22, v176, v177
    v_max3_u32 v22, v22, v178, v179
    v_max3_u32 v22, v22, v180, v181
    v_max3_u32 v22, v22, v182, v183
    v_max3_u32 v22, v22, v184, v185
    v_max3_u32 v22, v22, v186, v187
    v_max3_u32 v22, v22, v188, v189
    v_max3_u32 v22, v22, v190, v191
    v_max3_u32 v22, v22, v192, v193
    v_max3_u32 v22, v22, v194, v195
    v_cmp_eq_u32 vcc, -1, v22
    s_cbranch_vccnz L_slowx0
    s_branch L_backx0
L_slowx1:
    s_sub_i32 s39, s39, 1
    s_max_i32 s39, s39, 0
    s_cbranch_scc0 L_backx1
    s_mov_b32 exec_hi, 0x00ffffff
    s_add_u32 m0, s101, 29696
    s_sub_u32 s57, s100, 0
    buffer_load_dwordx4 v1, s[8:11], s57 offen sc1 lds
    s_add_u32 m0, s101, 30624
    s_sub_u32 s57, s100, 57344
    buffer_load_dwordx4 v1, s[8:11], s57 offen sc1 lds
    s_add_u32 m0, s101, 31552
    s_sub_u32 s57, s100, 114688
    buffer_load_dwordx4 v1, s[8:11], s57 offen sc1 lds
    s_add_u32 m0, s101, 32480
    s_sub_u32 s57, s100, 172032
    buffer_load_dwordx4 v1, s[8:11], s57 offen sc1 lds
    s_add_u32 m0, s101, 44544
    s_sub_u32 s57, s100, 917504
    buffer_load_dwordx4 v1, s[8:11], s57 offen sc1 lds
    s_add_u32 m0, s101, 45472
    s_sub_u32 s57, s100, 974848
    buffer_load_dwordx4 v1, s[8:11], s57 offen sc1 lds
    s_add_u32 m0, s101, 46400
    s_sub_u32 s57, s100, 1032192
    buffer_load_dwordx4 v1, s[8:11], s57 offen sc1 lds
    s_add_u32 m0, s101, 47328
    s_sub_u32 s57, s100, 1089536
    buffer_load_dwordx4 v1, s[8:11], s57 offen sc1 lds
    s_mov_b64 exec, -1
    s_waitcnt vmcnt(0)
    ds_read_b128 v[168:171], v133 offset:29696
    ds_read_b128 v[172:175], v133 offset:29760
    ds_read_b128 v[176:179], v133 offset:29824
    ds_read_b128 v[180:183], v133 offset:29888
    ds_read_b128 v[184:187], v133 offset:29952
    ds_read_b128 v[188:191], v133 offset:30016
    ds_read_b128 v[192:195], v196 offset:30464
    s_waitcnt lgkmcnt(0)
    v_max_u32 v22, v168, v169
    v_max3_u32 v22, v22, v170, v171
    v_max3_u32 v22, v22, v172, v173
    v_max3_u32 v22, v22, v174, v175
    v_max3_u32 v22, v22, v176, v177
    v_max3_u32 v22, v22, v178, v179
    v_max3_u32 v22, v22, v180, v181
    v_max3_u32 v22, v22, v182, v183
    v_max3_u32 v22, v22, v184, v185
    v_max3_u32 v22, v22, v186, v187
    v_max3_u32 v22, v22, v188, v189
    v_max3_u32 v22, v22, v190, v191
    v_max3_u32 v22, v22, v192, v193
    v_max3_u32 v22, v22, v194, v195
    v_cmp_eq_u32 vcc, -1, v22
    s_cbranch_vccnz L_slowx1
    s_branch L_backx1
L_slowt:
    s_sub_i32 s97, s97, 1
    s_max_i32 s97, s97, 0
    s_cbranch_scc0 L_backt
    s_waitcnt vmcnt(0) lgkmcnt(0)
    s_barrier
    s_lshl_b32 s34, s26, 8
    s_add_u32 s3, s34, s27
    s_mul_i32 s3, s3, 896
    s_add_u32 s100, s34, s28
    s_sub_u32 s100, 2048, s100
    s_mul_i32 s100, s100, 896
    s_mul_i32 s101, s26, 3712
    s_add_u32 s3, s3, 10182656
    s_add_u32 s100, s100, 10182656
    s_mov_b32 exec_hi, 0x00ffffff
    s_add_u32 m0, s101, 0
    s_add_u32 s57, s3, 0
    buffer_load_dwordx4 v1, s[8:11], s57 offen sc1 lds
    s_add_u32 m0, s101, 928
    s_add_u32 s57, s3, 57344
    buffer_load_dwordx4 v1, s[8:11], s57 offen sc1 lds
    s_add_u32 m0, s101, 1856
    s_add_u32 s57, s3, 114688
    buffer_load_dwordx4 v1, s[8:11], s57 offen sc1 lds
    s_add_u32 m0, s101, 2784
    s_add_u32 s57, s3, 172032
    buffer_load_dwordx4 v1, s[8:11], s57 offen sc1 lds
    s_add_u32 m0, s101, 14848
    s_add_u32 s57, s3, 917504
    buffer_load_dwordx4 v1, s[8:11], s57 offen sc1 lds
    s_add_u32 m0, s101, 15776
    s_add_u32 s57, s3, 974848
    buffer_load_dwordx4 v1, s[8:11], s57 offen sc1 lds
    s_add_u32 m0, s101, 16704
    s_add_u32 s57, s3, 1032192
    buffer_load_dwordx4 v1, s[8:11], s57 offen sc1 lds
    s_add_u32 m0, s101, 17632
    s_add_u32 s57, s3, 1089536
    buffer_load_dwordx4 v1, s[8:11], s57 offen sc1 lds
    s_mov_b64 exec, -1
    s_mov_b32 exec_hi, 0x00ffffff
    s_add_u32 m0, s101, 29696
    s_sub_u32 s57, s100, 0
    buffer_load_dwordx4 v1, s[8:11], s57 offen sc1 lds
    s_add_u32 m0, s101, 30624
    s_sub_u32 s57, s100, 57344
    buffer_load_dwordx4 v1, s[8:11], s57 offen sc1 lds
    s_add_u32 m0, s101, 31552
    s_sub_u32 s57, s100, 114688
    buffer_load_dwordx4 v1, s[8:11], s57 offen sc1 lds
    s_add_u32 m0, s101, 32480
    s_sub_u32 s57, s100, 172032
    buffer_load_dwordx4 v1, s[8:11], s57 offen sc1 lds
    s_add_u32 m0, s101, 44544
    s_sub_u32 s57, s100, 917504
    buffer_load_dwordx4 v1, s[8:11], s57 offen sc1 lds
    s_add_u32 m0, s101, 45472
    s_sub_u32 s57, s100, 974848
    buffer_load_dwordx4 v1, s[8:11], s57 offen sc1 lds
    s_add_u32 m0, s101, 46400
    s_sub_u32 s57, s100, 1032192
    buffer_load_dwordx4 v1, s[8:11], s57 offen sc1 lds
    s_add_u32 m0, s101, 47328
    s_sub_u32 s57, s100, 1089536
    buffer_load_dwordx4 v1, s[8:11], s57 offen sc1 lds
    s_mov_b64 exec, -1
    s_waitcnt vmcnt(0)
    s_barrier
    s_branch L_tagain
L_slow_95:
    s_add_u32 s37, s34, s49
L_re_97:
    buffer_load_dwordx4 v[216:219], v1, s[8:11], s37 offen offset:0 sc1
    buffer_load_dwordx4 v[200:203], v1, s[8:11], s37 offen offset:1024 sc1
    s_waitcnt vmcnt(0)
    v_and_b32 v21, v216, v217
    v_bitop3_b32 v21, v21, v218, v219 bitop3:0x80
    v_bitop3_b32 v21, v21, v200, v201 bitop3:0x80
    v_bitop3_b32 v21, v21, v202, v203 bitop3:0x80
    v_cmp_le_i32 vcc, 0, v21
    s_sub_i32 s39, s39, 1
    s_max_i32 s39, s39, 0
    s_cbranch_scc0 L_back_96
    s_cbranch_vccnz L_re_97
    s_branch L_back_96
L_slow_98:
    s_add_u32 s37, s34, s49
L_re_100:
    buffer_load_dwordx4 v[220:223], v1, s[8:11], s37 offen offset:2048 sc1
    buffer_load_dwordx4 v[204:207], v1, s[8:11], s37 offen offset:3072 sc1
    s_waitcnt vmcnt(0)
    v_and_b32 v21, v220, v221
    v_bitop3_b32 v21, v21, v222, v223 bitop3:0x80
    v_bitop3_b32 v21, v21, v204, v205 bitop3:0x80
    v_bitop3_b32 v21, v21, v206, v207 bitop3:0x80
    v_cmp_le_i32 vcc, 0, v21
    s_sub_i32 s39, s39, 1
    s_max_i32 s39, s39, 0
    s_cbranch_scc0 L_back_99
    s_cbranch_vccnz L_re_100
    s_branch L_back_99
L_slow_101:
    s_add_u32 s37, s34, s50
L_re_103:
    buffer_load_dwordx4 v[224:227], v1, s[8:11], s37 offen offset:0 sc1
    buffer_load_dwordx4 v[208:211], v1, s[8:11], s37 offen offset:1024 sc1
    s_waitcnt vmcnt(0)
    v_and_b32 v21, v224, v225
    v_bitop3_b32 v21, v21, v226, v227 bitop3:0x80
    v_bitop3_b32 v21, v21, v208, v209 bitop3:0x80
    v_bitop3_b32 v21, v21, v210, v211 bitop3:0x80
    v_cmp_le_i32 vcc, 0, v21
    s_sub_i32 s39, s39, 1
    s_max_i32 s39, s39, 0
    s_cbranch_scc0 L_back_102
    s_cbranch_vccnz L_re_103
    s_branch L_back_102
L_slow_104:
    s_add_u32 s37, s34, s50
L_re_106:
    buffer_load_dwordx4 v[228:231], v1, s[8:11], s37 offen offset:2048 sc1
    buffer_load_dwordx4 v[212:215], v1, s[8:11], s37 offen offset:3072 sc1
    s_waitcnt vmcnt(0)
    v_and_b32 v21, v228, v229
    v_bitop3_b32 v21, v21, v230, v231 bitop3:0x80
    v_bitop3_b32 v21, v21, v212, v213 bitop3:0x80
    v_bitop3_b32 v21, v21, v214, v215 bitop3:0x80
    v_cmp_le_i32 vcc, 0, v21
    s_sub_i32 s39, s39, 1
    s_max_i32 s39, s39, 0
    s_cbranch_scc0 L_back_105
    s_cbranch_vccnz L_re_106
    s_branch L_back_105
L_slow_107:
    s_add_u32 s37, s34, s51
L_re_109:
    buffer_load_dwordx4 v[24:27], v1, s[8:11], s37 offen offset:0 sc1
    buffer_load_dwordx4 v[28:31], v1, s[8:11], s37 offen offset:1024 sc1
    s_waitcnt vmcnt(0)
    v_and_b32 v21, v24, v25
    v_bitop3_b32 v21, v21, v26, v27 bitop3:0x80
    v_bitop3_b32 v21, v21, v28, v29 bitop3:0x80
    v_bitop3_b32 v21, v21, v30, v31 bitop3:0x80
    v_cmp_le_i32 vcc, 0, v21
    s_sub_i32 s39, s39, 1
    s_max_i32 s39, s39, 0
    s_cbranch_scc0 L_back_108
    s_cbranch_vccnz L_re_109
    s_branch L_back_108
L_slow_110:
    s_add_u32 s37, s34, s51
L_re_112:
    buffer_load_dwordx4 v[32:35], v1, s[8:11], s37 offen offset:2048 sc1
    buffer_load_dwordx4 v[36:39], v1, s[8:11], s37 offen offset:3072 sc1
    s_waitcnt vmcnt(0)
    v_and_b32 v21, v32, v33
    v_bitop3_b32 v21, v21, v34, v35 bitop3:0x80
    v_bitop3_b32 v21, v21, v36, v37 bitop3:0x80
    v_bitop3_b32 v21, v21, v38, v39 bitop3:0x80
    v_cmp_le_i32 vcc, 0, v21
    s_sub_i32 s39, s39, 1
    s_max_i32 s39, s39, 0
    s_cbranch_scc0 L_back_111
    s_cbranch_vccnz L_re_112
    s_branch L_back_111
L_slow_113:
    s_add_u32 s37, s34, s52
L_re_115:
    buffer_load_dwordx4 v[40:43], v1, s[8:11], s37 offen offset:0 sc1
    buffer_load_dwordx4 v[44:47], v1, s[8:11], s37 offen offset:1024 sc1
    s_waitcnt vmcnt(0)
    v_and_b32 v21, v40, v41
    v_bitop3_b32 v21, v21, v42, v43 bitop3:0x80
    v_bitop3_b32 v21, v21, v44, v45 bitop3:0x80
    v_bitop3_b32 v21, v21, v46, v47 bitop3:0x80
    v_cmp_le_i32 vcc, 0, v21
    s_sub_i32 s39, s39, 1
    s_max_i32 s39, s39, 0
    s_cbranch_scc0 L_back_114
    s_cbranch_vccnz L_re_115
    s_branch L_back_114
L_slow_116:
    s_add_u32 s37, s34, s52
L_re_118:
    buffer_load_dwordx4 v[48:51], v1, s[8:11], s37 offen offset:2048 sc1
    buffer_load_dwordx4 v[52:55], v1, s[8:11], s37 offen offset:3072 sc1
    s_waitcnt vmcnt(0)
    v_and_b32 v21, v48, v49
    v_bitop3_b32 v21, v21, v50, v51 bitop3:0x80
    v_bitop3_b32 v21, v21, v52, v53 bitop3:0x80
    v_bitop3_b32 v21, v21, v54, v55 bitop3:0x80
    v_cmp_le_i32 vcc, 0, v21
    s_sub_i32 s39, s39, 1
    s_max_i32 s39, s39, 0
    s_cbranch_scc0 L_back_117
    s_cbranch_vccnz L_re_118
    s_branch L_back_117
L_slow_119:
    s_add_u32 s37, s34, s53
L_re_121:
    buffer_load_dwordx4 v[248:251], v1, s[8:11], s37 offen offset:0 sc1
    buffer_load_dwordx4 v[252:255], v1, s[8:11], s37 offen offset:1024 sc1
    s_waitcnt vmcnt(0)
    v_and_b32 v21, v248, v249
    v_bitop3_b32 v21, v21, v250, v251 bitop3:0x80
    v_bitop3_b32 v21, v21, v252, v253 bitop3:0x80
    v_bitop3_b32 v21, v21, v254, v255 bitop3:0x80
    v_cmp_le_i32 vcc, 0, v21
    s_sub_i32 s39, s39, 1
    s_max_i32 s39, s39, 0
    s_cbranch_scc0 L_back_120
    s_cbranch_vccnz L_re_121
    s_branch L_back_120
L_slow_122:
    s_add_u32 s37, s34, s53
L_re_124:
    buffer_load_dwordx4 v[216:219], v1, s[8:11], s37 offen offset:2048 sc1
    buffer_load_dwordx4 v[200:203], v1, s[8:11], s37 offen offset:3072 sc1
    s_waitcnt vmcnt(0)
    v_and_b32 v21, v216, v217
    v_bitop3_b32 v21, v21, v218, v219 bitop3:0x80
    v_bitop3_b32 v21, v21, v200, v201 bitop3:0x80
    v_bitop3_b32 v21, v21, v202, v203 bitop3:0x80
    v_cmp_le_i32 vcc, 0, v21
    s_sub_i32 s39, s39, 1
    s_max_i32 s39, s39, 0
    s_cbranch_scc0 L_back_123
    s_cbranch_vccnz L_re_124
    s_branch L_back_123
L_slow_125:
    s_add_u32 s37, s34, s54
L_re_127:
    buffer_load_dwordx4 v[220:223], v1, s[8:11], s37 offen offset:0 sc1
    buffer_load_dwordx4 v[204:207], v1, s[8:11], s37 offen offset:1024 sc1
    buffer_load_dwordx4 v[224:227], v1, s[8:11], s37 offen offset:2048 sc1
    buffer_load_dwordx4 v[208:211], v1, s[8:11], s37 offen offset:3072 sc1
    s_waitcnt vmcnt(0)
    v_and_b32 v21, v220, v221
    v_bitop3_b32 v21, v21, v222, v223 bitop3:0x80
    v_bitop3_b32 v21, v21, v204, v205 bitop3:0x80
    v_bitop3_b32 v21, v21, v206, v207 bitop3:0x80
    v_bitop3_b32 v21, v21, v224, v225 bitop3:0x80
    v_bitop3_b32 v21, v21, v226, v227 bitop3:0x80
    v_bitop3_b32 v21, v21, v208, v209 bitop3:0x80
    v_bitop3_b32 v21, v21, v210, v211 bitop3:0x80
    v_cmp_le_i32 vcc, 0, v21
    s_sub_i32 s39, s39, 1
    s_max_i32 s39, s39, 0
    s_cbranch_scc0 L_back_126
    s_cbranch_vccnz L_re_127
    s_branch L_back_126
L_slow_128:
    s_add_u32 s37, s35, s49
L_re_130:
    buffer_load_dwordx4 v[228:231], v1, s[8:11], s37 offen offset:0 sc1
    buffer_load_dwordx4 v[212:215], v1, s[8:11], s37 offen offset:1024 sc1
    s_waitcnt vmcnt(0)
    v_and_b32 v21, v228, v229
    v_bitop3_b32 v21, v21, v230, v231 bitop3:0x80
    v_bitop3_b32 v21, v21, v212, v213 bitop3:0x80
    v_bitop3_b32 v21, v21, v214, v215 bitop3:0x80
    v_cmp_le_i32 vcc, 0, v21
    s_sub_i32 s39, s39, 1
    s_max_i32 s39, s39, 0
    s_cbranch_scc0 L_back_129
    s_cbranch_vccnz L_re_130
    s_branch L_back_129
L_slow_131:
    s_add_u32 s37, s35, s49
L_re_133:
    buffer_load_dwordx4 v[24:27], v1, s[8:11], s37 offen offset:2048 sc1
    buffer_load_dwordx4 v[28:31], v1, s[8:11], s37 offen offset:3072 sc1
    s_waitcnt vmcnt(0)
    v_and_b32 v21, v24, v25
    v_bitop3_b32 v21, v21, v26, v27 bitop3:0x80
    v_bitop3_b32 v21, v21, v28, v29 bitop3:0x80
    v_bitop3_b32 v21, v21, v30, v31 bitop3:0x80
    v_cmp_le_i32 vcc, 0, v21
    s_sub_i32 s39, s39, 1
    s_max_i32 s39, s39, 0
    s_cbranch_scc0 L_back_132
    s_cbranch_vccnz L_re_133
    s_branch L_back_132
L_slow_134:
    s_add_u32 s37, s35, s50
L_re_136:
    buffer_load_dwordx4 v[32:35], v1, s[8:11], s37 offen offset:0 sc1
    buffer_load_dwordx4 v[36:39], v1, s[8:11], s37 offen offset:1024 sc1
    s_waitcnt vmcnt(0)
    v_and_b32 v21, v32, v33
    v_bitop3_b32 v21, v21, v34, v35 bitop3:0x80
    v_bitop3_b32 v21, v21, v36, v37 bitop3:0x80
    v_bitop3_b32 v21, v21, v38, v39 bitop3:0x80
    v_cmp_le_i32 vcc, 0, v21
    s_sub_i32 s39, s39, 1
    s_max_i32 s39, s39, 0
    s_cbranch_scc0 L_back_135
    s_cbranch_vccnz L_re_136
    s_branch L_back_135
L_slow_137:
    s_add_u32 s37, s35, s50
L_re_139:
    buffer_load_dwordx4 v[40:43], v1, s[8:11], s37 offen offset:2048 sc1
    buffer_load_dwordx4 v[44:47], v1, s[8:11], s37 offen offset:3072 sc1
    s_waitcnt vmcnt(0)
    v_and_b32 v21, v40, v41
    v_bitop3_b32 v21, v21, v42, v43 bitop3:0x80
    v_bitop3_b32 v21, v21, v44, v45 bitop3:0x80
    v_bitop3_b32 v21, v21, v46, v47 bitop3:0x80
    v_cmp_le_i32 vcc, 0, v21
    s_sub_i32 s39, s39, 1
    s_max_i32 s39, s39, 0
    s_cbranch_scc0 L_back_138
    s_cbranch_vccnz L_re_139
    s_branch L_back_138
L_slow_140:
    s_add_u32 s37, s35, s51
L_re_142:
    buffer_load_dwordx4 v[48:51], v1, s[8:11], s37 offen offset:0 sc1
    buffer_load_dwordx4 v[52:55], v1, s[8:11], s37 offen offset:1024 sc1
    s_waitcnt vmcnt(0)
    v_and_b32 v21, v48, v49
    v_bitop3_b32 v21, v21, v50, v51 bitop3:0x80
    v_bitop3_b32 v21, v21, v52, v53 bitop3:0x80
    v_bitop3_b32 v21, v21, v54, v55 bitop3:0x80
    v_cmp_le_i32 vcc, 0, v21
    s_sub_i32 s39, s39, 1
    s_max_i32 s39, s39, 0
    s_cbranch_scc0 L_back_141
    s_cbranch_vccnz L_re_142
    s_branch L_back_141
L_slow_143:
    s_add_u32 s37, s35, s51
L_re_145:
    buffer_load_dwordx4 v[248:251], v1, s[8:11], s37 offen offset:2048 sc1
    buffer_load_dwordx4 v[252:255], v1, s[8:11], s37 offen offset:3072 sc1
    s_waitcnt vmcnt(0)
    v_and_b32 v21, v248, v249
    v_bitop3_b32 v21, v21, v250, v251 bitop3:0x80
    v_bitop3_b32 v21, v21, v252, v253 bitop3:0x80
    v_bitop3_b32 v21, v21, v254, v255 bitop3:0x80
    v_cmp_le_i32 vcc, 0, v21
    s_sub_i32 s39, s39, 1
    s_max_i32 s39, s39, 0
    s_cbranch_scc0 L_back_144
    s_cbranch_vccnz L_re_145
    s_branch L_back_144
L_slow_146:
    s_add_u32 s37, s35, s52
L_re_148:
    buffer_load_dwordx4 v[216:219], v1, s[8:11], s37 offen offset:0 sc1
    buffer_load_dwordx4 v[200:203], v1, s[8:11], s37 offen offset:1024 sc1
    s_waitcnt vmcnt(0)
    v_and_b32 v21, v216, v217
    v_bitop3_b32 v21, v21, v218, v219 bitop3:0x80
    v_bitop3_b32 v21, v21, v200, v201 bitop3:0x80
    v_bitop3_b32 v21, v21, v202, v203 bitop3:0x80
    v_cmp_le_i32 vcc, 0, v21
    s_sub_i32 s39, s39, 1
    s_max_i32 s39, s39, 0
    s_cbranch_scc0 L_back_147
    s_cbranch_vccnz L_re_148
    s_branch L_back_147
L_slow_149:
    s_add_u32 s37, s35, s52
L_re_151:
    buffer_load_dwordx4 v[220:223], v1, s[8:11], s37 offen offset:2048 sc1
    buffer_load_dwordx4 v[204:207], v1, s[8:11], s37 offen offset:3072 sc1
    s_waitcnt vmcnt(0)
    v_and_b32 v21, v220, v221
    v_bitop3_b32 v21, v21, v222, v223 bitop3:0x80
    v_bitop3_b32 v21, v21, v204, v205 bitop3:0x80
    v_bitop3_b32 v21, v21, v206, v207 bitop3:0x80
    v_cmp_le_i32 vcc, 0, v21
    s_sub_i32 s39, s39, 1
    s_max_i32 s39, s39, 0
    s_cbranch_scc0 L_back_150
    s_cbranch_vccnz L_re_151
    s_branch L_back_150
L_slow_152:
    s_add_u32 s37, s35, s53
L_re_154:
    buffer_load_dwordx4 v[224:227], v1, s[8:11], s37 offen offset:0 sc1
    buffer_load_dwordx4 v[208:211], v1, s[8:11], s37 offen offset:1024 sc1
    s_waitcnt vmcnt(0)
    v_and_b32 v21, v224, v225
    v_bitop3_b32 v21, v21, v226, v227 bitop3:0x80
    v_bitop3_b32 v21, v21, v208, v209 bitop3:0x80
    v_bitop3_b32 v21, v21, v210, v211 bitop3:0x80
    v_cmp_le_i32 vcc, 0, v21
    s_sub_i32 s39, s39, 1
    s_max_i32 s39, s39, 0
    s_cbranch_scc0 L_back_153
    s_cbranch_vccnz L_re_154
    s_branch L_back_153
L_slow_155:
    s_add_u32 s37, s35, s53
L_re_157:
    buffer_load_dwordx4 v[228:231], v1, s[8:11], s37 offen offset:2048 sc1
    buffer_load_dwordx4 v[212:215], v1, s[8:11], s37 offen offset:3072 sc1
    s_waitcnt vmcnt(0)
    v_and_b32 v21, v228, v229
    v_bitop3_b32 v21, v21, v230, v231 bitop3:0x80
    v_bitop3_b32 v21, v21, v212, v213 bitop3:0x80
    v_bitop3_b32 v21, v21, v214, v215 bitop3:0x80
    v_cmp_le_i32 vcc, 0, v21
    s_sub_i32 s39, s39, 1
    s_max_i32 s39, s39, 0
    s_cbranch_scc0 L_back_156
    s_cbranch_vccnz L_re_157
    s_branch L_back_156
L_slow_158:
    s_add_u32 s37, s35, s54
L_re_160:
    buffer_load_dwordx4 v[24:27], v1, s[8:11], s37 offen offset:0 sc1
    buffer_load_dwordx4 v[28:31], v1, s[8:11], s37 offen offset:1024 sc1
    buffer_load_dwordx4 v[32:35], v1, s[8:11], s37 offen offset:2048 sc1
    buffer_load_dwordx4 v[36:39], v1, s[8:11], s37 offen offset:3072 sc1
    s_waitcnt vmcnt(0)
    v_and_b32 v21, v24, v25
    v_bitop3_b32 v21, v21, v26, v27 bitop3:0x80
    v_bitop3_b32 v21, v21, v28, v29 bitop3:0x80
    v_bitop3_b32 v21, v21, v30, v31 bitop3:0x80
    v_bitop3_b32 v21, v21, v32, v33 bitop3:0x80
    v_bitop3_b32 v21, v21, v34, v35 bitop3:0x80
    v_bitop3_b32 v21, v21, v36, v37 bitop3:0x80
    v_bitop3_b32 v21, v21, v38, v39 bitop3:0x80
    v_cmp_le_i32 vcc, 0, v21
    s_sub_i32 s39, s39, 1
    s_max_i32 s39, s39, 0
    s_cbranch_scc0 L_back_159
    s_cbranch_vccnz L_re_160
    s_branch L_back_159
L_helper:
    s_sub_u32 s24, s2, 224
    s_lshr_b32 s24, s24, 3
    s_lshl2_add_u32 s24, s30, s24
    s_lshl2_add_u32 s31, s24, s26
    v_lshrrev_b32 v136, 3, v0
    v_and_b32 v137, 6, v136
    v_xor_b32 v137, v137, v0
    v_and_b32 v137, 7, v137
    v_lshlrev_b32 v137, 4, v137
    v_mul_u32_u24 v138, 896, v136
    v_mov_b32 v20, 1
    v_mov_b32 v168, 0
    v_mov_b32 v172, -1
    v_mov_b32 v169, 0
    v_mov_b32 v173, -1
    v_mov_b32 v170, 0
    v_mov_b32 v174, -1
    v_mov_b32 v171, 0
    v_mov_b32 v175, -1
    s_waitcnt lgkmcnt(0)
    s_and_b32 s9, s9, 0xffff
    s_mov_b32 s39, 262144
    s_mov_b32 s16, s40
    s_and_b32 s17, s41, 0xffff
    s_mov_b32 s18, 1605632
    s_mov_b32 s19, 0x20000
    s_mov_b32 s20, s42
    s_and_b32 s21, s43, 0xffff
    s_mov_b32 s22, 1605632
    s_mov_b32 s23, 0x20000
    s_mov_b32 s12, s44
    s_and_b32 s13, s45, 0xffff
    s_mov_b32 s14, 1835008
    s_mov_b32 s15, 0x20000
    s_mov_b32 s92, s46
    s_and_b32 s93, s47, 0xffff
    s_mov_b32 s94, 256
    s_mov_b32 s95, 0x20000
    s_cmp_lt_u32 s2, 232
    s_cselect_b32 s28, 0, 1073741824
    s_cmp_lt_u32 s26, 2
    s_cselect_b32 s28, s28, 1073741824
    v_add_u32 v236, s28, v1
    s_lshl3_add_u32 s38, s26, s30
    s_lshl_b32 s34, s38, 12
    s_add_u32 s34, s34, 65536
    s_lshl_b32 s35, s38, 7
    s_add_u32 s35, s35, 16384
    buffer_store_dwordx4 v[168:171], v236, s[8:11], s34 offen offset:0 sc1
    buffer_store_dwordx4 v[168:171], v236, s[8:11], s34 offen offset:1024 sc1
    buffer_store_dwordx4 v[168:171], v236, s[8:11], s34 offen offset:2048 sc1
    buffer_store_dwordx4 v[168:171], v236, s[8:11], s34 offen offset:3072 sc1
    s_mov_b64 exec, 0xff
    buffer_store_dwordx4 v[168:171], v236, s[8:11], s35 offen sc1
    s_lshl_b32 s34, s31, 8
    s_add_u32 s34, s34, 32768
    s_mov_b64 exec, 0xffff
    buffer_store_dwordx4 v[168:171], v1, s[8:11], s34 offen sc1
    s_mov_b64 exec, -1
    s_add_u32 s32, s31, 0
    s_mul_i32 s27, s32, 4682
    s_lshr_b32 s27, s27, 16
    s_mul_i32 s33, s27, 14
    s_sub_u32 s33, s32, s33
    s_lshr_b32 s25, s27, 2
    s_and_b32 s27, s27, 3
    s_cmp_ge_u32 s33, 8
    s_cselect_b32 s35, 7, 1
    s_cselect_b32 s29, 0, 32
    s_sub_u32 s35, s33, s35
    s_sub_u32 s34, s35, 1
    s_cmp_lt_u32 s34, s25
    s_cselect_b32 s34, s34, s35
    s_cmp_lt_u32 s33, 2
    s_cselect_b32 s34, s25, s34
    s_cmp_eq_u32 s33, 0
    s_cselect_b32 s29, 0, s29
    s_lshl2_add_u32 s34, s34, s27
    s_lshl_b32 s34, s34, 6
    s_add_u32 s34, s34, s29
    s_mul_i32 s34, s34, 896
    s_lshl_b32 s35, s25, 7
    s_add_u32 s34, s34, s35
    s_lshl_b32 s35, s32, 12
    s_add_u32 s35, s35, 262144
    s_cmp_lt_u32 s32, 392
    s_cselect_b32 s34, s34, 1073741824
    s_cselect_b32 s35, s35, 1073741824
    s_and_b32 s27, s27, 1
    s_lshl_b32 s27, s27, 6
    v_xor_b32 v22, s27, v137
    v_add3_u32 v22, v22, v138, s34
    v_add_u32 v232, s35, v1
    s_add_u32 m0, s60, 0
    s_mov_b32 s34, 0
    buffer_load_dwordx4 v22, s[20:23], s34 offen offset:0 lds
    s_mov_b32 s34, 13312
    buffer_load_dwordx4 v22, s[20:23], s34 offen offset:1024 lds
    s_mov_b32 s34, 5120
    buffer_load_dwordx4 v22, s[20:23], s34 offen offset:2048 lds
    s_mov_b32 s34, 18432
    buffer_load_dwordx4 v22, s[20:23], s34 offen offset:3072 lds
    v_lshl_add_u32 v236, v0, 8, s28
    s_waitcnt vmcnt(5)
    buffer_atomic_add v20, v236, s[92:95], 0 offen sc1
    s_add_u32 s32, s31, 128
    s_mul_i32 s27, s32, 4682
    s_lshr_b32 s27, s27, 16
    s_mul_i32 s33, s27, 14
    s_sub_u32 s33, s32, s33
    s_lshr_b32 s25, s27, 2
    s_and_b32 s27, s27, 3
    s_cmp_ge_u32 s33, 8
    s_cselect_b32 s35, 7, 1
    s_cselect_b32 s29, 0, 32
    s_sub_u32 s35, s33, s35
    s_sub_u32 s34, s35, 1
    s_cmp_lt_u32 s34, s25
    s_cselect_b32 s34, s34, s35
    s_cmp_lt_u32 s33, 2
    s_cselect_b32 s34, s25, s34
    s_cmp_eq_u32 s33, 0
    s_cselect_b32 s29, 0, s29
    s_lshl2_add_u32 s34, s34, s27
    s_lshl_b32 s34, s34, 6
    s_add_u32 s34, s34, s29
    s_mul_i32 s34, s34, 896
    s_lshl_b32 s35, s25, 7
    s_add_u32 s34, s34, s35
    s_lshl_b32 s35, s32, 12
    s_add_u32 s35, s35, 262144
    s_cmp_lt_u32 s32, 392
    s_cselect_b32 s34, s34, 1073741824
    s_cselect_b32 s35, s35, 1073741824
    s_and_b32 s27, s27, 1
    s_lshl_b32 s27, s27, 6
    v_xor_b32 v22, s27, v137
    v_add3_u32 v22, v22, v138, s34
    v_add_u32 v233, s35, v1
    s_add_u32 m0, s60, 4096
    s_mov_b32 s34, 0
    buffer_load_dwordx4 v22, s[20:23], s34 offen offset:0 lds
    s_mov_b32 s34, 13312
    buffer_load_dwordx4 v22, s[20:23], s34 offen offset:1024 lds
    s_mov_b32 s34, 5120
    buffer_load_dwordx4 v22, s[20:23], s34 offen offset:2048 lds
    s_mov_b32 s34, 18432
    buffer_load_dwordx4 v22, s[20:23], s34 offen offset:3072 lds
    s_add_u32 s32, s31, 256
    s_mul_i32 s27, s32, 4682
    s_lshr_b32 s27, s27, 16
    s_mul_i32 s33, s27, 14
    s_sub_u32 s33, s32, s33
    s_lshr_b32 s25, s27, 2
    s_and_b32 s27, s27, 3
    s_cmp_ge_u32 s33, 8
    s_cselect_b32 s35, 7, 1
    s_cselect_b32 s29, 0, 32
    s_sub_u32 s35, s33, s35
    s_sub_u32 s34, s35, 1
    s_cmp_lt_u32 s34, s25
    s_cselect_b32 s34, s34, s35
    s_cmp_lt_u32 s33, 2
    s_cselect_b32 s34, s25, s34
    s_cmp_eq_u32 s33, 0
    s_cselect_b32 s29, 0, s29
    s_lshl2_add_u32 s34, s34, s27
    s_lshl_b32 s34, s34, 6
    s_add_u32 s34, s34, s29
    s_mul_i32 s34, s34, 896
    s_lshl_b32 s35, s25, 7
    s_add_u32 s34, s34, s35
    s_lshl_b32 s35, s32, 12
    s_add_u32 s35, s35, 262144
    s_cmp_lt_u32 s32, 392
    s_cselect_b32 s34, s34, 1073741824
    s_cselect_b32 s35, s35, 1073741824
    s_and_b32 s27, s27, 1
    s_lshl_b32 s27, s27, 6
    v_xor_b32 v22, s27, v137
    v_add3_u32 v22, v22, v138, s34
    v_add_u32 v234, s35, v1
    s_add_u32 m0, s60, 8192
    s_mov_b32 s34, 0
    buffer_load_dwordx4 v22, s[20:23], s34 offen offset:0 lds
    s_mov_b32 s34, 13312
    buffer_load_dwordx4 v22, s[20:23], s34 offen offset:1024 lds
    s_mov_b32 s34, 5120
    buffer_load_dwordx4 v22, s[20:23], s34 offen offset:2048 lds
    s_mov_b32 s34, 18432
    buffer_load_dwordx4 v22, s[20:23], s34 offen offset:3072 lds
    s_add_u32 s32, s2, 136
    s_cmp_ge_u32 s2, 248
    s_cselect_b32 s32, s32, 500
    s_cmp_eq_u32 s26, 1
    s_cselect_b32 s32, s32, 500
    s_mul_i32 s27, s32, 4682
    s_lshr_b32 s27, s27, 16
    s_mul_i32 s33, s27, 14
    s_sub_u32 s33, s32, s33
    s_lshr_b32 s25, s27, 2
    s_and_b32 s27, s27, 3
    s_cmp_ge_u32 s33, 8
    s_cselect_b32 s35, 7, 1
    s_cselect_b32 s29, 0, 32
    s_sub_u32 s35, s33, s35
    s_sub_u32 s34, s35, 1
    s_cmp_lt_u32 s34, s25
    s_cselect_b32 s34, s34, s35
    s_cmp_lt_u32 s33, 2
    s_cselect_b32 s34, s25, s34
    s_cmp_eq_u32 s33, 0
    s_cselect_b32 s29, 0, s29
    s_lshl2_add_u32 s34, s34, s27
    s_lshl_b32 s34, s34, 6
    s_add_u32 s34, s34, s29
    s_mul_i32 s34, s34, 896
    s_lshl_b32 s35, s25, 7
    s_add_u32 s34, s34, s35
    s_lshl_b32 s35, s32, 12
    s_add_u32 s35, s35, 262144
    s_cmp_lt_u32 s32, 392
    s_cselect_b32 s34, s34, 1073741824
    s_cselect_b32 s35, s35, 1073741824
    s_and_b32 s27, s27, 1
    s_lshl_b32 s27, s27, 6
    v_xor_b32 v22, s27, v137
    v_add3_u32 v22, v22, v138, s34
    v_add_u32 v235, s35, v1
    s_add_u32 m0, s60, 12288
    s_mov_b32 s34, 0
    buffer_load_dwordx4 v22, s[20:23], s34 offen offset:0 lds
    s_mov_b32 s34, 13312
    buffer_load_dwordx4 v22, s[20:23], s34 offen offset:1024 lds
    s_mov_b32 s34, 5120
    buffer_load_dwordx4 v22, s[20:23], s34 offen offset:2048 lds
    s_mov_b32 s34, 18432
    buffer_load_dwordx4 v22, s[20:23], s34 offen offset:3072 lds
    v_bfe_u32 v136, v0, 2, 3
    v_lshrrev_b32 v22, 5, v0
    v_lshlrev_b32 v22, 11, v22
    v_lshl_add_u32 v22, v136, 7, v22
    v_lshrrev_b32 v136, 1, v136
    v_lshl_add_u32 v22, v136, 5, v22
    v_and_b32 v23, 3, v0
    v_lshl_add_u32 v22, v23, 3, v22
    v_add_u32 v252, s60, v22
    v_xor_b32 v253, 32, v252
    v_xor_b32 v254, 64, v252
    v_xor_b32 v255, 96, v252
    s_waitcnt vmcnt(13)
    ds_read_b64_tr_b16 v[24:25], v252 offset:0
    ds_read_b64_tr_b16 v[26:27], v252 offset:1024
    ds_read_b64_tr_b16 v[28:29], v253 offset:0
    ds_read_b64_tr_b16 v[30:31], v253 offset:1024
    ds_read_b64_tr_b16 v[32:33], v254 offset:0
    ds_read_b64_tr_b16 v[34:35], v254 offset:1024
    ds_read_b64_tr_b16 v[36:37], v255 offset:0
    ds_read_b64_tr_b16 v[38:39], v255 offset:1024
    s_waitcnt lgkmcnt(6)
    buffer_store_dwordx4 v[24:27], v232, s[8:11], 0 offen offset:0 sc1
    s_waitcnt lgkmcnt(4)
    buffer_store_dwordx4 v[28:31], v232, s[8:11], 0 offen offset:1024 sc1
    s_waitcnt lgkmcnt(2)
    buffer_store_dwordx4 v[32:35], v232, s[8:11], 0 offen offset:2048 sc1
    s_waitcnt lgkmcnt(0)
    buffer_store_dwordx4 v[36:39], v232, s[8:11], 0 offen offset:3072 sc1
    s_waitcnt vmcnt(12)
    ds_read_b64_tr_b16 v[40:41], v252 offset:4096
    ds_read_b64_tr_b16 v[42:43], v252 offset:5120
    ds_read_b64_tr_b16 v[44:45], v253 offset:4096
    ds_read_b64_tr_b16 v[46:47], v253 offset:5120
    ds_read_b64_tr_b16 v[48:49], v254 offset:4096
    ds_read_b64_tr_b16 v[50:51], v254 offset:5120
    ds_read_b64_tr_b16 v[52:53], v255 offset:4096
    ds_read_b64_tr_b16 v[54:55], v255 offset:5120
    s_waitcnt lgkmcnt(6)
    buffer_store_dwordx4 v[40:43], v233, s[8:11], 0 offen offset:0 sc1
    s_waitcnt lgkmcnt(4)
    buffer_store_dwordx4 v[44:47], v233, s[8:11], 0 offen offset:1024 sc1
    s_waitcnt lgkmcnt(2)
    buffer_store_dwordx4 v[48:51], v233, s[8:11], 0 offen offset:2048 sc1
    s_waitcnt lgkmcnt(0)
    buffer_store_dwordx4 v[52:55], v233, s[8:11], 0 offen offset:3072 sc1
    s_waitcnt vmcnt(12)
    ds_read_b64_tr_b16 v[56:57], v252 offset:8192
    ds_read_b64_tr_b16 v[58:59], v252 offset:9216
    ds_read_b64_tr_b16 v[60:61], v253 offset:8192
    ds_read_b64_tr_b16 v[62:63], v253 offset:9216
    ds_read_b64_tr_b16 v[64:65], v254 offset:8192
    ds_read_b64_tr_b16 v[66:67], v254 offset:9216
    ds_read_b64_tr_b16 v[68:69], v255 offset:8192
    ds_read_b64_tr_b16 v[70:71], v255 offset:9216
    s_waitcnt lgkmcnt(6)
    buffer_store_dwordx4 v[56:59], v234, s[8:11], 0 offen offset:0 sc1
    s_waitcnt lgkmcnt(4)
    buffer_store_dwordx4 v[60:63], v234, s[8:11], 0 offen offset:1024 sc1
    s_waitcnt lgkmcnt(2)
    buffer_store_dwordx4 v[64:67], v234, s[8:11], 0 offen offset:2048 sc1
    s_waitcnt lgkmcnt(0)
    buffer_store_dwordx4 v[68:71], v234, s[8:11], 0 offen offset:3072 sc1
    s_waitcnt vmcnt(12)
    ds_read_b64_tr_b16 v[72:73], v252 offset:12288
    ds_read_b64_tr_b16 v[74:75], v252 offset:13312
    ds_read_b64_tr_b16 v[76:77], v253 offset:12288
    ds_read_b64_tr_b16 v[78:79], v253 offset:13312
    ds_read_b64_tr_b16 v[80:81], v254 offset:12288
    ds_read_b64_tr_b16 v[82:83], v254 offset:13312
    ds_read_b64_tr_b16 v[84:85], v255 offset:12288
    ds_read_b64_tr_b16 v[86:87], v255 offset:13312
    s_waitcnt lgkmcnt(6)
    buffer_store_dwordx4 v[72:75], v235, s[8:11], 0 offen offset:0 sc1
    s_waitcnt lgkmcnt(4)
    buffer_store_dwordx4 v[76:79], v235, s[8:11], 0 offen offset:1024 sc1
    s_waitcnt lgkmcnt(2)
    buffer_store_dwordx4 v[80:83], v235, s[8:11], 0 offen offset:2048 sc1
    s_waitcnt lgkmcnt(0)
    buffer_store_dwordx4 v[84:87], v235, s[8:11], 0 offen offset:3072 sc1
    buffer_load_dword v21, off, s[92:95], 0 sc1
    v_lshlrev_b32 v22, 7, v0
    s_mov_b32 s34, 16384
    s_lshl3_add_u32 s37, s24, s26
    s_mul_i32 s32, s37, 28672
    s_add_u32 s32, s32, 2842624
    s_lshl_b32 s37, s37, 7
    s_add_u32 s37, s37, 32768
    s_mov_b32 s33, 3
L_fl_161:
    buffer_store_dwordx4 v[172:175], v1, s[8:11], s32 offen sc1
    buffer_store_dwordx4 v[172:175], v1, s[8:11], s32 offen offset:1024 sc1
    s_add_u32 s32, s32, 2048
    s_sub_u32 s33, s33, 1
    s_cmp_lg_u32 s33, 0
    s_cbranch_scc1 L_fl_161
    s_waitcnt vmcnt(6)
    s_barrier
    s_cmp_lg_u32 s26, 0
    s_cbranch_scc1 L_w0_162
    v_cmp_gt_u32 vcc, 16, v21
    s_cbranch_vccz L_ok_163
L_sp_164:
    buffer_load_dword v21, off, s[92:95], 0 sc1
    s_waitcnt vmcnt(0)
    v_cmp_gt_u32 vcc, 16, v21
    s_sub_i32 s39, s39, 1
    s_max_i32 s39, s39, 0
    s_cbranch_scc0 L_ok_163
    s_cbranch_vccnz L_sp_164
L_ok_163:
    s_mov_b64 exec, 0xff
    buffer_atomic_add v20, v22, s[8:11], s34 offen offset:0 sc1
    s_mov_b64 exec, -1
L_w0_162:
    s_mov_b32 s33, 11
L_fl_165:
    buffer_store_dwordx4 v[172:175], v1, s[8:11], s32 offen sc1
    buffer_store_dwordx4 v[172:175], v1, s[8:11], s32 offen offset:1024 sc1
    s_add_u32 s32, s32, 2048
    s_sub_u32 s33, s33, 1
    s_cmp_lg_u32 s33, 0
    s_cbranch_scc1 L_fl_165
    s_add_u32 s32, s32, 86016
    s_mov_b32 s33, 3
L_fl_166:
    buffer_store_dwordx4 v[172:175], v1, s[8:11], s32 offen sc1
    buffer_store_dwordx4 v[172:175], v1, s[8:11], s32 offen offset:1024 sc1
    s_add_u32 s32, s32, 2048
    s_sub_u32 s33, s33, 1
    s_cmp_lg_u32 s33, 0
    s_cbranch_scc1 L_fl_166
    s_waitcnt vmcnt(6)
    s_mov_b64 exec, 1
    buffer_store_dword v20, off, s[8:11], s37 offset:0 sc1
    s_mov_b64 exec, -1
    s_mov_b32 s33, 11
L_fl_167:
    buffer_store_dwordx4 v[172:175], v1, s[8:11], s32 offen sc1
    buffer_store_dwordx4 v[172:175], v1, s[8:11], s32 offen offset:1024 sc1
    s_add_u32 s32, s32, 2048
    s_sub_u32 s33, s33, 1
    s_cmp_lg_u32 s33, 0
    s_cbranch_scc1 L_fl_167
    s_mul_i32 s32, s31, 22528
    s_add_u32 s32, s32, 10182656
    s_mov_b32 s33, 3
L_fl_168:
    buffer_store_dwordx4 v[172:175], v1, s[8:11], s32 offen sc1
    buffer_store_dwordx4 v[172:175], v1, s[8:11], s32 offen offset:1024 sc1
    s_add_u32 s32, s32, 2048
    s_sub_u32 s33, s33, 1
    s_cmp_lg_u32 s33, 0
    s_cbranch_scc1 L_fl_168
    s_waitcnt vmcnt(6)
    s_mov_b64 exec, 1
    buffer_store_dword v20, off, s[8:11], s37 offset:512 sc1
    s_mov_b64 exec, -1
    s_mov_b32 s33, 8
L_fl_169:
    buffer_store_dwordx4 v[172:175], v1, s[8:11], s32 offen sc1
    buffer_store_dwordx4 v[172:175], v1, s[8:11], s32 offen offset:1024 sc1
    s_add_u32 s32, s32, 2048
    s_sub_u32 s33, s33, 1
    s_cmp_lg_u32 s33, 0
    s_cbranch_scc1 L_fl_169
    s_waitcnt vmcnt(0)
    s_barrier
    s_cmp_lg_u32 s26, 0
    s_cbranch_scc1 L_w0_170
    s_mov_b64 exec, 0xff
    buffer_atomic_add v20, v22, s[8:11], s34 offen offset:1024 sc1
    s_mov_b64 exec, -1
L_w0_170:
    s_endpgm
L_code_end:
.section .rodata,"a"
.p2align 6
.amdhsa_kernel interleave_layers__spectral_fnet__dense_activation_relu__prompt_kernel
  .amdhsa_next_free_vgpr 512
  .amdhsa_next_free_sgpr 102
  .amdhsa_accum_offset 256
  .amdhsa_group_segment_fixed_size 0
  .amdhsa_kernarg_size 88
  .amdhsa_user_sgpr_count 2
  .amdhsa_user_sgpr_kernarg_segment_ptr 1
  .amdhsa_system_sgpr_workgroup_id_x 1
  .amdhsa_float_denorm_mode_32 3
.end_amdhsa_kernel
```
